```python
import torch

def _softmax(x, axis=-1):
    return torch.softmax(x, dim=axis)

def _gelu(x):
    return torch.nn.functional.gelu(x, approximate='tanh')

def _silu(x):
    return torch.nn.functional.silu(x)

def _sigmoid(x):
    return torch.sigmoid(x)

def _layernorm(x, axis=-1, eps=1e-05):
    m = x.mean(dim=axis, keepdim=True)
    v = x.var(dim=axis, keepdim=True, unbiased=False)
    return (x - m) / torch.sqrt(v + eps)

def _scatter_add(tgt, idx, src, axis=0):
    return tgt.clone().index_add_(axis, idx, src)

def _segment_sum(src, seg, n):
    out = torch.zeros((n,) + src.shape[1:], dtype=src.dtype)
    return out.index_add_(0, seg, src)

def _pad(x, pw):
    flat = tuple((v for pair in reversed(pw) for v in pair))
    return torch.nn.functional.pad(x, flat)
kernel_name = 'interleave_layers__spectral_fnet__mixer_gmlp__prompt'

def setup_inputs():

    _w = lambda a: (lambda t: t.to(torch.bfloat16) if t.is_floating_point() else t)(torch.as_tensor(a))

    def _A_setup():
        B, S, D = (1, 2048, 512)
        ns = torch.arange(S)[:, None] * torch.arange(S)[None, :]
        nd = torch.arange(D)[:, None] * torch.arange(D)[None, :]
        Ws_re = torch.cos(-2.0 * torch.pi * ns / S).to(float)
        Ws_im = torch.sin(-2.0 * torch.pi * ns / S).to(float)
        Wd_re = torch.cos(-2.0 * torch.pi * nd / D).to(float)
        Wd_im = torch.sin(-2.0 * torch.pi * nd / D).to(float)
        return {'x': _w((lambda *s: torch.randn(*s, dtype=torch.bfloat16) * 0.05)(B, S, D)), 'dft_seq_re': _w(Ws_re), 'dft_seq_im': _w(Ws_im), 'dft_hid_re': _w(Wd_re), 'dft_hid_im': _w(Wd_im)}
    _A_in = _A_setup()

    def _B_setup():
        B, S, D, F = (1, 2048, 512, 1792)
        Fh = F // 2
        return {'x': _w((lambda *s: torch.randn(*s, dtype=torch.bfloat16) * 0.05)(B, S, D)), 'w_in': _w((lambda *s: torch.randn(*s, dtype=torch.bfloat16) * 1.6)(D, 2 * Fh)), 'w_sp': _w(0.01 * (lambda *s: torch.randn(*s, dtype=torch.bfloat16) * 1.6)(S, S)), 'b_sp': _w(1.0 + 0.01 * (lambda *s: torch.randn(*s, dtype=torch.bfloat16) * 1.6)(S)), 'w_out': _w((lambda *s: torch.randn(*s, dtype=torch.bfloat16) * 1.6)(Fh, D))}
    _B_in = _B_setup()
    return {'A_x': _A_in['x'], 'A_dft_seq_re': _A_in['dft_seq_re'], 'A_dft_seq_im': _A_in['dft_seq_im'], 'A_dft_hid_re': _A_in['dft_hid_re'], 'A_dft_hid_im': _A_in['dft_hid_im'], 'B_x': _B_in['x'], 'B_w_in': _B_in['w_in'], 'B_w_sp': _B_in['w_sp'], 'B_b_sp': _B_in['b_sp'], 'B_w_out': _B_in['w_out']}

def reference(A_x, A_dft_seq_re, A_dft_seq_im, A_dft_hid_re, A_dft_hid_im, B_x, B_w_in, B_w_sp, B_b_sp, B_w_out):

    def _A_ref(x, dft_seq_re, dft_seq_im, dft_hid_re, dft_hid_im):
        a = torch.einsum('bsd,ed->bse', x, dft_hid_re)
        b = torch.einsum('bsd,ed->bse', x, dft_hid_im)
        y = torch.einsum('ts,bse->bte', dft_seq_re, a) - torch.einsum('ts,bse->bte', dft_seq_im, b)
        return y

    def _B_ref(x, w_in, w_sp, b_sp, w_out):
        B, S, D = x.shape
        F = w_in.shape[-1]
        Fh = F // 2
        z = _gelu(torch.einsum('bsd,df->bsf', x, w_in))
        z1 = z[..., :Fh].clone()
        z2 = _layernorm(z[..., Fh:], axis=-1)
        g = torch.einsum('ts,bsf->btf', w_sp, z2) + b_sp[None, :, None]
        return torch.einsum('bsf,fd->bsd', z1 * g, w_out)
    x = A_x
    x = x + _A_ref(_layernorm(x, axis=-1), A_dft_seq_re, A_dft_seq_im, A_dft_hid_re, A_dft_hid_im)
    x = x + _B_ref(_layernorm(x, axis=-1), B_w_in, B_w_sp, B_b_sp, B_w_out)
    x = x + _A_ref(_layernorm(x, axis=-1), A_dft_seq_re, A_dft_seq_im, A_dft_hid_re, A_dft_hid_im)
    x = x + _B_ref(_layernorm(x, axis=-1), B_w_in, B_w_sp, B_b_sp, B_w_out)
    return x
```

```asm
; @launch grid=(256,1,1) block=(256,1,1) lds=163840
.amdgcn_target "amdgcn-amd-amdhsa--gfx950"
.text
.globl interleave_layers__spectral_fnet__mixer_gmlp__prompt_kernel
.p2align 8
.type interleave_layers__spectral_fnet__mixer_gmlp__prompt_kernel,@function
interleave_layers__spectral_fnet__mixer_gmlp__prompt_kernel:
    s_cmp_ge_u32 s2, 256
    s_cbranch_scc1 L_exit
    s_load_dwordx2 s[4:5], s[0:1], 0
    s_load_dwordx2 s[24:25], s[0:1], 96
    s_load_dwordx2 s[8:9], s[0:1], 48
    s_load_dwordx2 s[16:17], s[0:1], 72
    s_load_dwordx2 s[12:13], s[0:1], 56
    s_load_dwordx2 s[32:33], s[0:1], 64
    s_getpc_b64 s[92:93]
L_pc:
    v_mov_b32 v107, v0
    s_lshr_b32 s94, s2, 3
    s_lshl_b32 s94, s94, 4
    v_lshrrev_b32 v32, 4, v0
    v_add_u32 v32, s94, v32
    v_lshlrev_b32 v32, 7, v32
    v_min_u32 v32, L_end-L_pc-4, v32
    v_mov_b32 v35, s93
    v_add_co_u32 v34, vcc, s92, v32
    s_nop 1
    v_addc_co_u32 v35, vcc, 0, v35, vcc
    global_load_dword v253, v[34:35], off
    v_lshrrev_b32 v103, 6, v0
    v_and_b32 v100, 63, v0
    v_readfirstlane_b32 s40, v103
    s_lshr_b32 s94, s2, 3
    s_and_b32 s42, s94, 7
    s_and_b32 s95, s2, 7
    s_lshl_b32 s95, s95, 1
    s_lshr_b32 s96, s94, 4
    s_add_u32 s95, s95, s96
    s_sub_u32 s96, 32, s95
    s_cmp_eq_u32 s95, 0
    s_cselect_b32 s96, 16, s96
    s_bitcmp1_b32 s94, 3
    s_cselect_b32 s41, s96, s95
    s_lshl_b32 s69, s42, 7
    s_lshl_b32 s94, s40, 9
    s_add_u32 s94, s94, s41
    v_and_b32 v103, 28, v100
    v_lshlrev_b32 v103, 4, v103
    v_and_b32 v104, 32, v100
    v_add3_u32 v103, v103, v104, s94
    v_lshlrev_b32 v105, 10, v103
    v_and_b32 v104, 3, v100
    v_lshl_add_u32 v103, v104, 5, v105
    v_lshl_add_u32 v105, v104, 4, v105
    s_mov_b32 s6, 0x200000
    s_mov_b32 s7, 0x20000
    s_mov_b32 s43, 0
    s_waitcnt lgkmcnt(0)
    buffer_load_dwordx4 v[120:123], v103, s[4:7], s69 offen
    buffer_load_dwordx4 v[124:127], v103, s[4:7], s69 offen offset:16
    s_add_u32 s99, s69, 128
    s_and_b32 s99, s99, 0x3ff
    buffer_load_dwordx4 v[128:131], v105, s[4:7], s99 offen
    buffer_load_dwordx4 v[132:135], v105, s[4:7], s99 offen offset:64
    v_and_b32 v101, 15, v100
    v_lshrrev_b32 v102, 4, v100
    v_lshlrev_b32 v0, 4, v100
    s_mov_b32 s26, 0x800000
    s_mov_b32 s27, 0x20000
    s_mov_b32 s10, 0x1c0000
    s_mov_b32 s11, 0x20000
    s_mov_b32 s18, 0xe0000
    s_mov_b32 s19, 0x20000
    s_mov_b32 s14, 0x800000
    s_mov_b32 s15, 0x20000
    s_mov_b32 s34, 0x1000
    s_mov_b32 s35, 0x20000
    s_mov_b32 s38, 0x2000000
    s_mov_b32 s39, 0x20000
    s_mov_b32 s30, 0x100
    s_mov_b32 s31, 0x20000
    s_mov_b32 s22, 0x200000
    s_mov_b32 s23, 0x20000
    s_mov_b32 s44, 2000000
    s_lshl_b32 s3, s42, 2
    s_getreg_b32 s55, hwreg(HW_REG_XCC_ID)
    s_mov_b32 s63, 0x3f803f80
    s_mov_b32 s60, 0x05040100
    s_mov_b32 s61, 0x07060302
    s_bitcmp1_b32 s2, 6
    s_cselect_b32 s96, 0x02020202, 0
    s_xor_b32 s60, s60, s96
    s_xor_b32 s61, s61, s96
    v_and_b32 v106, 7, v101
    v_lshlrev_b32 v106, 6, v106
    v_and_b32 v104, 8, v101
    v_lshlrev_b32 v104, 2, v104
    v_add3_u32 v106, v106, v104, s94
    v_lshlrev_b32 v106, 1, v106
    s_lshl_b32 s96, s41, 2
    s_add_u32 s96, s96, s40
    s_lshl_b32 s56, s96, 10
    s_add_u32 s56, s56, 0x340000
    s_lshl_b32 s96, s41, 10
    s_add_u32 s66, s96, 0x310000
    s_lshl_b32 s96, s40, 7
    s_add_u32 s96, s96, 256
    s_add_u32 s68, s96, s66
    v_lshlrev_b32 v20, 3, v101
    v_lshl_add_u32 v20, v102, 8, v20
    s_lshl_b32 s96, s42, 2
    s_add_u32 s96, s96, s40
    s_mul_i32 s52, s96, 114688
    s_add_u32 s52, s52, 0x600000
    s_and_b32 s96, s41, 7
    s_lshl_b32 s96, s96, 10
    s_lshr_b32 s97, s41, 3
    s_lshl_b32 s97, s97, 8
    s_add_u32 s96, s96, s97
    s_add_u32 s51, s52, s96
    v_and_b32 v32, 1, v102
    v_lshlrev_b32 v32, 14, v32
    v_and_b32 v33, 2, v102
    v_lshl_add_u32 v32, v33, 12, v32
    v_lshl_add_u32 v7, v101, 4, v32
    v_mov_b32 v116, -1
    v_mov_b32 v117, -1
    v_mov_b32 v118, -1
    v_mov_b32 v119, -1
    v_mov_b32 v64, -1
    v_mov_b32 v65, -1
    v_mov_b32 v66, s55
    v_mov_b32 v67, 0
    v_and_b32 v68, 16, v0
    v_lshlrev_b32 v68, 13, v68
    v_and_b32 v69, 0x60, v0
    v_or_b32 v68, v68, v69
    s_load_dwordx2 s[28:29], s[0:1], 88
    s_load_dwordx2 s[20:21], s[0:1], 80
    s_lshl_b32 s96, s2, 2
    s_add_u32 s75, s96, s40
    s_cmp_eq_u32 s75, 3
    s_cbranch_scc0 skip_1
    v_lshlrev_b32 v70, 4, v0
    s_mov_b32 s99, 0x300000
    buffer_store_dword v67, v70, s[24:27], s99 offen sc1
    s_mov_b32 s99, 0x304000
    buffer_store_dword v67, v70, s[24:27], s99 offen sc1
skip_1:
    s_and_b32 s96, s42, 3
    s_lshl_b32 s96, s96, 3
    s_and_b32 s97, s42, 4
    s_add_u32 s96, s96, s97
    s_add_u32 s96, s96, s40
    s_lshl_b32 s96, s96, 2
    s_add_u32 s97, s66, 768
    s_add_u32 s86, s96, s97
    s_lshl_b32 s96, s40, 5
    s_add_u32 s87, s96, s97
    s_mov_b64 exec, 3
    buffer_store_dword v67, v68, s[24:27], s86 offen sc1
    s_mov_b64 exec, 0xffff
    s_add_u32 s96, s56, s69
    s_add_u32 s96, s96, 0x0
    buffer_store_dwordx2 v[64:65], v20, s[24:27], s96 offen sc1
    s_add_u32 s96, s56, s69
    s_add_u32 s96, s96, 0x20000
    buffer_store_dwordx2 v[64:65], v20, s[24:27], s96 offen sc1
    s_add_u32 s96, s56, s69
    s_add_u32 s96, s96, 0x40000
    buffer_store_dwordx2 v[64:65], v20, s[24:27], s96 offen sc1
    s_mov_b64 exec, 0xff
    s_add_u32 s97, s68, s3
    buffer_store_dword v67, v68, s[24:27], s97 offen sc1
    s_cmp_eq_u32 s40, 0
    s_cbranch_scc0 skip_2
    s_mov_b64 exec, 1
    s_add_u32 s96, s66, s3
    buffer_store_dword v66, off, s[24:27], s96 offset:128 sc1
    s_mov_b64 exec, 15
    buffer_store_dword v67, v68, s[24:27], s96 offen sc1
    s_lshl_b32 s96, s2, 8
    s_add_u32 s96, s96, 0x300000
    s_and_b32 s97, s2, 0x81
    s_cmp_eq_u32 s97, 0x80
    s_cselect_b32 exec_lo, 3, 2
    buffer_store_dword v67, v68, s[24:27], s96 offen sc1
skip_2:
    s_mov_b64 exec, -1
    s_add_u32 s36, s24, 0x800000
    s_addc_u32 s37, s25, 0
    s_waitcnt lgkmcnt(0)
    s_add_u32 s92, s92, L_table-L_pc
    s_addc_u32 s93, s93, 0
    v_add_u32 v32, 0, v107
    v_mul_u32_u24 v33, 4682, v32
    v_lshrrev_b32 v33, 16, v33
    v_mul_u32_u24 v34, 14, v33
    v_sub_u32 v32, v32, v34
    v_and_b32 v34, 0x38, v33
    v_add_u32 v33, v33, v34
    v_mul_u32_u24 v33, 3584, v33
    v_lshl_add_u32 v112, v32, 4, v33
    v_add_u32 v32, 256, v107
    v_mul_u32_u24 v33, 4682, v32
    v_lshrrev_b32 v33, 16, v33
    v_mul_u32_u24 v34, 14, v33
    v_sub_u32 v32, v32, v34
    v_and_b32 v34, 0x38, v33
    v_add_u32 v33, v33, v34
    v_mul_u32_u24 v33, 3584, v33
    v_lshl_add_u32 v113, v32, 4, v33
    s_and_b32 s94, s41, 7
    s_lshl_b32 s94, s94, 6
    s_and_b32 s95, s41, 8
    s_add_u32 s94, s94, s95
    s_mul_i32 s94, s94, 3584
    s_lshr_b32 s95, s41, 4
    s_mul_i32 s95, s95, 1792
    s_add_u32 s94, s94, s95
    s_mul_i32 s95, s42, 224
    s_add_u32 s76, s94, s95
    v_lshrrev_b32 v32, 3, v100
    v_and_b32 v33, 0x70, v0
    v_lshl_add_u32 v114, v32, 10, v33
    s_and_b32 s94, s41, 7
    s_mul_i32 s94, s94, 112
    s_lshr_b32 s95, s41, 3
    s_lshl_b32 s95, s95, 5
    s_add_u32 s94, s94, s95
    s_sub_u32 s95, s41, 24
    s_mul_i32 s95, s95, 224
    s_add_u32 s95, s95, 96
    s_cmp_lt_u32 s41, 24
    s_cselect_b32 s94, s94, s95
    s_cselect_b32 s95, 16, 112
    s_lshr_b32 s96, s40, 1
    s_mul_i32 s95, s95, s96
    s_add_u32 s94, s94, s95
    s_and_b32 s95, s40, 1
    s_lshl_b32 s95, s95, 3
    s_add_u32 s94, s94, s95
    s_lshl_b32 s94, s94, 10
    s_add_u32 s77, s94, s69
    v_lshrrev_b32 v32, 2, v101
    v_lshl_add_u32 v32, v102, 3, v32
    v_mul_u32_u24 v32, 224, v32
    v_and_b32 v33, 3, v100
    v_lshl_add_u32 v32, v33, 3, v32
    s_lshl_b32 s94, s40, 5
    s_add_u32 s94, s94, 149504
    v_add_u32 v242, s94, v32
    s_lshl_b32 s94, s40, 3
    s_add_u32 s94, s94, 157696
    v_lshl_add_u32 v243, v100, 5, s94
    v_lshrrev_b32 v32, 3, v100
    v_lshlrev_b32 v32, 18, v32
    v_and_b32 v33, 7, v100
    v_xor_b32 v33, v33, v102
    v_lshl_add_u32 v32, v33, 4, v32
    s_lshl_b32 s94, s41, 12
    s_add_u32 s100, s40, s42
    s_and_b32 s100, s100, 3
    s_lshl_b32 s95, s100, 10
    s_add_u32 s94, s94, s95
    v_add_u32 v244, s94, v32
    v_xor_b32 v32, 64, v244
    v_add_u32 v245, 0x20000, v32
    s_mul_i32 s59, s40, 24576
    v_lshrrev_b32 v32, 1, v101
    v_xor_b32 v32, v32, v102
    v_lshlrev_b32 v32, 4, v32
    v_lshl_add_u32 v32, v101, 7, v32
    s_add_u32 s94, s59, 1024
    v_add_u32 v236, s94, v32
    v_xor_b32 v237, 64, v236
    s_lshr_b32 s94, s42, 2
    s_lshl_b32 s95, s40, 21
    s_lshl_b32 s96, s94, 13
    s_add_u32 s78, s96, s59
    s_lshl_b32 s96, s94, 9
    s_add_u32 s80, s96, s95
    s_xor_b32 s94, s94, 1
    s_lshl_b32 s96, s94, 13
    s_add_u32 s79, s96, s59
    s_lshl_b32 s96, s94, 9
    s_add_u32 s81, s96, s95
    s_xor_b32 s94, s94, 1
    s_lshl_b32 s82, s40, 10
    s_add_u32 m0, s82, 149504
    s_nop 0
    buffer_load_dwordx4 v112, s[8:11], s76 offen lds
    s_add_u32 m0, s82, 153600
    s_nop 0
    buffer_load_dwordx4 v113, s[8:11], s76 offen lds
    s_add_u32 m0, s82, 157696
    s_nop 0
    buffer_load_dwordx4 v114, s[16:19], s77 offen lds
    buffer_load_ushort v6, v106, s[32:35], 0 offen
    s_mul_i32 s94, s42, 229376
    s_mul_i32 s95, s41, 7168
    s_add_u32 s94, s94, s95
    s_lshl_b32 s95, s40, 10
    s_add_u32 s94, s94, s95
    s_mov_b32 s83, s94
    s_add_u32 s94, s94, 4096
    s_cmp_lt_u32 s40, 3
    s_cselect_b32 s94, s94, 0x800000
    s_mov_b32 s84, s94
    s_mul_i32 s94, s42, 114688
    s_lshl_b32 s96, s41, 12
    s_add_u32 s94, s94, s96
    s_add_u32 s94, s94, s95
    s_add_u32 s94, s94, 0x200000
    s_cmp_lt_u32 s41, 28
    s_cselect_b32 s94, s94, 0x800000
    s_mov_b32 s85, s94
    s_lshl_b32 s45, s41, 11
    s_lshl_b32 s96, s42, 8
    s_add_u32 s45, s45, s96
    v_lshlrev_b32 v35, 17, v102
    v_lshl_add_u32 v35, v101, 4, v35
    s_lshl_b32 s96, s40, 19
    v_add_u32 v5, s96, v35
    v_mul_u32_u24 v35, 160, v101
    v_lshl_add_u32 v35, v102, 3, v35
    s_mul_i32 s96, s40, 2560
    s_add_u32 s96, s96, 137216
    v_add_u32 v250, s96, v35
    v_lshrrev_b32 v35, 2, v100
    v_mul_u32_u24 v35, 160, v35
    v_and_b32 v34, 3, v100
    v_lshl_add_u32 v35, v34, 3, v35
    v_add_u32 v16, s96, v35
    v_add_u32 v17, 137216, v35
    s_lshr_b32 s94, s42, 2
    s_and_b32 s95, s42, 3
    s_sub_u32 s96, 32, s41
    s_and_b32 s96, s96, 31
    s_cmp_eq_u32 s94, 0
    s_cselect_b32 s96, s41, s96
    s_lshl_b32 s46, s96, 16
    s_lshl_b32 s47, s41, 16
    s_lshl_b32 s96, s95, 14
    s_lshl_b32 s97, s94, 7
    s_add_u32 s96, s96, s97
    s_add_u32 s48, s47, s96
    s_lshl_b32 s96, s40, 14
    s_add_u32 s47, s47, s96
    s_mov_b32 s50, 0
    s_mov_b32 s49, 0x10000
    s_lshl_b32 s96, s42, 2
    s_add_u32 s96, s96, s100
    s_mul_i32 s52, s96, 114688
    s_add_u32 s52, s52, 0x600000
    s_lshl_b32 s96, s41, 2
    s_add_u32 s96, s96, s40
    s_lshl_b32 s54, s96, 14
    s_add_u32 s54, s54, 0x200000
    s_lshl_b32 s97, s42, 10
    s_add_u32 s53, s54, s97
    s_lshl_b32 s70, s40, 12
    s_mul_i32 s57, s42, 229376
    s_add_u32 s57, s57, s70
    s_mul_i32 s58, s42, 114688
    s_add_u32 s58, s58, s70
    s_add_u32 s58, s58, 0x200000
    s_and_b32 s96, s2, 15
    s_lshl_b32 s96, s96, 8
    s_add_u32 s64, s96, 0x300000
    s_and_b32 s96, s2, 7
    s_lshl_b32 s96, s96, 12
    s_add_u32 s65, s96, 0x300000
    s_lshl_b32 s97, s42, 9
    s_add_u32 s97, s97, 0x308000
    s_add_u32 s88, s96, s97
    s_mov_b32 s67, s97
    s_mov_b32 s89, 0
    v_lshlrev_b32 v21, 3, v100
    v_add_u32 v252, 0x10000, v0
    v_add_u32 v255, 0x20000, v0
    v_lshlrev_b32 v23, 8, v101
    v_and_b32 v24, 7, v100
    v_lshlrev_b32 v254, 2, v24
    v_lshlrev_b32 v24, 12, v24
    v_mov_b32 v26, 0xbdd2d3e8
    v_mov_b32 v27, 0xc0135761
    v_lshrrev_b32 v32, 3, v100
    v_and_b32 v36, 7, v100
    v_lshlrev_b32 v36, 4, v36
    v_lshl_add_u32 v34, v32, 8, v36
    s_lshl_b32 s96, s40, 12
    v_add_u32 v2, s96, v34
    v_and_b32 v32, 1, v32
    v_lshl_add_u32 v32, v32, 4, v102
    v_mul_u32_u24 v32, 144, v32
    s_lshr_b32 s96, s40, 1
    s_mul_i32 s96, s96, 4608
    s_and_b32 s97, s40, 1
    s_mul_i32 s97, s97, 1152
    s_add_u32 s96, s96, s97
    s_add_u32 s96, s96, 137216
    v_add3_u32 v22, v32, v36, s96
    v_lshrrev_b32 v32, 5, v100
    v_and_b32 v33, 1, v102
    v_lshl_add_u32 v34, v32, 4, v101
    v_mul_u32_u24 v34, 144, v34
    v_lshl_add_u32 v34, v33, 4, v34
    s_lshl_b32 s96, s40, 5
    s_add_u32 s97, s96, 137216
    v_add_u32 v1, s97, v34
    v_and_b32 v34, 1, v100
    v_lshlrev_b32 v34, 5, v34
    v_and_b32 v35, 2, v100
    v_lshl_add_u32 v34, v35, 3, v34
    v_lshrrev_b32 v35, 2, v100
    v_add_u32 v34, v34, v35
    v_mul_u32_u24 v34, 144, v34
    v_add_u32 v246, s97, v34
    v_add_u32 v247, 16, v246
    s_lshl_b32 s96, s95, 4
    s_add_u32 s96, s96, s94
    s_lshl_b32 s96, s96, 5
    s_add_u32 s98, s96, s41
    s_lshl_b32 s96, s40, 7
    s_add_u32 s96, s96, s98
    s_lshl_b32 s96, s96, 10
    v_add_u32 v3, s96, v0
    v_mul_u32_u24 v35, 1040, v33
    v_lshl_add_u32 v35, v32, 8, v35
    v_lshl_add_u32 v35, v101, 3, v35
    s_mul_i32 s96, s40, 2080
    s_add_u32 s96, s96, 137216
    v_add_u32 v19, s96, v35
    v_mul_u32_u24 v35, 1040, v101
    v_lshl_add_u32 v35, v102, 5, v35
    s_lshl_b32 s96, s40, 8
    s_add_u32 s96, s96, 137216
    v_add_u32 v18, s96, v35
    v_lshlrev_b32 v35, 13, v102
    v_lshl_add_u32 v35, v101, 4, v35
    s_lshl_b32 s96, s40, 9
    v_add_u32 v4, s96, v35
    s_add_u32 s96, s40, 1
    s_and_b32 s96, s96, 3
    s_mul_i32 s96, s96, 3072
    s_add_u32 s96, s96, 114688
    v_add_u32 v28, s96, v0
    s_add_u32 s96, s40, 2
    s_and_b32 s96, s96, 3
    s_mul_i32 s96, s96, 3072
    s_add_u32 s96, s96, 115712
    v_add_u32 v29, s96, v0
    s_add_u32 s96, s40, 3
    s_and_b32 s96, s96, 3
    s_mul_i32 s96, s96, 3072
    s_add_u32 s96, s96, 116736
    v_add_u32 v30, s96, v0
    s_add_u32 s96, s40, 4
    s_and_b32 s96, s96, 3
    s_mul_i32 s96, s96, 3072
    s_add_u32 s96, s96, 114688
    v_add_u32 v31, s96, v0
    v_and_b32 v32, 7, v101
    v_lshlrev_b32 v32, 6, v32
    v_add_u32 v32, s98, v32
    v_lshlrev_b32 v33, 2, v102
    v_mul_u32_u24 v33, v33, v32
    v_lshrrev_b32 v34, 3, v101
    v_lshl_add_u32 v33, v34, 9, v33
    s_cmp_eq_u32 s94, 0
    s_cselect_b32 s73, 1.0, -1.0
    s_cselect_b32 s74, 0, 1.0
    s_cselect_b32 s72, 1.0, 0
    s_cmp_eq_u32 s41, 0
    s_cselect_b32 s72, s72, 1.0
    s_cselect_b32 s73, 0, s73
    s_cselect_b32 s74, s74, 0
    v_mad_u32_u24 v34, v32, 0, v33
    v_and_b32 v34, 0x7ff, v34
    v_cvt_f32_u32 v34, v34
    v_mul_f32 v34, 0x3a000000, v34
    v_cos_f32 v35, v34
    v_sin_f32 v36, v34
    v_mul_f32 v37, s74, v35
    v_mul_f32 v35, s72, v35
    v_fma_f32 v36, s73, v36, v37
    v_cvt_pk_bf16_f32 v8, v35, v36
    v_mad_u32_u24 v34, v32, 1, v33
    v_and_b32 v34, 0x7ff, v34
    v_cvt_f32_u32 v34, v34
    v_mul_f32 v34, 0x3a000000, v34
    v_cos_f32 v35, v34
    v_sin_f32 v36, v34
    v_mul_f32 v37, s74, v35
    v_mul_f32 v35, s72, v35
    v_fma_f32 v36, s73, v36, v37
    v_cvt_pk_bf16_f32 v9, v35, v36
    v_mad_u32_u24 v34, v32, 2, v33
    v_and_b32 v34, 0x7ff, v34
    v_cvt_f32_u32 v34, v34
    v_mul_f32 v34, 0x3a000000, v34
    v_cos_f32 v35, v34
    v_sin_f32 v36, v34
    v_mul_f32 v37, s74, v35
    v_mul_f32 v35, s72, v35
    v_fma_f32 v36, s73, v36, v37
    v_cvt_pk_bf16_f32 v10, v35, v36
    v_mad_u32_u24 v34, v32, 3, v33
    v_and_b32 v34, 0x7ff, v34
    v_cvt_f32_u32 v34, v34
    v_mul_f32 v34, 0x3a000000, v34
    v_cos_f32 v35, v34
    v_sin_f32 v36, v34
    v_mul_f32 v37, s74, v35
    v_mul_f32 v35, s72, v35
    v_fma_f32 v36, s73, v36, v37
    v_cvt_pk_bf16_f32 v11, v35, v36
    v_mad_u32_u24 v34, v32, 16, v33
    v_and_b32 v34, 0x7ff, v34
    v_cvt_f32_u32 v34, v34
    v_mul_f32 v34, 0x3a000000, v34
    v_cos_f32 v35, v34
    v_sin_f32 v36, v34
    v_mul_f32 v37, s74, v35
    v_mul_f32 v35, s72, v35
    v_fma_f32 v36, s73, v36, v37
    v_cvt_pk_bf16_f32 v12, v35, v36
    v_mad_u32_u24 v34, v32, 17, v33
    v_and_b32 v34, 0x7ff, v34
    v_cvt_f32_u32 v34, v34
    v_mul_f32 v34, 0x3a000000, v34
    v_cos_f32 v35, v34
    v_sin_f32 v36, v34
    v_mul_f32 v37, s74, v35
    v_mul_f32 v35, s72, v35
    v_fma_f32 v36, s73, v36, v37
    v_cvt_pk_bf16_f32 v13, v35, v36
    v_mad_u32_u24 v34, v32, 18, v33
    v_and_b32 v34, 0x7ff, v34
    v_cvt_f32_u32 v34, v34
    v_mul_f32 v34, 0x3a000000, v34
    v_cos_f32 v35, v34
    v_sin_f32 v36, v34
    v_mul_f32 v37, s74, v35
    v_mul_f32 v35, s72, v35
    v_fma_f32 v36, s73, v36, v37
    v_cvt_pk_bf16_f32 v14, v35, v36
    v_mad_u32_u24 v34, v32, 19, v33
    v_and_b32 v34, 0x7ff, v34
    v_cvt_f32_u32 v34, v34
    v_mul_f32 v34, 0x3a000000, v34
    v_cos_f32 v35, v34
    v_sin_f32 v36, v34
    v_mul_f32 v37, s74, v35
    v_mul_f32 v35, s72, v35
    v_fma_f32 v36, s73, v36, v37
    v_cvt_pk_bf16_f32 v15, v35, v36
    s_add_u32 s99, s69, 256
    s_and_b32 s99, s99, 0x3ff
    buffer_load_dwordx4 v[136:139], v105, s[4:7], s99 offen
    buffer_load_dwordx4 v[140:143], v105, s[4:7], s99 offen offset:64
    s_add_u32 s99, s69, 384
    s_and_b32 s99, s99, 0x3ff
    buffer_load_dwordx4 v[144:147], v105, s[4:7], s99 offen
    buffer_load_dwordx4 v[148:151], v105, s[4:7], s99 offen offset:64
    s_add_u32 s99, s69, 512
    s_and_b32 s99, s99, 0x3ff
    buffer_load_dwordx4 v[152:155], v105, s[4:7], s99 offen
    buffer_load_dwordx4 v[156:159], v105, s[4:7], s99 offen offset:64
    s_add_u32 s99, s69, 640
    s_and_b32 s99, s99, 0x3ff
    buffer_load_dwordx4 v[160:163], v105, s[4:7], s99 offen
    buffer_load_dwordx4 v[164:167], v105, s[4:7], s99 offen offset:64
    s_add_u32 s99, s69, 768
    s_and_b32 s99, s99, 0x3ff
    buffer_load_dwordx4 v[168:171], v105, s[4:7], s99 offen
    buffer_load_dwordx4 v[172:175], v105, s[4:7], s99 offen offset:64
    s_add_u32 s99, s69, 896
    s_and_b32 s99, s99, 0x3ff
    buffer_load_dwordx4 v[176:179], v105, s[4:7], s99 offen
    buffer_load_dwordx4 v[180:183], v105, s[4:7], s99 offen offset:64
    s_lshl_b32 s99, s40, 11
    s_add_u32 s99, s99, 14336
    v_add_u32 v108, s99, v0
    v_mov_b32 v109, s93
    v_add_co_u32 v108, vcc, s92, v108
    s_nop 1
    v_addc_co_u32 v109, vcc, 0, v109, vcc
    global_load_dwordx4 v[184:187], v[108:109], off offset:0
    global_load_dwordx4 v[188:191], v[108:109], off offset:1024
    s_mul_i32 s99, s40, 3584
    s_add_u32 m0, s99, 114688
    v_add_u32 v110, s99, v0
    v_mov_b32 v111, s93
    v_add_co_u32 v110, vcc, s92, v110
    s_nop 1
    v_addc_co_u32 v111, vcc, 0, v111, vcc
    global_load_lds_dwordx4 v[110:111], off offset:0
    global_load_lds_dwordx4 v[110:111], off offset:1024
    global_load_lds_dwordx4 v[110:111], off offset:2048
    s_mov_b32 exec_hi, 0
    global_load_lds_dwordx4 v[110:111], off offset:3072
    s_mov_b64 exec, -1
    v_mov_b32 v34, 0
    v_mov_b32 v35, 0
    v_mov_b32 v36, 0
    v_mov_b32 v37, 0
    s_waitcnt vmcnt(30)
    v_dot2c_f32_bf16 v34, s63, v120
    v_dot2c_f32_bf16 v36, v120, v120
    s_cmp_eq_u32 s75, 3
    s_cbranch_scc0 skip_3
    s_waitcnt vmcnt(27)
    v_mov_b32 v64, 1
    s_mov_b64 exec, 1
    buffer_store_dword v64, off, s[28:31], 0 sc1
    s_mov_b64 exec, -1
skip_3:
    v_dot2c_f32_bf16 v35, s63, v121
    v_dot2c_f32_bf16 v37, v121, v121
    v_dot2c_f32_bf16 v34, s63, v122
    v_dot2c_f32_bf16 v36, v122, v122
    v_dot2c_f32_bf16 v35, s63, v123
    v_dot2c_f32_bf16 v37, v123, v123
    s_waitcnt vmcnt(29)
    v_dot2c_f32_bf16 v34, s63, v124
    v_dot2c_f32_bf16 v36, v124, v124
    buffer_store_dwordx4 v[116:119], v7, s[36:39], s51 offen sc1
    v_dot2c_f32_bf16 v35, s63, v125
    v_dot2c_f32_bf16 v37, v125, v125
    v_dot2c_f32_bf16 v34, s63, v126
    v_dot2c_f32_bf16 v36, v126, v126
    v_dot2c_f32_bf16 v35, s63, v127
    v_dot2c_f32_bf16 v37, v127, v127
    v_lshlrev_b32 v40, 16, v120
    v_and_b32 v41, 0xffff0000, v120
    s_add_u32 m0, s78, 1024
    s_nop 0
    buffer_load_dwordx4 v244, s[12:15], s80 offen offset:0 lds
    v_lshlrev_b32 v42, 16, v121
    v_and_b32 v43, 0xffff0000, v121
    v_lshlrev_b32 v44, 16, v122
    v_and_b32 v45, 0xffff0000, v122
    v_lshlrev_b32 v46, 16, v123
    v_and_b32 v47, 0xffff0000, v123
    v_lshlrev_b32 v48, 16, v124
    v_and_b32 v49, 0xffff0000, v124
    s_add_u32 m0, s78, 2048
    s_nop 0
    buffer_load_dwordx4 v245, s[12:15], s80 offen offset:0 lds
    v_lshlrev_b32 v50, 16, v125
    v_and_b32 v51, 0xffff0000, v125
    v_lshlrev_b32 v52, 16, v126
    v_and_b32 v53, 0xffff0000, v126
    v_lshlrev_b32 v54, 16, v127
    v_and_b32 v55, 0xffff0000, v127
    s_waitcnt vmcnt(31)
    v_dot2c_f32_bf16 v34, s63, v128
    v_dot2c_f32_bf16 v36, v128, v128
    s_add_u32 m0, s78, 2944
    s_nop 0
    buffer_load_dwordx4 v244, s[12:15], s80 offen offset:128 lds
    v_dot2c_f32_bf16 v35, s63, v129
    v_dot2c_f32_bf16 v37, v129, v129
    v_dot2c_f32_bf16 v34, s63, v130
    v_dot2c_f32_bf16 v36, v130, v130
    v_dot2c_f32_bf16 v35, s63, v131
    v_dot2c_f32_bf16 v37, v131, v131
    s_waitcnt vmcnt(31)
    v_dot2c_f32_bf16 v34, s63, v132
    v_dot2c_f32_bf16 v36, v132, v132
    s_add_u32 m0, s78, 3968
    s_nop 0
    buffer_load_dwordx4 v245, s[12:15], s80 offen offset:128 lds
    v_dot2c_f32_bf16 v35, s63, v133
    v_dot2c_f32_bf16 v37, v133, v133
    v_dot2c_f32_bf16 v34, s63, v134
    v_dot2c_f32_bf16 v36, v134, v134
    v_dot2c_f32_bf16 v35, s63, v135
    v_dot2c_f32_bf16 v37, v135, v135
    s_waitcnt vmcnt(22)
    v_dot2c_f32_bf16 v34, s63, v136
    v_dot2c_f32_bf16 v36, v136, v136
    s_add_u32 m0, s78, 4864
    s_nop 0
    buffer_load_dwordx4 v244, s[12:15], s80 offen offset:256 lds
    v_dot2c_f32_bf16 v35, s63, v137
    v_dot2c_f32_bf16 v37, v137, v137
    v_dot2c_f32_bf16 v34, s63, v138
    v_dot2c_f32_bf16 v36, v138, v138
    v_dot2c_f32_bf16 v35, s63, v139
    v_dot2c_f32_bf16 v37, v139, v139
    s_waitcnt vmcnt(22)
    v_dot2c_f32_bf16 v34, s63, v140
    v_dot2c_f32_bf16 v36, v140, v140
    s_add_u32 m0, s78, 5888
    s_nop 0
    buffer_load_dwordx4 v245, s[12:15], s80 offen offset:256 lds
    v_dot2c_f32_bf16 v35, s63, v141
    v_dot2c_f32_bf16 v37, v141, v141
    v_dot2c_f32_bf16 v34, s63, v142
    v_dot2c_f32_bf16 v36, v142, v142
    v_dot2c_f32_bf16 v35, s63, v143
    v_dot2c_f32_bf16 v37, v143, v143
    s_waitcnt vmcnt(22)
    v_dot2c_f32_bf16 v34, s63, v144
    v_dot2c_f32_bf16 v36, v144, v144
    s_add_u32 m0, s78, 6784
    s_nop 0
    buffer_load_dwordx4 v244, s[12:15], s80 offen offset:384 lds
    v_dot2c_f32_bf16 v35, s63, v145
    v_dot2c_f32_bf16 v37, v145, v145
    v_dot2c_f32_bf16 v34, s63, v146
    v_dot2c_f32_bf16 v36, v146, v146
    v_dot2c_f32_bf16 v35, s63, v147
    v_dot2c_f32_bf16 v37, v147, v147
    s_waitcnt vmcnt(22)
    v_dot2c_f32_bf16 v34, s63, v148
    v_dot2c_f32_bf16 v36, v148, v148
    s_add_u32 m0, s78, 7808
    s_nop 0
    buffer_load_dwordx4 v245, s[12:15], s80 offen offset:384 lds
    v_dot2c_f32_bf16 v35, s63, v149
    v_dot2c_f32_bf16 v37, v149, v149
    v_dot2c_f32_bf16 v34, s63, v150
    v_dot2c_f32_bf16 v36, v150, v150
    v_dot2c_f32_bf16 v35, s63, v151
    v_dot2c_f32_bf16 v37, v151, v151
    s_waitcnt vmcnt(22)
    v_dot2c_f32_bf16 v34, s63, v152
    v_dot2c_f32_bf16 v36, v152, v152
    v_dot2c_f32_bf16 v35, s63, v153
    v_dot2c_f32_bf16 v37, v153, v153
    v_dot2c_f32_bf16 v34, s63, v154
    v_dot2c_f32_bf16 v36, v154, v154
    v_dot2c_f32_bf16 v35, s63, v155
    v_dot2c_f32_bf16 v37, v155, v155
    s_waitcnt vmcnt(21)
    v_dot2c_f32_bf16 v34, s63, v156
    v_dot2c_f32_bf16 v36, v156, v156
    v_dot2c_f32_bf16 v35, s63, v157
    v_dot2c_f32_bf16 v37, v157, v157
    v_dot2c_f32_bf16 v34, s63, v158
    v_dot2c_f32_bf16 v36, v158, v158
    v_dot2c_f32_bf16 v35, s63, v159
    v_dot2c_f32_bf16 v37, v159, v159
    s_waitcnt vmcnt(20)
    v_dot2c_f32_bf16 v34, s63, v160
    v_dot2c_f32_bf16 v36, v160, v160
    v_dot2c_f32_bf16 v35, s63, v161
    v_dot2c_f32_bf16 v37, v161, v161
    v_dot2c_f32_bf16 v34, s63, v162
    v_dot2c_f32_bf16 v36, v162, v162
    v_dot2c_f32_bf16 v35, s63, v163
    v_dot2c_f32_bf16 v37, v163, v163
    s_waitcnt vmcnt(19)
    v_dot2c_f32_bf16 v34, s63, v164
    v_dot2c_f32_bf16 v36, v164, v164
    v_dot2c_f32_bf16 v35, s63, v165
    v_dot2c_f32_bf16 v37, v165, v165
    v_dot2c_f32_bf16 v34, s63, v166
    v_dot2c_f32_bf16 v36, v166, v166
    v_dot2c_f32_bf16 v35, s63, v167
    v_dot2c_f32_bf16 v37, v167, v167
    s_waitcnt vmcnt(18)
    v_dot2c_f32_bf16 v34, s63, v168
    v_dot2c_f32_bf16 v36, v168, v168
    v_dot2c_f32_bf16 v35, s63, v169
    v_dot2c_f32_bf16 v37, v169, v169
    v_dot2c_f32_bf16 v34, s63, v170
    v_dot2c_f32_bf16 v36, v170, v170
    v_dot2c_f32_bf16 v35, s63, v171
    v_dot2c_f32_bf16 v37, v171, v171
    s_waitcnt vmcnt(17)
    v_dot2c_f32_bf16 v34, s63, v172
    v_dot2c_f32_bf16 v36, v172, v172
    v_dot2c_f32_bf16 v35, s63, v173
    v_dot2c_f32_bf16 v37, v173, v173
    v_dot2c_f32_bf16 v34, s63, v174
    v_dot2c_f32_bf16 v36, v174, v174
    v_dot2c_f32_bf16 v35, s63, v175
    v_dot2c_f32_bf16 v37, v175, v175
    s_waitcnt vmcnt(16)
    v_dot2c_f32_bf16 v34, s63, v176
    v_dot2c_f32_bf16 v36, v176, v176
    v_dot2c_f32_bf16 v35, s63, v177
    v_dot2c_f32_bf16 v37, v177, v177
    v_dot2c_f32_bf16 v34, s63, v178
    v_dot2c_f32_bf16 v36, v178, v178
    v_dot2c_f32_bf16 v35, s63, v179
    v_dot2c_f32_bf16 v37, v179, v179
    s_waitcnt vmcnt(15)
    v_dot2c_f32_bf16 v34, s63, v180
    v_dot2c_f32_bf16 v36, v180, v180
    v_dot2c_f32_bf16 v35, s63, v181
    v_dot2c_f32_bf16 v37, v181, v181
    v_dot2c_f32_bf16 v34, s63, v182
    v_dot2c_f32_bf16 v36, v182, v182
    v_dot2c_f32_bf16 v35, s63, v183
    v_dot2c_f32_bf16 v37, v183, v183
    s_nop 1
    v_add_f32 v32, v34, v35
    v_add_f32 v33, v36, v37
    s_nop 0
    v_add_f32_dpp v32, v32, v32 quad_perm:[1,0,3,2] row_mask:0xf bank_mask:0xf
    v_add_f32_dpp v33, v33, v33 quad_perm:[1,0,3,2] row_mask:0xf bank_mask:0xf
    s_nop 0
    v_add_f32_dpp v32, v32, v32 quad_perm:[2,3,0,1] row_mask:0xf bank_mask:0xf
    v_add_f32_dpp v33, v33, v33 quad_perm:[2,3,0,1] row_mask:0xf bank_mask:0xf
    s_waitcnt lgkmcnt(0)
    s_mov_b32 s0, s86
    s_mov_b32 s1, s87
L_layer:
    v_mul_f32 v34, 0x3b000000, v32
    v_mul_f32 v33, 0x3b000000, v33
    v_fma_f32 v33, -v34, v34, v33
    v_max_f32 v33, 0, v33
    v_add_f32 v33, 0x3727c5ac, v33
    v_rsq_f32 v32, v33
    s_nop 0
    v_mul_f32 v33, -v34, v32
    v_pk_fma_f32 v[40:41], v[40:41], v[32:33], v[32:33] op_sel:[0,0,1] op_sel_hi:[1,0,1]
    v_pk_fma_f32 v[42:43], v[42:43], v[32:33], v[32:33] op_sel:[0,0,1] op_sel_hi:[1,0,1]
    v_pk_fma_f32 v[44:45], v[44:45], v[32:33], v[32:33] op_sel:[0,0,1] op_sel_hi:[1,0,1]
    v_pk_fma_f32 v[46:47], v[46:47], v[32:33], v[32:33] op_sel:[0,0,1] op_sel_hi:[1,0,1]
    v_pk_fma_f32 v[48:49], v[48:49], v[32:33], v[32:33] op_sel:[0,0,1] op_sel_hi:[1,0,1]
    v_pk_fma_f32 v[50:51], v[50:51], v[32:33], v[32:33] op_sel:[0,0,1] op_sel_hi:[1,0,1]
    v_pk_fma_f32 v[52:53], v[52:53], v[32:33], v[32:33] op_sel:[0,0,1] op_sel_hi:[1,0,1]
    v_pk_fma_f32 v[54:55], v[54:55], v[32:33], v[32:33] op_sel:[0,0,1] op_sel_hi:[1,0,1]
    v_cvt_pk_bf16_f32 v56, v40, v44
    v_cvt_pk_bf16_f32 v57, v48, v52
    ds_write_b64 v16, v[56:57] offset:0
    v_cvt_pk_bf16_f32 v58, v41, v45
    v_cvt_pk_bf16_f32 v59, v49, v53
    ds_write_b64 v16, v[58:59] offset:32
    v_cvt_pk_bf16_f32 v60, v42, v46
    v_cvt_pk_bf16_f32 v61, v50, v54
    ds_write_b64 v16, v[60:61] offset:64
    v_cvt_pk_bf16_f32 v62, v43, v47
    v_cvt_pk_bf16_f32 v63, v51, v55
    ds_write_b64 v16, v[62:63] offset:96
    s_add_u32 s73, s45, 0x10000
    s_waitcnt lgkmcnt(0)
    s_barrier
    ds_read_b64_tr_b16 v[72:73], v17 offset:0
    ds_read_b64_tr_b16 v[74:75], v17 offset:2560
    ds_read_b64_tr_b16 v[76:77], v17 offset:32
    ds_read_b64_tr_b16 v[78:79], v17 offset:2592
    ds_read_b64_tr_b16 v[80:81], v17 offset:64
    ds_read_b64_tr_b16 v[82:83], v17 offset:2624
    ds_read_b64_tr_b16 v[84:85], v17 offset:96
    ds_read_b64_tr_b16 v[86:87], v17 offset:2656
    ds_read_b64_tr_b16 v[88:89], v17 offset:5120
    ds_read_b64_tr_b16 v[90:91], v17 offset:7680
    ds_read_b64_tr_b16 v[92:93], v17 offset:5152
    ds_read_b64_tr_b16 v[94:95], v17 offset:7712
    ds_read_b64_tr_b16 v[96:97], v17 offset:5184
    ds_read_b64_tr_b16 v[98:99], v17 offset:7744
    ds_read_b64_tr_b16 v[100:101], v17 offset:5216
    ds_read_b64_tr_b16 v[102:103], v17 offset:7776
    s_cmp_eq_u32 s43, 0
    s_cbranch_scc0 skip_4
    ds_read_b64_tr_b16 v[224:225], v242 offset:0
    ds_read_b64_tr_b16 v[226:227], v242 offset:896
    ds_read_b64_tr_b16 v[228:229], v242 offset:128
    ds_read_b64_tr_b16 v[230:231], v242 offset:1024
    ds_read_b64_tr_b16 v[232:233], v243 offset:0
    ds_read_b64_tr_b16 v[234:235], v243 offset:2048
skip_4:
    s_waitcnt vmcnt(14) lgkmcnt(14)
    v_mfma_f32_16x16x32_bf16 v[104:107], v[184:187], v[72:75], 0
    s_waitcnt lgkmcnt(12)
    v_mfma_f32_16x16x32_bf16 v[108:111], v[184:187], v[76:79], 0
    s_waitcnt lgkmcnt(10)
    v_mfma_f32_16x16x32_bf16 v[112:115], v[184:187], v[80:83], 0
    s_waitcnt lgkmcnt(8)
    v_mfma_f32_16x16x32_bf16 v[116:119], v[184:187], v[84:87], 0
    s_waitcnt vmcnt(13) lgkmcnt(6)
    v_mfma_f32_16x16x32_bf16 v[104:107], v[188:191], v[88:91], v[104:107]
    s_waitcnt lgkmcnt(4)
    v_mfma_f32_16x16x32_bf16 v[108:111], v[188:191], v[92:95], v[108:111]
    s_waitcnt lgkmcnt(2)
    v_mfma_f32_16x16x32_bf16 v[112:115], v[188:191], v[96:99], v[112:115]
    s_waitcnt lgkmcnt(0)
    v_mfma_f32_16x16x32_bf16 v[116:119], v[188:191], v[100:103], v[116:119]
    s_cmp_eq_u32 s43, 0
    s_cbranch_scc0 skip_5
    v_lshlrev_b32 v6, 16, v6
    s_waitcnt lgkmcnt(4)
    buffer_store_dwordx4 v[224:227], v0, s[24:27], s83 offen sc1
    s_waitcnt lgkmcnt(2)
    buffer_store_dwordx4 v[228:231], v0, s[24:27], s84 offen sc1
    s_waitcnt lgkmcnt(0)
    buffer_store_dwordx4 v[232:235], v0, s[24:27], s85 offen sc1
skip_5:
    v_cvt_pk_bf16_f32 v56, v104, v105
    s_nop 0
    v_cvt_pk_bf16_f32 v57, v108, v109
    s_nop 0
    v_cvt_pk_bf16_f32 v58, v112, v113
    s_nop 0
    v_cvt_pk_bf16_f32 v59, v116, v117
    buffer_store_dwordx4 v[56:59], v5, s[36:39], s45 offen sc1
    v_cvt_pk_bf16_f32 v60, v106, v107
    v_cvt_pk_bf16_f32 v61, v110, v111
    v_cvt_pk_bf16_f32 v62, v114, v115
    v_cvt_pk_bf16_f32 v63, v118, v119
    buffer_store_dwordx4 v[60:63], v5, s[36:39], s73 offen sc1
    s_cmp_eq_u32 s43, 0
    s_cbranch_scc0 skip_6
    s_cmp_eq_u32 s40, 0
    s_cbranch_scc0 skip_7
    buffer_load_dword v241, off, s[28:31], 0 sc1
skip_7:
    s_add_u32 m0, s79, 1024
    s_nop 0
    buffer_load_dwordx4 v244, s[12:15], s81 offen offset:0 lds
    s_add_u32 m0, s79, 2048
    s_nop 0
    buffer_load_dwordx4 v245, s[12:15], s81 offen offset:0 lds
    s_add_u32 m0, s79, 2944
    s_nop 0
    buffer_load_dwordx4 v244, s[12:15], s81 offen offset:128 lds
    s_add_u32 m0, s79, 3968
    s_nop 0
    buffer_load_dwordx4 v245, s[12:15], s81 offen offset:128 lds
    s_add_u32 m0, s79, 4864
    s_nop 0
    buffer_load_dwordx4 v244, s[12:15], s81 offen offset:256 lds
    s_add_u32 m0, s79, 5888
    s_nop 0
    buffer_load_dwordx4 v245, s[12:15], s81 offen offset:256 lds
    s_add_u32 m0, s79, 6784
    s_nop 0
    buffer_load_dwordx4 v244, s[12:15], s81 offen offset:384 lds
    s_add_u32 m0, s79, 7808
    s_nop 0
    buffer_load_dwordx4 v245, s[12:15], s81 offen offset:384 lds
    s_cmp_eq_u32 s40, 0
    s_cbranch_scc0 skip_8
    s_waitcnt vmcnt(8)
    v_cmp_ne_u32 vcc, 1, v241
    s_cbranch_vccnz ool_9
back_10:
skip_8:
skip_6:
    s_cmp_eq_u32 s43, 1
    s_cbranch_scc0 skip_13
    s_mul_i32 s99, s40, 3584
    s_add_u32 m0, s99, 114688
    v_add_u32 v38, s99, v0
    v_mov_b32 v39, s93
    v_add_co_u32 v38, vcc, s92, v38
    s_nop 1
    v_addc_co_u32 v39, vcc, 0, v39, vcc
    global_load_lds_dwordx4 v[38:39], off offset:0
    global_load_lds_dwordx4 v[38:39], off offset:1024
    global_load_lds_dwordx4 v[38:39], off offset:2048
    s_mov_b32 exec_hi, 0
    global_load_lds_dwordx4 v[38:39], off offset:3072
    s_mov_b64 exec, -1
    s_add_u32 m0, s70, 0x10000
    s_add_u32 s71, s57, 0x2c000
    buffer_load_dwordx4 v0, s[24:27], s71 offen offset:0 sc1 lds
    buffer_load_dwordx4 v0, s[24:27], s71 offen offset:1024 sc1 lds
    buffer_load_dwordx4 v0, s[24:27], s71 offen offset:2048 sc1 lds
    buffer_load_dwordx4 v0, s[24:27], s71 offen offset:3072 sc1 lds
skip_13:
    s_cmp_eq_u32 s43, 0
    s_cbranch_scc0 skip_14
    s_waitcnt vmcnt(8)
    s_barrier
    s_cmp_eq_u32 s40, 0
    s_cbranch_scc0 skip_15
    v_mov_b32 v32, 1
    s_mov_b64 exec, 0xff
    buffer_atomic_add v32, v24, s[24:27], s64 offen sc1
    s_mov_b64 exec, -1
skip_15:
skip_14:
    s_cmp_eq_u32 s43, 1
    s_cbranch_scc0 skip_16
    s_waitcnt vmcnt(10)
    s_waitcnt vmcnt(4)
    s_barrier
    s_cmp_eq_u32 s40, 0
    s_cbranch_scc0 skip_17
    v_mov_b32 v32, 1
    s_add_u32 s99, s66, s3
    s_mov_b64 exec, 1
    s_cmp_eq_u32 s55, 0
    s_cbranch_scc1 ool_18
    buffer_store_dword v32, off, s[24:27], s99 offset:32
back_19:
    s_mov_b64 exec, -1
skip_17:
skip_16:
    ds_read_b128 v[40:43], v252 offset:49152
    ds_read_b128 v[44:47], v252 offset:50176
    ds_read_b128 v[48:51], v252 offset:51200
    ds_read_b128 v[52:55], v252 offset:52224
    ds_read_b128 v[56:59], v252 offset:53248
    ds_read_b128 v[60:63], v252 offset:54272
    ds_read_b128 v[64:67], v252 offset:55296
    ds_read_b128 v[68:71], v252 offset:56320
    ds_read_b128 v[72:75], v252 offset:57344
    ds_read_b128 v[76:79], v252 offset:58368
    ds_read_b128 v[80:83], v252 offset:59392
    ds_read_b128 v[84:87], v252 offset:60416
    ds_read_b128 v[88:91], v252 offset:61440
    ds_read_b128 v[92:95], v252 offset:62464
    s_cmp_eq_u32 s43, 0
    s_cbranch_scc0 skip_20
    s_add_u32 m0, s59, 17408
    s_add_u32 s71, s40, 1
    s_and_b32 s71, s71, 3
    s_lshl_b32 s71, s71, 21
    buffer_load_dwordx4 v244, s[12:15], s71 offen offset:0 lds
    s_add_u32 m0, s59, 18432
    s_nop 0
    buffer_load_dwordx4 v245, s[12:15], s71 offen offset:0 lds
    s_add_u32 m0, s59, 19328
    s_nop 0
    buffer_load_dwordx4 v244, s[12:15], s71 offen offset:128 lds
    s_add_u32 m0, s59, 20352
    s_nop 0
    buffer_load_dwordx4 v245, s[12:15], s71 offen offset:128 lds
    s_add_u32 m0, s59, 21248
    s_nop 0
    buffer_load_dwordx4 v244, s[12:15], s71 offen offset:256 lds
    s_add_u32 m0, s59, 22272
    s_nop 0
    buffer_load_dwordx4 v245, s[12:15], s71 offen offset:256 lds
    s_add_u32 m0, s59, 23168
    s_nop 0
    buffer_load_dwordx4 v244, s[12:15], s71 offen offset:384 lds
    s_add_u32 m0, s59, 24192
    s_nop 0
    buffer_load_dwordx4 v245, s[12:15], s71 offen offset:384 lds
    s_waitcnt vmcnt(8)
    ds_read_b128 v[160:163], v236 offset:0
    ds_read_b128 v[164:167], v237 offset:0
    ds_read_b128 v[168:171], v236 offset:2048
    ds_read_b128 v[172:175], v237 offset:2048
    ds_read_b128 v[176:179], v236 offset:4096
    ds_read_b128 v[180:183], v237 offset:4096
    ds_read_b128 v[184:187], v236 offset:6144
    ds_read_b128 v[188:191], v237 offset:6144
    s_waitcnt lgkmcnt(0)
    s_add_u32 m0, s59, 512
    s_add_u32 s71, s40, 1
    s_and_b32 s71, s71, 3
    s_lshl_b32 s71, s71, 21
    buffer_load_dwordx4 v244, s[12:15], s71 offen offset:512 lds
    s_add_u32 m0, s59, 1536
    s_nop 0
    buffer_load_dwordx4 v245, s[12:15], s71 offen offset:512 lds
    s_add_u32 m0, s59, 2432
    s_nop 0
    buffer_load_dwordx4 v244, s[12:15], s71 offen offset:640 lds
    s_add_u32 m0, s59, 3456
    s_nop 0
    buffer_load_dwordx4 v245, s[12:15], s71 offen offset:640 lds
    s_add_u32 m0, s59, 4352
    s_nop 0
    buffer_load_dwordx4 v244, s[12:15], s71 offen offset:768 lds
    s_add_u32 m0, s59, 5376
    s_nop 0
    buffer_load_dwordx4 v245, s[12:15], s71 offen offset:768 lds
    s_add_u32 m0, s59, 6272
    s_nop 0
    buffer_load_dwordx4 v244, s[12:15], s71 offen offset:896 lds
    s_add_u32 m0, s59, 7296
    s_nop 0
    buffer_load_dwordx4 v245, s[12:15], s71 offen offset:896 lds
    ds_read_b128 v[192:195], v236 offset:8192
    ds_read_b128 v[196:199], v237 offset:8192
    ds_read_b128 v[200:203], v236 offset:10240
    ds_read_b128 v[204:207], v237 offset:10240
    ds_read_b128 v[208:211], v236 offset:12288
    ds_read_b128 v[212:215], v237 offset:12288
    ds_read_b128 v[216:219], v236 offset:14336
    ds_read_b128 v[220:223], v237 offset:14336
    s_waitcnt lgkmcnt(0)
    s_add_u32 m0, s59, 9216
    s_add_u32 s71, s40, 2
    s_and_b32 s71, s71, 3
    s_lshl_b32 s71, s71, 21
    buffer_load_dwordx4 v244, s[12:15], s71 offen offset:0 lds
    s_add_u32 m0, s59, 10240
    s_nop 0
    buffer_load_dwordx4 v245, s[12:15], s71 offen offset:0 lds
    s_add_u32 m0, s59, 11136
    s_nop 0
    buffer_load_dwordx4 v244, s[12:15], s71 offen offset:128 lds
    s_add_u32 m0, s59, 12160
    s_nop 0
    buffer_load_dwordx4 v245, s[12:15], s71 offen offset:128 lds
    s_add_u32 m0, s59, 13056
    s_nop 0
    buffer_load_dwordx4 v244, s[12:15], s71 offen offset:256 lds
    s_add_u32 m0, s59, 14080
    s_nop 0
    buffer_load_dwordx4 v245, s[12:15], s71 offen offset:256 lds
    s_add_u32 m0, s59, 14976
    s_nop 0
    buffer_load_dwordx4 v244, s[12:15], s71 offen offset:384 lds
    s_add_u32 m0, s59, 16000
    s_nop 0
    buffer_load_dwordx4 v245, s[12:15], s71 offen offset:384 lds
    v_perm_b32 v32, v168, v160, s60
    v_accvgpr_write_b32 a0, v32
    v_perm_b32 v33, v168, v160, s61
    v_accvgpr_write_b32 a4, v33
    v_perm_b32 v34, v169, v161, s60
    v_accvgpr_write_b32 a8, v34
    v_perm_b32 v35, v169, v161, s61
    v_accvgpr_write_b32 a12, v35
    v_perm_b32 v36, v170, v162, s60
    v_accvgpr_write_b32 a16, v36
    v_perm_b32 v37, v170, v162, s61
    v_accvgpr_write_b32 a20, v37
    v_perm_b32 v38, v171, v163, s60
    v_accvgpr_write_b32 a24, v38
    v_perm_b32 v39, v171, v163, s61
    v_accvgpr_write_b32 a28, v39
    v_perm_b32 v32, v172, v164, s60
    v_accvgpr_write_b32 a32, v32
    v_perm_b32 v33, v172, v164, s61
    v_accvgpr_write_b32 a36, v33
    v_perm_b32 v34, v173, v165, s60
    v_accvgpr_write_b32 a40, v34
    v_perm_b32 v35, v173, v165, s61
    v_accvgpr_write_b32 a44, v35
    v_perm_b32 v36, v174, v166, s60
    v_accvgpr_write_b32 a48, v36
    v_perm_b32 v37, v174, v166, s61
    v_accvgpr_write_b32 a52, v37
    v_perm_b32 v38, v175, v167, s60
    v_accvgpr_write_b32 a56, v38
    v_perm_b32 v39, v175, v167, s61
    v_accvgpr_write_b32 a60, v39
    v_perm_b32 v32, v184, v176, s60
    v_accvgpr_write_b32 a1, v32
    v_perm_b32 v33, v184, v176, s61
    v_accvgpr_write_b32 a5, v33
    v_perm_b32 v34, v185, v177, s60
    v_accvgpr_write_b32 a9, v34
    v_perm_b32 v35, v185, v177, s61
    v_accvgpr_write_b32 a13, v35
    v_perm_b32 v36, v186, v178, s60
    v_accvgpr_write_b32 a17, v36
    v_perm_b32 v37, v186, v178, s61
    v_accvgpr_write_b32 a21, v37
    v_perm_b32 v38, v187, v179, s60
    v_accvgpr_write_b32 a25, v38
    v_perm_b32 v39, v187, v179, s61
    v_accvgpr_write_b32 a29, v39
    v_perm_b32 v32, v188, v180, s60
    v_accvgpr_write_b32 a33, v32
    v_perm_b32 v33, v188, v180, s61
    v_accvgpr_write_b32 a37, v33
    v_perm_b32 v34, v189, v181, s60
    v_accvgpr_write_b32 a41, v34
    v_perm_b32 v35, v189, v181, s61
    v_accvgpr_write_b32 a45, v35
    v_perm_b32 v36, v190, v182, s60
    v_accvgpr_write_b32 a49, v36
    v_perm_b32 v37, v190, v182, s61
    v_accvgpr_write_b32 a53, v37
    v_perm_b32 v38, v191, v183, s60
    v_accvgpr_write_b32 a57, v38
    v_perm_b32 v39, v191, v183, s61
    v_accvgpr_write_b32 a61, v39
    s_waitcnt vmcnt(16)
    ds_read_b128 v[160:163], v236 offset:16384
    ds_read_b128 v[164:167], v237 offset:16384
    ds_read_b128 v[168:171], v236 offset:18432
    ds_read_b128 v[172:175], v237 offset:18432
    ds_read_b128 v[176:179], v236 offset:20480
    ds_read_b128 v[180:183], v237 offset:20480
    ds_read_b128 v[184:187], v236 offset:22528
    ds_read_b128 v[188:191], v237 offset:22528
    s_waitcnt lgkmcnt(0)
    s_add_u32 m0, s59, 16896
    s_add_u32 s71, s40, 2
    s_and_b32 s71, s71, 3
    s_lshl_b32 s71, s71, 21
    buffer_load_dwordx4 v244, s[12:15], s71 offen offset:512 lds
    s_add_u32 m0, s59, 17920
    s_nop 0
    buffer_load_dwordx4 v245, s[12:15], s71 offen offset:512 lds
    s_add_u32 m0, s59, 18816
    s_nop 0
    buffer_load_dwordx4 v244, s[12:15], s71 offen offset:640 lds
    s_add_u32 m0, s59, 19840
    s_nop 0
    buffer_load_dwordx4 v245, s[12:15], s71 offen offset:640 lds
    s_add_u32 m0, s59, 20736
    s_nop 0
    buffer_load_dwordx4 v244, s[12:15], s71 offen offset:768 lds
    s_add_u32 m0, s59, 21760
    s_nop 0
    buffer_load_dwordx4 v245, s[12:15], s71 offen offset:768 lds
    s_add_u32 m0, s59, 22656
    s_nop 0
    buffer_load_dwordx4 v244, s[12:15], s71 offen offset:896 lds
    s_add_u32 m0, s59, 23680
    s_nop 0
    buffer_load_dwordx4 v245, s[12:15], s71 offen offset:896 lds
    v_perm_b32 v32, v200, v192, s60
    v_accvgpr_write_b32 a2, v32
    v_perm_b32 v33, v200, v192, s61
    v_accvgpr_write_b32 a6, v33
    v_perm_b32 v34, v201, v193, s60
    v_accvgpr_write_b32 a10, v34
    v_perm_b32 v35, v201, v193, s61
    v_accvgpr_write_b32 a14, v35
    v_perm_b32 v36, v202, v194, s60
    v_accvgpr_write_b32 a18, v36
    v_perm_b32 v37, v202, v194, s61
    v_accvgpr_write_b32 a22, v37
    v_perm_b32 v38, v203, v195, s60
    v_accvgpr_write_b32 a26, v38
    v_perm_b32 v39, v203, v195, s61
    v_accvgpr_write_b32 a30, v39
    v_perm_b32 v32, v204, v196, s60
    v_accvgpr_write_b32 a34, v32
    v_perm_b32 v33, v204, v196, s61
    v_accvgpr_write_b32 a38, v33
    v_perm_b32 v34, v205, v197, s60
    v_accvgpr_write_b32 a42, v34
    v_perm_b32 v35, v205, v197, s61
    v_accvgpr_write_b32 a46, v35
    v_perm_b32 v36, v206, v198, s60
    v_accvgpr_write_b32 a50, v36
    v_perm_b32 v37, v206, v198, s61
    v_accvgpr_write_b32 a54, v37
    v_perm_b32 v38, v207, v199, s60
    v_accvgpr_write_b32 a58, v38
    v_perm_b32 v39, v207, v199, s61
    v_accvgpr_write_b32 a62, v39
    v_perm_b32 v32, v216, v208, s60
    v_accvgpr_write_b32 a3, v32
    v_perm_b32 v33, v216, v208, s61
    v_accvgpr_write_b32 a7, v33
    v_perm_b32 v34, v217, v209, s60
    v_accvgpr_write_b32 a11, v34
    v_perm_b32 v35, v217, v209, s61
    v_accvgpr_write_b32 a15, v35
    v_perm_b32 v36, v218, v210, s60
    v_accvgpr_write_b32 a19, v36
    v_perm_b32 v37, v218, v210, s61
    v_accvgpr_write_b32 a23, v37
    v_perm_b32 v38, v219, v211, s60
    v_accvgpr_write_b32 a27, v38
    v_perm_b32 v39, v219, v211, s61
    v_accvgpr_write_b32 a31, v39
    v_perm_b32 v32, v220, v212, s60
    v_accvgpr_write_b32 a35, v32
    v_perm_b32 v33, v220, v212, s61
    v_accvgpr_write_b32 a39, v33
    v_perm_b32 v34, v221, v213, s60
    v_accvgpr_write_b32 a43, v34
    v_perm_b32 v35, v221, v213, s61
    v_accvgpr_write_b32 a47, v35
    v_perm_b32 v36, v222, v214, s60
    v_accvgpr_write_b32 a51, v36
    v_perm_b32 v37, v222, v214, s61
    v_accvgpr_write_b32 a55, v37
    v_perm_b32 v38, v223, v215, s60
    v_accvgpr_write_b32 a59, v38
    v_perm_b32 v39, v223, v215, s61
    v_accvgpr_write_b32 a63, v39
    s_waitcnt vmcnt(16)
    ds_read_b128 v[192:195], v236 offset:0
    ds_read_b128 v[196:199], v237 offset:0
    ds_read_b128 v[200:203], v236 offset:2048
    ds_read_b128 v[204:207], v237 offset:2048
    ds_read_b128 v[208:211], v236 offset:4096
    ds_read_b128 v[212:215], v237 offset:4096
    ds_read_b128 v[216:219], v236 offset:6144
    ds_read_b128 v[220:223], v237 offset:6144
    s_waitcnt lgkmcnt(0)
    s_add_u32 m0, s59, 1024
    s_add_u32 s71, s40, 3
    s_and_b32 s71, s71, 3
    s_lshl_b32 s71, s71, 21
    buffer_load_dwordx4 v244, s[12:15], s71 offen offset:0 lds
    s_add_u32 m0, s59, 2048
    s_nop 0
    buffer_load_dwordx4 v245, s[12:15], s71 offen offset:0 lds
    s_add_u32 m0, s59, 2944
    s_nop 0
    buffer_load_dwordx4 v244, s[12:15], s71 offen offset:128 lds
    s_add_u32 m0, s59, 3968
    s_nop 0
    buffer_load_dwordx4 v245, s[12:15], s71 offen offset:128 lds
    s_add_u32 m0, s59, 4864
    s_nop 0
    buffer_load_dwordx4 v244, s[12:15], s71 offen offset:256 lds
    s_add_u32 m0, s59, 5888
    s_nop 0
    buffer_load_dwordx4 v245, s[12:15], s71 offen offset:256 lds
    s_add_u32 m0, s59, 6784
    s_nop 0
    buffer_load_dwordx4 v244, s[12:15], s71 offen offset:384 lds
    s_add_u32 m0, s59, 7808
    s_nop 0
    buffer_load_dwordx4 v245, s[12:15], s71 offen offset:384 lds
    v_perm_b32 v32, v168, v160, s60
    v_accvgpr_write_b32 a64, v32
    v_perm_b32 v33, v168, v160, s61
    v_accvgpr_write_b32 a68, v33
    v_perm_b32 v34, v169, v161, s60
    v_accvgpr_write_b32 a72, v34
    v_perm_b32 v35, v169, v161, s61
    v_accvgpr_write_b32 a76, v35
    v_perm_b32 v36, v170, v162, s60
    v_accvgpr_write_b32 a80, v36
    v_perm_b32 v37, v170, v162, s61
    v_accvgpr_write_b32 a84, v37
    v_perm_b32 v38, v171, v163, s60
    v_accvgpr_write_b32 a88, v38
    v_perm_b32 v39, v171, v163, s61
    v_accvgpr_write_b32 a92, v39
    v_perm_b32 v32, v172, v164, s60
    v_accvgpr_write_b32 a96, v32
    v_perm_b32 v33, v172, v164, s61
    v_accvgpr_write_b32 a100, v33
    v_perm_b32 v34, v173, v165, s60
    v_accvgpr_write_b32 a104, v34
    v_perm_b32 v35, v173, v165, s61
    v_accvgpr_write_b32 a108, v35
    v_perm_b32 v36, v174, v166, s60
    v_accvgpr_write_b32 a112, v36
    v_perm_b32 v37, v174, v166, s61
    v_accvgpr_write_b32 a116, v37
    v_perm_b32 v38, v175, v167, s60
    v_accvgpr_write_b32 a120, v38
    v_perm_b32 v39, v175, v167, s61
    v_accvgpr_write_b32 a124, v39
    v_perm_b32 v32, v184, v176, s60
    v_accvgpr_write_b32 a65, v32
    v_perm_b32 v33, v184, v176, s61
    v_accvgpr_write_b32 a69, v33
    v_perm_b32 v34, v185, v177, s60
    v_accvgpr_write_b32 a73, v34
    v_perm_b32 v35, v185, v177, s61
    v_accvgpr_write_b32 a77, v35
    v_perm_b32 v36, v186, v178, s60
    v_accvgpr_write_b32 a81, v36
    v_perm_b32 v37, v186, v178, s61
    v_accvgpr_write_b32 a85, v37
    v_perm_b32 v38, v187, v179, s60
    v_accvgpr_write_b32 a89, v38
    v_perm_b32 v39, v187, v179, s61
    v_accvgpr_write_b32 a93, v39
    v_perm_b32 v32, v188, v180, s60
    v_accvgpr_write_b32 a97, v32
    v_perm_b32 v33, v188, v180, s61
    v_accvgpr_write_b32 a101, v33
    v_perm_b32 v34, v189, v181, s60
    v_accvgpr_write_b32 a105, v34
    v_perm_b32 v35, v189, v181, s61
    v_accvgpr_write_b32 a109, v35
    v_perm_b32 v36, v190, v182, s60
    v_accvgpr_write_b32 a113, v36
    v_perm_b32 v37, v190, v182, s61
    v_accvgpr_write_b32 a117, v37
    v_perm_b32 v38, v191, v183, s60
    v_accvgpr_write_b32 a121, v38
    v_perm_b32 v39, v191, v183, s61
    v_accvgpr_write_b32 a125, v39
    s_waitcnt vmcnt(16)
    ds_read_b128 v[160:163], v236 offset:8192
    ds_read_b128 v[164:167], v237 offset:8192
    ds_read_b128 v[168:171], v236 offset:10240
    ds_read_b128 v[172:175], v237 offset:10240
    ds_read_b128 v[176:179], v236 offset:12288
    ds_read_b128 v[180:183], v237 offset:12288
    ds_read_b128 v[184:187], v236 offset:14336
    ds_read_b128 v[188:191], v237 offset:14336
    s_cmp_eq_u32 s40, 0
    s_cbranch_scc0 skip_21
    buffer_load_dword v241, v23, s[24:27], s65 offen sc1
skip_21:
    s_waitcnt lgkmcnt(0)
    s_add_u32 m0, s59, 8704
    s_add_u32 s71, s40, 3
    s_and_b32 s71, s71, 3
    s_lshl_b32 s71, s71, 21
    buffer_load_dwordx4 v244, s[12:15], s71 offen offset:512 lds
    s_add_u32 m0, s59, 9728
    s_nop 0
    buffer_load_dwordx4 v245, s[12:15], s71 offen offset:512 lds
    s_add_u32 m0, s59, 10624
    s_nop 0
    buffer_load_dwordx4 v244, s[12:15], s71 offen offset:640 lds
    s_add_u32 m0, s59, 11648
    s_nop 0
    buffer_load_dwordx4 v245, s[12:15], s71 offen offset:640 lds
    s_add_u32 m0, s59, 12544
    s_nop 0
    buffer_load_dwordx4 v244, s[12:15], s71 offen offset:768 lds
    s_add_u32 m0, s59, 13568
    s_nop 0
    buffer_load_dwordx4 v245, s[12:15], s71 offen offset:768 lds
    s_add_u32 m0, s59, 14464
    s_nop 0
    buffer_load_dwordx4 v244, s[12:15], s71 offen offset:896 lds
    s_add_u32 m0, s59, 15488
    s_nop 0
    buffer_load_dwordx4 v245, s[12:15], s71 offen offset:896 lds
    v_perm_b32 v32, v200, v192, s60
    v_accvgpr_write_b32 a66, v32
    v_perm_b32 v33, v200, v192, s61
    v_accvgpr_write_b32 a70, v33
    v_perm_b32 v34, v201, v193, s60
    v_accvgpr_write_b32 a74, v34
    v_perm_b32 v35, v201, v193, s61
    v_accvgpr_write_b32 a78, v35
    v_perm_b32 v36, v202, v194, s60
    v_accvgpr_write_b32 a82, v36
    v_perm_b32 v37, v202, v194, s61
    v_accvgpr_write_b32 a86, v37
    v_perm_b32 v38, v203, v195, s60
    v_accvgpr_write_b32 a90, v38
    v_perm_b32 v39, v203, v195, s61
    v_accvgpr_write_b32 a94, v39
    v_perm_b32 v32, v204, v196, s60
    v_accvgpr_write_b32 a98, v32
    v_perm_b32 v33, v204, v196, s61
    v_accvgpr_write_b32 a102, v33
    v_perm_b32 v34, v205, v197, s60
    v_accvgpr_write_b32 a106, v34
    v_perm_b32 v35, v205, v197, s61
    v_accvgpr_write_b32 a110, v35
    v_perm_b32 v36, v206, v198, s60
    v_accvgpr_write_b32 a114, v36
    v_perm_b32 v37, v206, v198, s61
    v_accvgpr_write_b32 a118, v37
    v_perm_b32 v38, v207, v199, s60
    v_accvgpr_write_b32 a122, v38
    v_perm_b32 v39, v207, v199, s61
    v_accvgpr_write_b32 a126, v39
    v_perm_b32 v32, v216, v208, s60
    v_accvgpr_write_b32 a67, v32
    v_perm_b32 v33, v216, v208, s61
    v_accvgpr_write_b32 a71, v33
    v_perm_b32 v34, v217, v209, s60
    v_accvgpr_write_b32 a75, v34
    v_perm_b32 v35, v217, v209, s61
    v_accvgpr_write_b32 a79, v35
    v_perm_b32 v36, v218, v210, s60
    v_accvgpr_write_b32 a83, v36
    v_perm_b32 v37, v218, v210, s61
    v_accvgpr_write_b32 a87, v37
    v_perm_b32 v38, v219, v211, s60
    v_accvgpr_write_b32 a91, v38
    v_perm_b32 v39, v219, v211, s61
    v_accvgpr_write_b32 a95, v39
    v_perm_b32 v32, v220, v212, s60
    v_accvgpr_write_b32 a99, v32
    v_perm_b32 v33, v220, v212, s61
    v_accvgpr_write_b32 a103, v33
    v_perm_b32 v34, v221, v213, s60
    v_accvgpr_write_b32 a107, v34
    v_perm_b32 v35, v221, v213, s61
    v_accvgpr_write_b32 a111, v35
    v_perm_b32 v36, v222, v214, s60
    v_accvgpr_write_b32 a115, v36
    v_perm_b32 v37, v222, v214, s61
    v_accvgpr_write_b32 a119, v37
    v_perm_b32 v38, v223, v215, s60
    v_accvgpr_write_b32 a123, v38
    v_perm_b32 v39, v223, v215, s61
    v_accvgpr_write_b32 a127, v39
    s_cmp_eq_u32 s40, 0
    s_cbranch_scc0 skip_22
    s_waitcnt vmcnt(8)
    v_cmp_ne_u32 vcc, 16, v241
    s_cbranch_vccnz ool_23
back_24:
skip_22:
    s_and_b32 s99, s60, 2
    s_lshl_b32 s99, s99, 9
    v_add_u32 v23, s99, v0
    v_xor_b32 v251, 0x400, v23
    s_add_u32 s94, s99, s70
    s_xor_b32 s95, s94, 0x400
    s_barrier
skip_20:
    s_add_u32 s76, s46, 0x0
    s_add_u32 s77, s46, 0x1000
    s_add_u32 s78, s46, 0x8000
    s_add_u32 s79, s46, 0x9000
    s_cmp_eq_u32 s43, 1
    s_cbranch_scc0 skip_27
    s_add_u32 m0, s70, 0x14000
    s_add_u32 s71, s57, 0x30000
    buffer_load_dwordx4 v0, s[24:27], s71 offen offset:0 sc1 lds
    buffer_load_dwordx4 v0, s[24:27], s71 offen offset:1024 sc1 lds
    buffer_load_dwordx4 v0, s[24:27], s71 offen offset:2048 sc1 lds
    buffer_load_dwordx4 v0, s[24:27], s71 offen offset:3072 sc1 lds
    s_add_u32 m0, s70, 0x18000
    s_add_u32 s71, s57, 0x34000
    buffer_load_dwordx4 v0, s[24:27], s71 offen offset:0 sc1 lds
    buffer_load_dwordx4 v0, s[24:27], s71 offen offset:1024 sc1 lds
    buffer_load_dwordx4 v0, s[24:27], s71 offen offset:2048 sc1 lds
    buffer_load_dwordx4 v0, s[24:27], s71 offen offset:3072 sc1 lds
    buffer_load_dword v248, v254, s[24:27], s66 offen offset:32 sc1
skip_27:
L_k2:
    buffer_load_dwordx4 v[96:99], v4, s[36:39], s76 offen offset:0 sc1
    buffer_load_dwordx4 v[100:103], v4, s[36:39], s76 offen offset:2048 sc1
    buffer_load_dwordx4 v[104:107], v4, s[36:39], s77 offen offset:0 sc1
    buffer_load_dwordx4 v[108:111], v4, s[36:39], s77 offen offset:2048 sc1
    s_cmp_eq_u32 s43, 0
    s_cbranch_scc0 skip_28
    s_waitcnt vmcnt(20)
    ds_read_b128 v[192:195], v236 offset:16384
    ds_read_b128 v[196:199], v237 offset:16384
    ds_read_b128 v[200:203], v236 offset:18432
    ds_read_b128 v[204:207], v237 offset:18432
    ds_read_b128 v[208:211], v236 offset:20480
    ds_read_b128 v[212:215], v237 offset:20480
    ds_read_b128 v[216:219], v236 offset:22528
    ds_read_b128 v[220:223], v237 offset:22528
    v_perm_b32 v32, v168, v160, s60
    v_accvgpr_write_b32 a128, v32
    v_perm_b32 v33, v168, v160, s61
    v_accvgpr_write_b32 a132, v33
    v_perm_b32 v34, v169, v161, s60
    v_accvgpr_write_b32 a136, v34
    v_perm_b32 v35, v169, v161, s61
    v_accvgpr_write_b32 a140, v35
    v_perm_b32 v36, v170, v162, s60
    v_accvgpr_write_b32 a144, v36
    v_perm_b32 v37, v170, v162, s61
    v_accvgpr_write_b32 a148, v37
    v_perm_b32 v38, v171, v163, s60
    v_accvgpr_write_b32 a152, v38
    v_perm_b32 v39, v171, v163, s61
    v_accvgpr_write_b32 a156, v39
    v_perm_b32 v32, v172, v164, s60
    v_accvgpr_write_b32 a160, v32
    v_perm_b32 v33, v172, v164, s61
    v_accvgpr_write_b32 a164, v33
    v_perm_b32 v34, v173, v165, s60
    v_accvgpr_write_b32 a168, v34
    v_perm_b32 v35, v173, v165, s61
    v_accvgpr_write_b32 a172, v35
    v_perm_b32 v36, v174, v166, s60
    v_accvgpr_write_b32 a176, v36
    v_perm_b32 v37, v174, v166, s61
    v_accvgpr_write_b32 a180, v37
    v_perm_b32 v38, v175, v167, s60
    v_accvgpr_write_b32 a184, v38
    v_perm_b32 v39, v175, v167, s61
    v_accvgpr_write_b32 a188, v39
    v_perm_b32 v32, v184, v176, s60
    v_accvgpr_write_b32 a129, v32
    v_perm_b32 v33, v184, v176, s61
    v_accvgpr_write_b32 a133, v33
    v_perm_b32 v34, v185, v177, s60
    v_accvgpr_write_b32 a137, v34
    v_perm_b32 v35, v185, v177, s61
    v_accvgpr_write_b32 a141, v35
    v_perm_b32 v36, v186, v178, s60
    v_accvgpr_write_b32 a145, v36
    v_perm_b32 v37, v186, v178, s61
    v_accvgpr_write_b32 a149, v37
    v_perm_b32 v38, v187, v179, s60
    v_accvgpr_write_b32 a153, v38
    v_perm_b32 v39, v187, v179, s61
    v_accvgpr_write_b32 a157, v39
    v_perm_b32 v32, v188, v180, s60
    v_accvgpr_write_b32 a161, v32
    v_perm_b32 v33, v188, v180, s61
    v_accvgpr_write_b32 a165, v33
    v_perm_b32 v34, v189, v181, s60
    v_accvgpr_write_b32 a169, v34
    v_perm_b32 v35, v189, v181, s61
    v_accvgpr_write_b32 a173, v35
    v_perm_b32 v36, v190, v182, s60
    v_accvgpr_write_b32 a177, v36
    v_perm_b32 v37, v190, v182, s61
    v_accvgpr_write_b32 a181, v37
    v_perm_b32 v38, v191, v183, s60
    v_accvgpr_write_b32 a185, v38
    v_perm_b32 v39, v191, v183, s61
    v_accvgpr_write_b32 a189, v39
skip_28:
    buffer_load_dwordx4 v[112:115], v4, s[36:39], s78 offen offset:0 sc1
    buffer_load_dwordx4 v[116:119], v4, s[36:39], s78 offen offset:2048 sc1
    buffer_load_dwordx4 v[120:123], v4, s[36:39], s79 offen offset:0 sc1
    buffer_load_dwordx4 v[124:127], v4, s[36:39], s79 offen offset:2048 sc1
    s_cmp_eq_u32 s43, 0
    s_cbranch_scc0 skip_29
    s_waitcnt vmcnt(16)
    ds_read_b128 a[192:195], v236 offset:0
    ds_read_b128 a[224:227], v237 offset:0
    ds_read_b128 a[196:199], v236 offset:2048
    ds_read_b128 a[228:231], v237 offset:2048
    ds_read_b128 a[200:203], v236 offset:4096
    ds_read_b128 a[232:235], v237 offset:4096
    ds_read_b128 a[204:207], v236 offset:6144
    ds_read_b128 a[236:239], v237 offset:6144
    s_waitcnt lgkmcnt(13)
    v_perm_b32 v32, v200, v192, s60
    v_accvgpr_write_b32 a130, v32
    v_perm_b32 v33, v200, v192, s61
    v_accvgpr_write_b32 a134, v33
    v_perm_b32 v34, v201, v193, s60
    v_accvgpr_write_b32 a138, v34
    v_perm_b32 v35, v201, v193, s61
    v_accvgpr_write_b32 a142, v35
    v_perm_b32 v36, v202, v194, s60
    v_accvgpr_write_b32 a146, v36
    v_perm_b32 v37, v202, v194, s61
    v_accvgpr_write_b32 a150, v37
    v_perm_b32 v38, v203, v195, s60
    v_accvgpr_write_b32 a154, v38
    v_perm_b32 v39, v203, v195, s61
    v_accvgpr_write_b32 a158, v39
    s_waitcnt lgkmcnt(12)
    v_perm_b32 v32, v204, v196, s60
    v_accvgpr_write_b32 a162, v32
    v_perm_b32 v33, v204, v196, s61
    v_accvgpr_write_b32 a166, v33
    v_perm_b32 v34, v205, v197, s60
    v_accvgpr_write_b32 a170, v34
    v_perm_b32 v35, v205, v197, s61
    v_accvgpr_write_b32 a174, v35
    v_perm_b32 v36, v206, v198, s60
    v_accvgpr_write_b32 a178, v36
    v_perm_b32 v37, v206, v198, s61
    v_accvgpr_write_b32 a182, v37
    v_perm_b32 v38, v207, v199, s60
    v_accvgpr_write_b32 a186, v38
    v_perm_b32 v39, v207, v199, s61
    v_accvgpr_write_b32 a190, v39
    s_waitcnt lgkmcnt(9)
    v_perm_b32 v32, v216, v208, s60
    v_accvgpr_write_b32 a131, v32
    v_perm_b32 v33, v216, v208, s61
    v_accvgpr_write_b32 a135, v33
    v_perm_b32 v34, v217, v209, s60
    v_accvgpr_write_b32 a139, v34
    v_perm_b32 v35, v217, v209, s61
    v_accvgpr_write_b32 a143, v35
    v_perm_b32 v36, v218, v210, s60
    v_accvgpr_write_b32 a147, v36
    v_perm_b32 v37, v218, v210, s61
    v_accvgpr_write_b32 a151, v37
    v_perm_b32 v38, v219, v211, s60
    v_accvgpr_write_b32 a155, v38
    v_perm_b32 v39, v219, v211, s61
    v_accvgpr_write_b32 a159, v39
    s_waitcnt lgkmcnt(8)
    v_perm_b32 v32, v220, v212, s60
    v_accvgpr_write_b32 a163, v32
    v_perm_b32 v33, v220, v212, s61
    v_accvgpr_write_b32 a167, v33
    v_perm_b32 v34, v221, v213, s60
    v_accvgpr_write_b32 a171, v34
    v_perm_b32 v35, v221, v213, s61
    v_accvgpr_write_b32 a175, v35
    v_perm_b32 v36, v222, v214, s60
    v_accvgpr_write_b32 a179, v36
    v_perm_b32 v37, v222, v214, s61
    v_accvgpr_write_b32 a183, v37
    v_perm_b32 v38, v223, v215, s60
    v_accvgpr_write_b32 a187, v38
    v_perm_b32 v39, v223, v215, s61
    v_accvgpr_write_b32 a191, v39
skip_29:
    buffer_load_dwordx4 v[128:131], v4, s[36:39], s76 offen offset:256 sc1
    buffer_load_dwordx4 v[132:135], v4, s[36:39], s76 offen offset:2304 sc1
    buffer_load_dwordx4 v[136:139], v4, s[36:39], s77 offen offset:256 sc1
    buffer_load_dwordx4 v[140:143], v4, s[36:39], s77 offen offset:2304 sc1
    s_cmp_eq_u32 s43, 0
    s_cbranch_scc0 skip_30
    s_waitcnt vmcnt(12)
    ds_read_b128 a[208:211], v236 offset:8192
    ds_read_b128 a[240:243], v237 offset:8192
    ds_read_b128 a[212:215], v236 offset:10240
    ds_read_b128 a[244:247], v237 offset:10240
    ds_read_b128 a[216:219], v236 offset:12288
    ds_read_b128 a[248:251], v237 offset:12288
    ds_read_b128 a[220:223], v236 offset:14336
    ds_read_b128 a[252:255], v237 offset:14336
skip_30:
    buffer_load_dwordx4 v[144:147], v4, s[36:39], s78 offen offset:256 sc1
    buffer_load_dwordx4 v[148:151], v4, s[36:39], s78 offen offset:2304 sc1
    buffer_load_dwordx4 v[152:155], v4, s[36:39], s79 offen offset:256 sc1
    buffer_load_dwordx4 v[156:159], v4, s[36:39], s79 offen offset:2304 sc1
    s_cmp_eq_u32 s43, 1
    s_cbranch_scc0 skip_31
    s_waitcnt vmcnt(16)
    v_cmp_ne_u32 vcc, 1, v248
    s_cbranch_vccnz ool_32
back_33:
skip_31:
    buffer_load_dwordx4 v[224:227], v3, s[4:7], s50 offen sc1
    buffer_load_dwordx4 v[228:231], v3, s[4:7], s49 offen sc1
    s_cmp_eq_u32 s43, 0
    s_cbranch_scc0 skip_36
    buffer_load_dword v248, v254, s[24:27], s66 offen offset:128 sc1
    s_waitcnt lgkmcnt(0)
    s_barrier
skip_36:
    s_waitcnt vmcnt(15)
    v_max3_u32 v32, v99, v103, v107
    s_waitcnt vmcnt(14)
    v_max_u32 v32, v32, v111
    v_cmp_eq_u32 vcc, -1, v32
    s_cbranch_vccnz ool_37
back_38:
    v_swap_b32 v97, v100
    v_swap_b32 v98, v104
    v_swap_b32 v99, v108
    v_swap_b32 v102, v105
    v_swap_b32 v103, v109
    v_swap_b32 v107, v110
    v_mfma_f32_16x16x32_bf16 v[160:163], v[96:99], v[8:11], 0
    v_mfma_f32_16x16x32_bf16 v[164:167], v[100:103], v[8:11], 0
    v_mfma_f32_16x16x32_bf16 v[168:171], v[104:107], v[8:11], 0
    v_mfma_f32_16x16x32_bf16 v[172:175], v[108:111], v[8:11], 0
    s_waitcnt vmcnt(11)
    v_max3_u32 v32, v115, v119, v123
    s_waitcnt vmcnt(10)
    v_max_u32 v32, v32, v127
    v_cmp_eq_u32 vcc, -1, v32
    s_cbranch_vccnz ool_41
back_42:
    v_swap_b32 v113, v116
    v_swap_b32 v114, v120
    v_swap_b32 v115, v124
    v_swap_b32 v118, v121
    v_swap_b32 v119, v125
    v_swap_b32 v123, v126
    v_mfma_f32_16x16x32_bf16 v[160:163], v[112:115], v[12:15], v[160:163]
    v_mfma_f32_16x16x32_bf16 v[164:167], v[116:119], v[12:15], v[164:167]
    v_mfma_f32_16x16x32_bf16 v[168:171], v[120:123], v[12:15], v[168:171]
    v_mfma_f32_16x16x32_bf16 v[172:175], v[124:127], v[12:15], v[172:175]
    s_waitcnt vmcnt(7)
    v_max3_u32 v32, v131, v135, v139
    s_waitcnt vmcnt(6)
    v_max_u32 v32, v32, v143
    v_cmp_eq_u32 vcc, -1, v32
    s_cbranch_vccnz ool_45
back_46:
    v_swap_b32 v129, v132
    v_swap_b32 v130, v136
    v_swap_b32 v131, v140
    v_swap_b32 v134, v137
    v_swap_b32 v135, v141
    v_swap_b32 v139, v142
    v_mfma_f32_16x16x32_bf16 v[176:179], v[128:131], v[8:11], 0
    v_mfma_f32_16x16x32_bf16 v[180:183], v[132:135], v[8:11], 0
    v_mfma_f32_16x16x32_bf16 v[184:187], v[136:139], v[8:11], 0
    v_mfma_f32_16x16x32_bf16 v[188:191], v[140:143], v[8:11], 0
    v_cvt_pk_bf16_f32 v192, v160, v164
    v_cvt_pk_bf16_f32 v193, v168, v172
    v_cvt_pk_bf16_f32 v194, v161, v165
    v_cvt_pk_bf16_f32 v195, v169, v173
    ds_write_b128 v18, v[192:195] offset:0
    v_cvt_pk_bf16_f32 v196, v162, v166
    v_cvt_pk_bf16_f32 v197, v170, v174
    v_cvt_pk_bf16_f32 v198, v163, v167
    v_cvt_pk_bf16_f32 v199, v171, v175
    ds_write_b128 v18, v[196:199] offset:16
    s_waitcnt vmcnt(3)
    v_max3_u32 v32, v147, v151, v155
    s_waitcnt vmcnt(2)
    v_max_u32 v32, v32, v159
    v_cmp_eq_u32 vcc, -1, v32
    s_cbranch_vccnz ool_49
back_50:
    v_swap_b32 v145, v148
    v_swap_b32 v146, v152
    v_swap_b32 v147, v156
    v_swap_b32 v150, v153
    v_swap_b32 v151, v157
    v_swap_b32 v155, v158
    v_mfma_f32_16x16x32_bf16 v[176:179], v[144:147], v[12:15], v[176:179]
    v_mfma_f32_16x16x32_bf16 v[180:183], v[148:151], v[12:15], v[180:183]
    v_mfma_f32_16x16x32_bf16 v[184:187], v[152:155], v[12:15], v[184:187]
    v_mfma_f32_16x16x32_bf16 v[188:191], v[156:159], v[12:15], v[188:191]
    s_add_u32 m0, s70, 0x0
    s_add_u32 s71, s57, 0x1c000
    buffer_load_dwordx4 v0, s[24:27], s71 offen offset:0 sc1 lds
    buffer_load_dwordx4 v0, s[24:27], s71 offen offset:1024 sc1 lds
    buffer_load_dwordx4 v0, s[24:27], s71 offen offset:2048 sc1 lds
    buffer_load_dwordx4 v0, s[24:27], s71 offen offset:3072 sc1 lds
    v_cvt_pk_bf16_f32 v200, v176, v180
    s_nop 0
    v_cvt_pk_bf16_f32 v201, v184, v188
    v_cvt_pk_bf16_f32 v202, v177, v181
    v_cvt_pk_bf16_f32 v203, v185, v189
    ds_write_b128 v18, v[200:203] offset:128
    v_cvt_pk_bf16_f32 v204, v178, v182
    v_cvt_pk_bf16_f32 v205, v186, v190
    v_cvt_pk_bf16_f32 v206, v179, v183
    v_cvt_pk_bf16_f32 v207, v187, v191
    ds_write_b128 v18, v[204:207] offset:144
    s_waitcnt vmcnt(5)
    ds_write_b128 v246, v[224:227] offset:16640
    s_waitcnt vmcnt(4)
    ds_write_b128 v247, v[228:231] offset:16640
    s_waitcnt lgkmcnt(0)
    s_barrier
    s_cmp_eq_u32 s43, 0
    s_cbranch_scc0 skip_53
    v_mov_b32 v176, -1
    v_mov_b32 v177, -1
    v_mov_b32 v178, -1
    v_mov_b32 v179, -1
    s_add_u32 s99, s45, 0x1000000
    buffer_store_dwordx4 v[176:179], v5, s[36:39], s99 offen sc1
    s_add_u32 s99, s45, 0x1010000
    buffer_store_dwordx4 v[176:179], v5, s[36:39], s99 offen sc1
skip_53:
    ds_read_b64_tr_b16 v[96:97], v19 offset:0
    ds_read_b64_tr_b16 v[98:99], v19 offset:128
    ds_read_b64_tr_b16 v[100:101], v19 offset:512
    ds_read_b64_tr_b16 v[102:103], v19 offset:640
    ds_read_b64_tr_b16 v[104:105], v19 offset:8320
    ds_read_b64_tr_b16 v[106:107], v19 offset:8448
    ds_read_b64_tr_b16 v[108:109], v19 offset:8832
    ds_read_b64_tr_b16 v[110:111], v19 offset:8960
    ds_read_b128 v[224:227], v1 offset:16640
    ds_read_b128 v[228:231], v1 offset:21248
    s_add_u32 m0, s70, 0x4000
    s_add_u32 s71, s57, 0x20000
    buffer_load_dwordx4 v0, s[24:27], s71 offen offset:0 sc1 lds
    buffer_load_dwordx4 v0, s[24:27], s71 offen offset:1024 sc1 lds
    buffer_load_dwordx4 v0, s[24:27], s71 offen offset:2048 sc1 lds
    buffer_load_dwordx4 v0, s[24:27], s71 offen offset:3072 sc1 lds
    s_waitcnt lgkmcnt(8)
    v_mfma_f32_32x32x16_bf16 v[112:127], v[96:99], v[40:43], 0
    v_mfma_f32_32x32x16_bf16 v[128:143], v[96:99], v[56:59], 0
    s_waitcnt lgkmcnt(6)
    v_mfma_f32_32x32x16_bf16 v[112:127], v[100:103], v[44:47], v[112:127]
    v_mfma_f32_32x32x16_bf16 v[128:143], v[100:103], v[60:63], v[128:143]
    s_waitcnt lgkmcnt(4)
    v_mfma_f32_32x32x16_bf16 v[112:127], v[104:107], v[48:51], v[112:127]
    v_mfma_f32_32x32x16_bf16 v[128:143], v[104:107], v[40:43], v[128:143]
    s_waitcnt lgkmcnt(2)
    v_mfma_f32_32x32x16_bf16 v[112:127], v[108:111], v[52:55], v[112:127]
    v_mfma_f32_32x32x16_bf16 v[128:143], v[108:111], v[44:47], v[128:143]
    s_waitcnt lgkmcnt(1)
    v_lshlrev_b32 v208, 16, v224
    v_and_b32 v209, 0xffff0000, v224
    v_lshlrev_b32 v210, 16, v225
    v_and_b32 v211, 0xffff0000, v225
    v_lshlrev_b32 v212, 16, v226
    v_and_b32 v213, 0xffff0000, v226
    v_lshlrev_b32 v214, 16, v227
    v_and_b32 v215, 0xffff0000, v227
    s_waitcnt lgkmcnt(0)
    v_lshlrev_b32 v216, 16, v228
    v_and_b32 v217, 0xffff0000, v228
    v_lshlrev_b32 v218, 16, v229
    v_and_b32 v219, 0xffff0000, v229
    v_lshlrev_b32 v220, 16, v230
    v_and_b32 v221, 0xffff0000, v230
    v_lshlrev_b32 v222, 16, v231
    v_and_b32 v223, 0xffff0000, v231
    s_add_u32 m0, s70, 0x8000
    s_add_u32 s71, s57, 0x24000
    buffer_load_dwordx4 v0, s[24:27], s71 offen offset:0 sc1 lds
    buffer_load_dwordx4 v0, s[24:27], s71 offen offset:1024 sc1 lds
    buffer_load_dwordx4 v0, s[24:27], s71 offen offset:2048 sc1 lds
    buffer_load_dwordx4 v0, s[24:27], s71 offen offset:3072 sc1 lds
    v_pk_mul_f32 v[144:145], v[128:129], v[72:73]
    v_pk_mul_f32 v[152:153], v[112:113], v[72:73]
    v_pk_mul_f32 v[146:147], v[130:131], v[74:75]
    v_pk_mul_f32 v[154:155], v[114:115], v[74:75]
    v_pk_mul_f32 v[148:149], v[132:133], v[76:77]
    v_pk_mul_f32 v[156:157], v[116:117], v[76:77]
    v_pk_mul_f32 v[150:151], v[134:135], v[78:79]
    v_pk_mul_f32 v[158:159], v[118:119], v[78:79]
    v_pk_fma_f32 v[144:145], v[112:113], v[64:65], v[144:145]
    v_pk_fma_f32 v[152:153], v[128:129], v[64:65], v[152:153] neg_lo:[0,0,1] neg_hi:[0,0,1]
    v_pk_fma_f32 v[146:147], v[114:115], v[66:67], v[146:147]
    v_pk_fma_f32 v[154:155], v[130:131], v[66:67], v[154:155] neg_lo:[0,0,1] neg_hi:[0,0,1]
    v_pk_fma_f32 v[148:149], v[116:117], v[68:69], v[148:149]
    v_pk_fma_f32 v[156:157], v[132:133], v[68:69], v[156:157] neg_lo:[0,0,1] neg_hi:[0,0,1]
    v_pk_fma_f32 v[150:151], v[118:119], v[70:71], v[150:151]
    v_pk_fma_f32 v[158:159], v[134:135], v[70:71], v[158:159] neg_lo:[0,0,1] neg_hi:[0,0,1]
    v_cvt_pk_bf16_f32 v160, v144, v145
    v_cvt_pk_bf16_f32 v161, v146, v147
    v_cvt_pk_bf16_f32 v162, v148, v149
    v_cvt_pk_bf16_f32 v163, v150, v151
    v_cvt_pk_bf16_f32 v164, v152, v153
    v_cvt_pk_bf16_f32 v165, v154, v155
    v_cvt_pk_bf16_f32 v166, v156, v157
    v_cvt_pk_bf16_f32 v167, v158, v159
    v_pk_mul_f32 v[144:145], v[136:137], v[72:73]
    v_pk_mul_f32 v[152:153], v[120:121], v[72:73]
    v_pk_mul_f32 v[146:147], v[138:139], v[74:75]
    v_pk_mul_f32 v[154:155], v[122:123], v[74:75]
    v_pk_mul_f32 v[148:149], v[140:141], v[76:77]
    v_pk_mul_f32 v[156:157], v[124:125], v[76:77]
    v_pk_mul_f32 v[150:151], v[142:143], v[78:79]
    v_pk_mul_f32 v[158:159], v[126:127], v[78:79]
    v_pk_fma_f32 v[144:145], v[120:121], v[64:65], v[144:145]
    v_pk_fma_f32 v[152:153], v[136:137], v[64:65], v[152:153] neg_lo:[0,0,1] neg_hi:[0,0,1]
    v_pk_fma_f32 v[146:147], v[122:123], v[66:67], v[146:147]
    v_pk_fma_f32 v[154:155], v[138:139], v[66:67], v[154:155] neg_lo:[0,0,1] neg_hi:[0,0,1]
    v_pk_fma_f32 v[148:149], v[124:125], v[68:69], v[148:149]
    v_pk_fma_f32 v[156:157], v[140:141], v[68:69], v[156:157] neg_lo:[0,0,1] neg_hi:[0,0,1]
    v_pk_fma_f32 v[150:151], v[126:127], v[70:71], v[150:151]
    v_pk_fma_f32 v[158:159], v[142:143], v[70:71], v[158:159] neg_lo:[0,0,1] neg_hi:[0,0,1]
    v_cvt_pk_bf16_f32 v168, v144, v145
    v_cvt_pk_bf16_f32 v169, v146, v147
    v_cvt_pk_bf16_f32 v170, v148, v149
    v_cvt_pk_bf16_f32 v171, v150, v151
    v_cvt_pk_bf16_f32 v172, v152, v153
    v_cvt_pk_bf16_f32 v173, v154, v155
    v_cvt_pk_bf16_f32 v174, v156, v157
    v_cvt_pk_bf16_f32 v175, v158, v159
    v_mfma_f32_32x32x16_bf16 v[208:223], v[160:163], v[80:83], v[208:223]
    v_mfma_f32_32x32x16_bf16 v[208:223], v[164:167], v[84:87], v[208:223]
    v_mfma_f32_32x32x16_bf16 v[208:223], v[168:171], v[88:91], v[208:223]
    v_mfma_f32_32x32x16_bf16 v[208:223], v[172:175], v[92:95], v[208:223]
    s_add_u32 m0, s70, 0xc000
    s_add_u32 s71, s57, 0x28000
    buffer_load_dwordx4 v0, s[24:27], s71 offen offset:0 sc1 lds
    buffer_load_dwordx4 v0, s[24:27], s71 offen offset:1024 sc1 lds
    buffer_load_dwordx4 v0, s[24:27], s71 offen offset:2048 sc1 lds
    buffer_load_dwordx4 v0, s[24:27], s71 offen offset:3072 sc1 lds
    s_cmp_eq_u32 s43, 0
    s_cbranch_scc0 skip_54
    s_waitcnt vmcnt(18)
    v_cmp_ne_u32 vcc, s55, v248
    s_nop 0
    s_cmp_eq_u64 vcc, 0
    s_cselect_b32 s55, 1, 0
    s_mov_b32 s100, s55
skip_54:
    s_nop 3
    v_pk_add_f32 v[34:35], v[208:209], v[210:211]
    v_pk_mul_f32 v[36:37], v[208:209], v[208:209]
    v_pk_fma_f32 v[36:37], v[210:211], v[210:211], v[36:37]
    v_pk_add_f32 v[34:35], v[34:35], v[212:213]
    v_pk_fma_f32 v[36:37], v[212:213], v[212:213], v[36:37]
    v_pk_add_f32 v[34:35], v[34:35], v[214:215]
    v_pk_fma_f32 v[36:37], v[214:215], v[214:215], v[36:37]
    v_pk_add_f32 v[34:35], v[34:35], v[216:217]
    v_pk_fma_f32 v[36:37], v[216:217], v[216:217], v[36:37]
    v_pk_add_f32 v[34:35], v[34:35], v[218:219]
    v_pk_fma_f32 v[36:37], v[218:219], v[218:219], v[36:37]
    v_pk_add_f32 v[34:35], v[34:35], v[220:221]
    v_pk_fma_f32 v[36:37], v[220:221], v[220:221], v[36:37]
    v_pk_add_f32 v[34:35], v[34:35], v[222:223]
    v_pk_fma_f32 v[36:37], v[222:223], v[222:223], v[36:37]
    v_add_f32 v32, v34, v35
    v_add_f32 v33, v36, v37
    s_nop 1
    v_permlane32_swap_b32 v32, v33
    v_add_f32 v32, v32, v33
    v_cvt_pk_bf16_f32 v224, v208, v209
    v_cvt_pk_bf16_f32 v225, v210, v211
    v_add_f32_dpp v32, v32, v32 row_ror:8 row_mask:0xf bank_mask:0xf
    v_cvt_pk_bf16_f32 v226, v212, v213
    v_cvt_pk_bf16_f32 v227, v214, v215
    v_add_f32_dpp v32, v32, v32 row_ror:4 row_mask:0xf bank_mask:0xf
    v_cvt_pk_bf16_f32 v228, v216, v217
    v_cvt_pk_bf16_f32 v229, v218, v219
    v_add_f32_dpp v32, v32, v32 row_ror:2 row_mask:0xf bank_mask:0xf
    v_cvt_pk_bf16_f32 v230, v220, v221
    v_cvt_pk_bf16_f32 v231, v222, v223
    v_add_f32_dpp v32, v32, v32 row_ror:1 row_mask:0xf bank_mask:0xf
    v_mov_b32 v33, v32
    s_add_u32 s72, s48, 0x400000
    s_add_u32 s73, s48, 0x200000
    v_permlane32_swap_b32 v32, v33
    v_mul_f32 v34, 0x3b000000, v32
    v_mul_f32 v33, 0x3b000000, v33
    v_fma_f32 v33, -v34, v34, v33
    v_max_f32 v33, 0, v33
    v_add_f32 v33, 0x3727c5ac, v33
    v_rsq_f32 v32, v33
    s_nop 0
    v_mul_f32 v33, -v34, v32
    v_pk_fma_f32 v[208:209], v[208:209], v[32:33], v[32:33] op_sel:[0,0,1] op_sel_hi:[1,0,1]
    v_pk_fma_f32 v[210:211], v[210:211], v[32:33], v[32:33] op_sel:[0,0,1] op_sel_hi:[1,0,1]
    v_pk_fma_f32 v[212:213], v[212:213], v[32:33], v[32:33] op_sel:[0,0,1] op_sel_hi:[1,0,1]
    v_pk_fma_f32 v[214:215], v[214:215], v[32:33], v[32:33] op_sel:[0,0,1] op_sel_hi:[1,0,1]
    v_pk_fma_f32 v[216:217], v[216:217], v[32:33], v[32:33] op_sel:[0,0,1] op_sel_hi:[1,0,1]
    v_pk_fma_f32 v[218:219], v[218:219], v[32:33], v[32:33] op_sel:[0,0,1] op_sel_hi:[1,0,1]
    v_pk_fma_f32 v[220:221], v[220:221], v[32:33], v[32:33] op_sel:[0,0,1] op_sel_hi:[1,0,1]
    v_pk_fma_f32 v[222:223], v[222:223], v[32:33], v[32:33] op_sel:[0,0,1] op_sel_hi:[1,0,1]
    v_cvt_pk_bf16_f32 v232, v208, v209
    v_cvt_pk_bf16_f32 v233, v210, v211
    v_cvt_pk_bf16_f32 v234, v212, v213
    v_cvt_pk_bf16_f32 v235, v214, v215
    v_cvt_pk_bf16_f32 v236, v216, v217
    v_cvt_pk_bf16_f32 v237, v218, v219
    v_cvt_pk_bf16_f32 v238, v220, v221
    v_cvt_pk_bf16_f32 v239, v222, v223
    ds_write_b128 v1, v[232:235] offset:16640
    ds_write_b128 v1, v[236:239] offset:21248
    s_waitcnt lgkmcnt(0)
    s_barrier
    ds_read_b128 v[232:235], v22 offset:16640
    ds_read_b128 v[236:239], v22 offset:17216
    ds_write_b128 v1, v[224:227] offset:0
    ds_write_b128 v1, v[228:231] offset:4608
    s_cmp_eq_u32 s89, 0
    s_cbranch_scc1 ool_55
    s_waitcnt lgkmcnt(3)
    buffer_store_dwordx4 v[232:235], v2, s[36:39], s73 offen offset:0
    s_waitcnt lgkmcnt(2)
    buffer_store_dwordx4 v[236:239], v2, s[36:39], s73 offen offset:2048
back_56:
    s_add_u32 s76, s47, 0x200000
    s_add_u32 s77, s47, 0x201000
    s_add_u32 s78, s47, 0x202000
    s_add_u32 s79, s47, 0x203000
    s_cmp_eq_u32 s43, 0
    s_cbranch_scc0 skip_57
    s_add_u32 m0, s70, 0x10000
    s_add_u32 s71, s57, 0x2c000
    buffer_load_dwordx4 v0, s[24:27], s71 offen offset:0 sc1 lds
    buffer_load_dwordx4 v0, s[24:27], s71 offen offset:1024 sc1 lds
    v_accvgpr_read_b32 v104, a192
    v_accvgpr_read_b32 v105, a193
    v_accvgpr_read_b32 v106, a194
    v_accvgpr_read_b32 v107, a195
    v_accvgpr_read_b32 v108, a196
    v_accvgpr_read_b32 v109, a197
    v_accvgpr_read_b32 v110, a198
    v_accvgpr_read_b32 v111, a199
    v_accvgpr_read_b32 v112, a200
    v_accvgpr_read_b32 v113, a201
    v_accvgpr_read_b32 v114, a202
    v_accvgpr_read_b32 v115, a203
    v_accvgpr_read_b32 v116, a204
    v_accvgpr_read_b32 v117, a205
    v_accvgpr_read_b32 v118, a206
    v_accvgpr_read_b32 v119, a207
    v_accvgpr_read_b32 v120, a208
    v_accvgpr_read_b32 v121, a209
    v_accvgpr_read_b32 v122, a210
    v_accvgpr_read_b32 v123, a211
    v_accvgpr_read_b32 v124, a212
    v_accvgpr_read_b32 v125, a213
    v_accvgpr_read_b32 v126, a214
    v_accvgpr_read_b32 v127, a215
    v_accvgpr_read_b32 v128, a216
    v_accvgpr_read_b32 v129, a217
    v_accvgpr_read_b32 v130, a218
    v_accvgpr_read_b32 v131, a219
    v_accvgpr_read_b32 v132, a220
    v_accvgpr_read_b32 v133, a221
    v_accvgpr_read_b32 v134, a222
    v_accvgpr_read_b32 v135, a223
    v_perm_b32 v136, v108, v104, s60
    v_accvgpr_write_b32 a192, v136
    v_perm_b32 v137, v108, v104, s61
    v_accvgpr_write_b32 a196, v137
    v_perm_b32 v138, v109, v105, s60
    v_accvgpr_write_b32 a200, v138
    v_perm_b32 v139, v109, v105, s61
    v_accvgpr_write_b32 a204, v139
    v_perm_b32 v136, v110, v106, s60
    v_accvgpr_write_b32 a208, v136
    v_perm_b32 v137, v110, v106, s61
    v_accvgpr_write_b32 a212, v137
    v_perm_b32 v138, v111, v107, s60
    v_accvgpr_write_b32 a216, v138
    v_perm_b32 v139, v111, v107, s61
    v_accvgpr_write_b32 a220, v139
    v_perm_b32 v136, v116, v112, s60
    v_accvgpr_write_b32 a193, v136
    v_perm_b32 v137, v116, v112, s61
    v_accvgpr_write_b32 a197, v137
    v_perm_b32 v138, v117, v113, s60
    v_accvgpr_write_b32 a201, v138
    v_perm_b32 v139, v117, v113, s61
    v_accvgpr_write_b32 a205, v139
    v_perm_b32 v136, v118, v114, s60
    v_accvgpr_write_b32 a209, v136
    v_perm_b32 v137, v118, v114, s61
    v_accvgpr_write_b32 a213, v137
    v_perm_b32 v138, v119, v115, s60
    v_accvgpr_write_b32 a217, v138
    v_perm_b32 v139, v119, v115, s61
    v_accvgpr_write_b32 a221, v139
    v_perm_b32 v136, v124, v120, s60
    v_accvgpr_write_b32 a194, v136
    v_perm_b32 v137, v124, v120, s61
    v_accvgpr_write_b32 a198, v137
    v_perm_b32 v138, v125, v121, s60
    v_accvgpr_write_b32 a202, v138
    v_perm_b32 v139, v125, v121, s61
    v_accvgpr_write_b32 a206, v139
    v_perm_b32 v136, v126, v122, s60
    v_accvgpr_write_b32 a210, v136
    v_perm_b32 v137, v126, v122, s61
    v_accvgpr_write_b32 a214, v137
    v_perm_b32 v138, v127, v123, s60
    v_accvgpr_write_b32 a218, v138
    v_perm_b32 v139, v127, v123, s61
    v_accvgpr_write_b32 a222, v139
    v_perm_b32 v136, v132, v128, s60
    v_accvgpr_write_b32 a195, v136
    v_perm_b32 v137, v132, v128, s61
    v_accvgpr_write_b32 a199, v137
    v_perm_b32 v138, v133, v129, s60
    v_accvgpr_write_b32 a203, v138
    v_perm_b32 v139, v133, v129, s61
    v_accvgpr_write_b32 a207, v139
    v_perm_b32 v136, v134, v130, s60
    v_accvgpr_write_b32 a211, v136
    v_perm_b32 v137, v134, v130, s61
    v_accvgpr_write_b32 a215, v137
    v_perm_b32 v138, v135, v131, s60
    v_accvgpr_write_b32 a219, v138
    v_perm_b32 v139, v135, v131, s61
    v_accvgpr_write_b32 a223, v139
skip_57:
    s_waitcnt lgkmcnt(0)
    s_barrier
    ds_read_b128 v[224:227], v22 offset:0
    ds_read_b128 v[228:231], v22 offset:576
    v_mov_b32 v32, 1
    s_waitcnt vmcnt(0)
    s_mov_b64 exec, 1
    s_cmp_eq_u32 s55, 0
    s_cbranch_scc1 ool_58
    buffer_store_dword v32, off, s[24:27], s0
back_59:
    s_mov_b64 exec, -1
    s_cmp_eq_u32 s43, 0
    s_cbranch_scc0 skip_60
    buffer_load_dwordx4 v0, s[24:27], s71 offen offset:2048 sc1 lds
    buffer_load_dwordx4 v0, s[24:27], s71 offen offset:3072 sc1 lds
    s_add_u32 m0, s70, 0x14000
    s_add_u32 s71, s57, 0x30000
    buffer_load_dwordx4 v0, s[24:27], s71 offen offset:0 sc1 lds
    buffer_load_dwordx4 v0, s[24:27], s71 offen offset:1024 sc1 lds
    buffer_load_dwordx4 v0, s[24:27], s71 offen offset:2048 sc1 lds
    buffer_load_dwordx4 v0, s[24:27], s71 offen offset:3072 sc1 lds
    s_add_u32 m0, s70, 0x18000
    s_add_u32 s71, s57, 0x34000
    buffer_load_dwordx4 v0, s[24:27], s71 offen offset:0 sc1 lds
    buffer_load_dwordx4 v0, s[24:27], s71 offen offset:1024 sc1 lds
    buffer_load_dwordx4 v0, s[24:27], s71 offen offset:2048 sc1 lds
    buffer_load_dwordx4 v0, s[24:27], s71 offen offset:3072 sc1 lds
    v_accvgpr_read_b32 v104, a224
    v_accvgpr_read_b32 v105, a225
    v_accvgpr_read_b32 v106, a226
    v_accvgpr_read_b32 v107, a227
    v_accvgpr_read_b32 v108, a228
    v_accvgpr_read_b32 v109, a229
    v_accvgpr_read_b32 v110, a230
    v_accvgpr_read_b32 v111, a231
    v_accvgpr_read_b32 v112, a232
    v_accvgpr_read_b32 v113, a233
    v_accvgpr_read_b32 v114, a234
    v_accvgpr_read_b32 v115, a235
    v_accvgpr_read_b32 v116, a236
    v_accvgpr_read_b32 v117, a237
    v_accvgpr_read_b32 v118, a238
    v_accvgpr_read_b32 v119, a239
    v_accvgpr_read_b32 v120, a240
    v_accvgpr_read_b32 v121, a241
    v_accvgpr_read_b32 v122, a242
    v_accvgpr_read_b32 v123, a243
    v_accvgpr_read_b32 v124, a244
    v_accvgpr_read_b32 v125, a245
    v_accvgpr_read_b32 v126, a246
    v_accvgpr_read_b32 v127, a247
    v_accvgpr_read_b32 v128, a248
    v_accvgpr_read_b32 v129, a249
    v_accvgpr_read_b32 v130, a250
    v_accvgpr_read_b32 v131, a251
    v_accvgpr_read_b32 v132, a252
    v_accvgpr_read_b32 v133, a253
    v_accvgpr_read_b32 v134, a254
    v_accvgpr_read_b32 v135, a255
    v_perm_b32 v136, v108, v104, s60
    v_accvgpr_write_b32 a224, v136
    v_perm_b32 v137, v108, v104, s61
    v_accvgpr_write_b32 a228, v137
    v_perm_b32 v138, v109, v105, s60
    v_accvgpr_write_b32 a232, v138
    v_perm_b32 v139, v109, v105, s61
    v_accvgpr_write_b32 a236, v139
    v_perm_b32 v136, v110, v106, s60
    v_accvgpr_write_b32 a240, v136
    v_perm_b32 v137, v110, v106, s61
    v_accvgpr_write_b32 a244, v137
    v_perm_b32 v138, v111, v107, s60
    v_accvgpr_write_b32 a248, v138
    v_perm_b32 v139, v111, v107, s61
    v_accvgpr_write_b32 a252, v139
    v_perm_b32 v136, v116, v112, s60
    v_accvgpr_write_b32 a225, v136
    v_perm_b32 v137, v116, v112, s61
    v_accvgpr_write_b32 a229, v137
    v_perm_b32 v138, v117, v113, s60
    v_accvgpr_write_b32 a233, v138
    v_perm_b32 v139, v117, v113, s61
    v_accvgpr_write_b32 a237, v139
    v_perm_b32 v136, v118, v114, s60
    v_accvgpr_write_b32 a241, v136
    v_perm_b32 v137, v118, v114, s61
    v_accvgpr_write_b32 a245, v137
    v_perm_b32 v138, v119, v115, s60
    v_accvgpr_write_b32 a249, v138
    v_perm_b32 v139, v119, v115, s61
    v_accvgpr_write_b32 a253, v139
    v_perm_b32 v136, v124, v120, s60
    v_accvgpr_write_b32 a226, v136
    v_perm_b32 v137, v124, v120, s61
    v_accvgpr_write_b32 a230, v137
    v_perm_b32 v138, v125, v121, s60
    v_accvgpr_write_b32 a234, v138
    v_perm_b32 v139, v125, v121, s61
    v_accvgpr_write_b32 a238, v139
    v_perm_b32 v136, v126, v122, s60
    v_accvgpr_write_b32 a242, v136
    v_perm_b32 v137, v126, v122, s61
    v_accvgpr_write_b32 a246, v137
    v_perm_b32 v138, v127, v123, s60
    v_accvgpr_write_b32 a250, v138
    v_perm_b32 v139, v127, v123, s61
    v_accvgpr_write_b32 a254, v139
    v_perm_b32 v136, v132, v128, s60
    v_accvgpr_write_b32 a227, v136
    v_perm_b32 v137, v132, v128, s61
    v_accvgpr_write_b32 a231, v137
    v_perm_b32 v138, v133, v129, s60
    v_accvgpr_write_b32 a235, v138
    v_perm_b32 v139, v133, v129, s61
    v_accvgpr_write_b32 a239, v139
    v_perm_b32 v136, v134, v130, s60
    v_accvgpr_write_b32 a243, v136
    v_perm_b32 v137, v134, v130, s61
    v_accvgpr_write_b32 a247, v137
    v_perm_b32 v138, v135, v131, s60
    v_accvgpr_write_b32 a251, v138
    v_perm_b32 v139, v135, v131, s61
    v_accvgpr_write_b32 a255, v139
skip_60:
    s_waitcnt lgkmcnt(0)
    s_waitcnt vmcnt(8)
    s_waitcnt vmcnt(4)
    s_waitcnt vmcnt(0)
    s_barrier
poll_61:
    buffer_load_dword v32, v254, s[24:27], s1 offen sc1
    s_waitcnt vmcnt(0)
    v_cmp_ne_u32 vcc, 1, v32
    s_cbranch_vccz pdone_62
    s_sub_u32 s44, s44, 1
    s_cbranch_scc0 poll_61
    s_mov_b32 s44, 0
pdone_62:
L_k3:
    buffer_load_dwordx4 v[40:43], v0, s[36:39], s76 offen offset:0 sc1
    buffer_load_dwordx4 v[44:47], v0, s[36:39], s76 offen offset:1024 sc1
    buffer_load_dwordx4 v[48:51], v0, s[36:39], s76 offen offset:2048 sc1
    buffer_load_dwordx4 v[52:55], v0, s[36:39], s76 offen offset:3072 sc1
    buffer_load_dwordx4 v[56:59], v0, s[36:39], s77 offen offset:0 sc1
    buffer_load_dwordx4 v[60:63], v0, s[36:39], s77 offen offset:1024 sc1
    v_and_b32 v212, 0xf0, v0
    v_lshrrev_b32 v213, 2, v0
    v_and_b32 v213, 0xc0, v213
    v_sub_u32 v212, v212, v213
    v_mov_b32 v216, 0x3f80
    v_lshlrev_b32 v216, v212, v216
    v_lshrrev_b32 v213, 5, v212
    v_cmp_eq_u32 vcc, 0, v213
    s_nop 1
    v_cndmask_b32 v214, 0, v216, vcc
    v_cmp_eq_u32 vcc, 1, v213
    s_nop 1
    v_cndmask_b32 v215, 0, v216, vcc
    v_mov_b32 v212, 0
    v_mov_b32 v213, 0
    v_mov_b32 v216, 0
    v_mov_b32 v217, 0
    v_mov_b32 v242, 0
    v_mov_b32 v243, 0
    ds_read_b128 v[164:167], v0 offset:0
    ds_read_b128 v[168:171], v0 offset:1024
    ds_read_b128 v[172:175], v0 offset:2048
    ds_read_b128 v[176:179], v0 offset:3072
    ds_read_b128 v[180:183], v0 offset:4096
    ds_read_b128 v[184:187], v0 offset:5120
    ds_read_b128 v[188:191], v0 offset:6144
    ds_read_b128 v[192:195], v0 offset:7168
    ds_read_b128 v[196:199], v0 offset:8192
    ds_read_b128 v[200:203], v0 offset:9216
    ds_read_b128 v[204:207], v0 offset:10240
    ds_read_b128 v[208:211], v0 offset:11264
    s_waitcnt lgkmcnt(10)
    s_waitcnt vmcnt(5)
    v_mfma_f32_16x16x32_bf16 v[104:107], v[164:167], v[40:43], 0
    ds_read_b128 v[164:167], v0 offset:12288
    v_mfma_f32_16x16x32_bf16 v[108:111], v[168:171], v[40:43], 0
    ds_read_b128 v[168:171], v0 offset:13312
    buffer_load_dwordx4 v[64:67], v0, s[36:39], s77 offen offset:2048 sc1
    s_waitcnt lgkmcnt(10)
    v_mfma_f32_16x16x32_bf16 v[112:115], v[172:175], v[40:43], 0
    ds_read_b128 v[172:175], v0 offset:14336
    v_mfma_f32_16x16x32_bf16 v[116:119], v[176:179], v[40:43], 0
    ds_read_b128 v[176:179], v0 offset:15360
    s_waitcnt lgkmcnt(10)
    v_mfma_f32_16x16x32_bf16 v[120:123], v[180:183], v[40:43], 0
    ds_read_b128 v[180:183], v0 offset:16384
    v_mfma_f32_16x16x32_bf16 v[124:127], v[184:187], v[40:43], 0
    ds_read_b128 v[184:187], v0 offset:17408
    buffer_load_dwordx4 v[68:71], v0, s[36:39], s77 offen offset:3072 sc1
    s_waitcnt lgkmcnt(10)
    v_mfma_f32_16x16x32_bf16 v[128:131], v[188:191], v[40:43], 0
    ds_read_b128 v[188:191], v0 offset:18432
    s_waitcnt vmcnt(6)
    v_mfma_f32_16x16x32_bf16 v[104:107], v[192:195], v[44:47], v[104:107]
    ds_read_b128 v[192:195], v0 offset:19456
    s_waitcnt lgkmcnt(10)
    v_mfma_f32_16x16x32_bf16 v[108:111], v[196:199], v[44:47], v[108:111]
    ds_read_b128 v[196:199], v0 offset:20480
    v_mfma_f32_16x16x32_bf16 v[112:115], v[200:203], v[44:47], v[112:115]
    ds_read_b128 v[200:203], v0 offset:21504
    buffer_load_dwordx4 v[72:75], v0, s[36:39], s78 offen offset:0 sc1
    s_waitcnt lgkmcnt(10)
    v_mfma_f32_16x16x32_bf16 v[116:119], v[204:207], v[44:47], v[116:119]
    ds_read_b128 v[204:207], v0 offset:22528
    v_mfma_f32_16x16x32_bf16 v[120:123], v[208:211], v[44:47], v[120:123]
    ds_read_b128 v[208:211], v0 offset:23552
    s_waitcnt lgkmcnt(10)
    v_mfma_f32_16x16x32_bf16 v[124:127], v[164:167], v[44:47], v[124:127]
    ds_read_b128 v[164:167], v0 offset:24576
    v_mfma_f32_16x16x32_bf16 v[128:131], v[168:171], v[44:47], v[128:131]
    ds_read_b128 v[168:171], v0 offset:25600
    buffer_load_dwordx4 v[76:79], v0, s[36:39], s78 offen offset:1024 sc1
    s_waitcnt lgkmcnt(10)
    s_waitcnt vmcnt(7)
    v_mfma_f32_16x16x32_bf16 v[104:107], v[172:175], v[48:51], v[104:107]
    ds_read_b128 v[172:175], v0 offset:26624
    v_mfma_f32_16x16x32_bf16 v[108:111], v[176:179], v[48:51], v[108:111]
    ds_read_b128 v[176:179], v0 offset:27648
    s_waitcnt lgkmcnt(10)
    v_mfma_f32_16x16x32_bf16 v[112:115], v[180:183], v[48:51], v[112:115]
    ds_read_b128 v[180:183], v0 offset:28672
    v_mfma_f32_16x16x32_bf16 v[116:119], v[184:187], v[48:51], v[116:119]
    ds_read_b128 v[184:187], v0 offset:29696
    buffer_load_dwordx4 v[80:83], v0, s[36:39], s78 offen offset:2048 sc1
    s_waitcnt lgkmcnt(10)
    v_mfma_f32_16x16x32_bf16 v[120:123], v[188:191], v[48:51], v[120:123]
    ds_read_b128 v[188:191], v0 offset:30720
    v_mfma_f32_16x16x32_bf16 v[124:127], v[192:195], v[48:51], v[124:127]
    ds_read_b128 v[192:195], v0 offset:31744
    s_waitcnt lgkmcnt(10)
    v_mfma_f32_16x16x32_bf16 v[128:131], v[196:199], v[48:51], v[128:131]
    ds_read_b128 v[196:199], v0 offset:32768
    s_waitcnt vmcnt(7)
    v_mfma_f32_16x16x32_bf16 v[104:107], v[200:203], v[52:55], v[104:107]
    ds_read_b128 v[200:203], v0 offset:33792
    buffer_load_dwordx4 v[84:87], v0, s[36:39], s78 offen offset:3072 sc1
    s_waitcnt lgkmcnt(10)
    v_mfma_f32_16x16x32_bf16 v[108:111], v[204:207], v[52:55], v[108:111]
    ds_read_b128 v[204:207], v0 offset:34816
    v_mfma_f32_16x16x32_bf16 v[112:115], v[208:211], v[52:55], v[112:115]
    ds_read_b128 v[208:211], v0 offset:35840
    s_waitcnt lgkmcnt(10)
    v_mfma_f32_16x16x32_bf16 v[116:119], v[164:167], v[52:55], v[116:119]
    ds_read_b128 v[164:167], v0 offset:36864
    v_mfma_f32_16x16x32_bf16 v[120:123], v[168:171], v[52:55], v[120:123]
    ds_read_b128 v[168:171], v0 offset:37888
    buffer_load_dwordx4 v[88:91], v0, s[36:39], s79 offen offset:0 sc1
    s_waitcnt lgkmcnt(10)
    v_mfma_f32_16x16x32_bf16 v[124:127], v[172:175], v[52:55], v[124:127]
    ds_read_b128 v[172:175], v0 offset:38912
    v_mfma_f32_16x16x32_bf16 v[128:131], v[176:179], v[52:55], v[128:131]
    ds_read_b128 v[176:179], v0 offset:39936
    s_waitcnt lgkmcnt(10)
    s_waitcnt vmcnt(8)
    v_mfma_f32_16x16x32_bf16 v[104:107], v[180:183], v[56:59], v[104:107]
    ds_read_b128 v[180:183], v0 offset:40960
    v_mfma_f32_16x16x32_bf16 v[108:111], v[184:187], v[56:59], v[108:111]
    ds_read_b128 v[184:187], v0 offset:41984
    buffer_load_dwordx4 v[92:95], v0, s[36:39], s79 offen offset:1024 sc1
    s_waitcnt lgkmcnt(10)
    v_mfma_f32_16x16x32_bf16 v[112:115], v[188:191], v[56:59], v[112:115]
    ds_read_b128 v[188:191], v0 offset:43008
    v_mfma_f32_16x16x32_bf16 v[116:119], v[192:195], v[56:59], v[116:119]
    ds_read_b128 v[192:195], v0 offset:44032
    s_waitcnt lgkmcnt(10)
    v_mfma_f32_16x16x32_bf16 v[120:123], v[196:199], v[56:59], v[120:123]
    ds_read_b128 v[196:199], v0 offset:45056
    v_mfma_f32_16x16x32_bf16 v[124:127], v[200:203], v[56:59], v[124:127]
    ds_read_b128 v[200:203], v0 offset:46080
    buffer_load_dwordx4 v[96:99], v0, s[36:39], s79 offen offset:2048 sc1
    s_waitcnt lgkmcnt(10)
    v_mfma_f32_16x16x32_bf16 v[128:131], v[204:207], v[56:59], v[128:131]
    ds_read_b128 v[204:207], v0 offset:47104
    s_waitcnt vmcnt(9)
    v_mfma_f32_16x16x32_bf16 v[104:107], v[208:211], v[60:63], v[104:107]
    ds_read_b128 v[208:211], v0 offset:48128
    s_waitcnt lgkmcnt(10)
    v_mfma_f32_16x16x32_bf16 v[108:111], v[164:167], v[60:63], v[108:111]
    ds_read_b128 v[164:167], v0 offset:49152
    v_mfma_f32_16x16x32_bf16 v[112:115], v[168:171], v[60:63], v[112:115]
    ds_read_b128 v[168:171], v0 offset:50176
    buffer_load_dwordx4 v[100:103], v0, s[36:39], s79 offen offset:3072 sc1
    s_waitcnt lgkmcnt(10)
    v_mfma_f32_16x16x32_bf16 v[116:119], v[172:175], v[60:63], v[116:119]
    ds_read_b128 v[172:175], v0 offset:51200
    v_mfma_f32_16x16x32_bf16 v[120:123], v[176:179], v[60:63], v[120:123]
    ds_read_b128 v[176:179], v0 offset:52224
    s_waitcnt lgkmcnt(10)
    v_mfma_f32_16x16x32_bf16 v[124:127], v[180:183], v[60:63], v[124:127]
    ds_read_b128 v[180:183], v0 offset:53248
    v_mfma_f32_16x16x32_bf16 v[128:131], v[184:187], v[60:63], v[128:131]
    ds_read_b128 v[184:187], v0 offset:54272
    buffer_store_dwordx4 v[224:227], v2, s[36:39], s72 offen offset:0 sc1
    s_waitcnt lgkmcnt(10)
    s_waitcnt vmcnt(10)
    v_mfma_f32_16x16x32_bf16 v[104:107], v[188:191], v[64:67], v[104:107]
    ds_read_b128 v[188:191], v0 offset:55296
    v_mfma_f32_16x16x32_bf16 v[108:111], v[192:195], v[64:67], v[108:111]
    ds_read_b128 v[192:195], v0 offset:56320
    s_waitcnt lgkmcnt(10)
    v_mfma_f32_16x16x32_bf16 v[112:115], v[196:199], v[64:67], v[112:115]
    ds_read_b128 v[196:199], v0 offset:57344
    v_mfma_f32_16x16x32_bf16 v[116:119], v[200:203], v[64:67], v[116:119]
    ds_read_b128 v[200:203], v0 offset:58368
    buffer_store_dwordx4 v[228:231], v2, s[36:39], s72 offen offset:2048 sc1
    s_waitcnt lgkmcnt(10)
    v_mfma_f32_16x16x32_bf16 v[120:123], v[204:207], v[64:67], v[120:123]
    ds_read_b128 v[204:207], v0 offset:59392
    v_mfma_f32_16x16x32_bf16 v[124:127], v[208:211], v[64:67], v[124:127]
    ds_read_b128 v[208:211], v0 offset:60416
    s_waitcnt lgkmcnt(10)
    v_mfma_f32_16x16x32_bf16 v[128:131], v[164:167], v[64:67], v[128:131]
    ds_read_b128 v[164:167], v0 offset:61440
    s_waitcnt vmcnt(10)
    v_mfma_f32_16x16x32_bf16 v[104:107], v[168:171], v[68:71], v[104:107]
    ds_read_b128 v[168:171], v0 offset:62464
    s_add_u32 m0, s70, 0x1c000
    s_add_u32 s71, s57, 0x0
    buffer_load_dwordx4 v0, s[24:27], s71 offen offset:0 sc1 lds
    s_waitcnt lgkmcnt(10)
    v_mfma_f32_16x16x32_bf16 v[108:111], v[172:175], v[68:71], v[108:111]
    ds_read_b128 v[172:175], v0 offset:63488
    v_mfma_f32_16x16x32_bf16 v[112:115], v[176:179], v[68:71], v[112:115]
    ds_read_b128 v[176:179], v0 offset:64512
    s_waitcnt lgkmcnt(10)
    v_mfma_f32_16x16x32_bf16 v[116:119], v[180:183], v[68:71], v[116:119]
    ds_read_b128 v[180:183], v252 offset:0
    v_mfma_f32_16x16x32_bf16 v[120:123], v[184:187], v[68:71], v[120:123]
    ds_read_b128 v[184:187], v252 offset:1024
    buffer_load_dwordx4 v0, s[24:27], s71 offen offset:1024 sc1 lds
    s_waitcnt lgkmcnt(10)
    v_mfma_f32_16x16x32_bf16 v[124:127], v[188:191], v[68:71], v[124:127]
    ds_read_b128 v[188:191], v252 offset:2048
    v_mfma_f32_16x16x32_bf16 v[128:131], v[192:195], v[68:71], v[128:131]
    ds_read_b128 v[192:195], v252 offset:3072
    s_waitcnt lgkmcnt(10)
    s_waitcnt vmcnt(11)
    v_mfma_f32_16x16x32_bf16 v[104:107], v[196:199], v[72:75], v[104:107]
    ds_read_b128 v[196:199], v252 offset:4096
    v_mfma_f32_16x16x32_bf16 v[108:111], v[200:203], v[72:75], v[108:111]
    ds_read_b128 v[200:203], v252 offset:5120
    buffer_load_dwordx4 v0, s[24:27], s71 offen offset:2048 sc1 lds
    s_waitcnt lgkmcnt(10)
    v_mfma_f32_16x16x32_bf16 v[112:115], v[204:207], v[72:75], v[112:115]
    ds_read_b128 v[204:207], v252 offset:6144
    v_mfma_f32_16x16x32_bf16 v[116:119], v[208:211], v[72:75], v[116:119]
    ds_read_b128 v[208:211], v252 offset:7168
    s_waitcnt lgkmcnt(10)
    v_mfma_f32_16x16x32_bf16 v[120:123], v[164:167], v[72:75], v[120:123]
    ds_read_b128 v[164:167], v252 offset:8192
    v_mfma_f32_16x16x32_bf16 v[124:127], v[168:171], v[72:75], v[124:127]
    ds_read_b128 v[168:171], v252 offset:9216
    buffer_load_dwordx4 v0, s[24:27], s71 offen offset:3072 sc1 lds
    s_waitcnt lgkmcnt(10)
    v_mfma_f32_16x16x32_bf16 v[128:131], v[172:175], v[72:75], v[128:131]
    ds_read_b128 v[172:175], v252 offset:10240
    s_waitcnt vmcnt(12)
    v_mfma_f32_16x16x32_bf16 v[104:107], v[176:179], v[76:79], v[104:107]
    ds_read_b128 v[176:179], v252 offset:11264
    s_waitcnt lgkmcnt(10)
    v_mfma_f32_16x16x32_bf16 v[108:111], v[180:183], v[76:79], v[108:111]
    ds_read_b128 v[180:183], v252 offset:12288
    v_mfma_f32_16x16x32_bf16 v[112:115], v[184:187], v[76:79], v[112:115]
    ds_read_b128 v[184:187], v252 offset:13312
    s_add_u32 m0, s70, 0x20000
    s_add_u32 s71, s57, 0x4000
    buffer_load_dwordx4 v0, s[24:27], s71 offen offset:0 sc1 lds
    s_waitcnt lgkmcnt(10)
    v_mfma_f32_16x16x32_bf16 v[116:119], v[188:191], v[76:79], v[116:119]
    ds_read_b128 v[188:191], v252 offset:14336
    v_mfma_f32_16x16x32_bf16 v[120:123], v[192:195], v[76:79], v[120:123]
    ds_read_b128 v[192:195], v252 offset:15360
    s_waitcnt lgkmcnt(10)
    v_mfma_f32_16x16x32_bf16 v[124:127], v[196:199], v[76:79], v[124:127]
    ds_read_b128 v[196:199], v252 offset:16384
    v_mfma_f32_16x16x32_bf16 v[128:131], v[200:203], v[76:79], v[128:131]
    ds_read_b128 v[200:203], v252 offset:17408
    buffer_load_dwordx4 v0, s[24:27], s71 offen offset:1024 sc1 lds
    s_waitcnt lgkmcnt(10)
    s_waitcnt vmcnt(13)
    v_mfma_f32_16x16x32_bf16 v[104:107], v[204:207], v[80:83], v[104:107]
    ds_read_b128 v[204:207], v252 offset:18432
    v_mfma_f32_16x16x32_bf16 v[108:111], v[208:211], v[80:83], v[108:111]
    ds_read_b128 v[208:211], v252 offset:19456
    s_waitcnt lgkmcnt(10)
    v_mfma_f32_16x16x32_bf16 v[112:115], v[164:167], v[80:83], v[112:115]
    ds_read_b128 v[164:167], v252 offset:20480
    v_mfma_f32_16x16x32_bf16 v[116:119], v[168:171], v[80:83], v[116:119]
    ds_read_b128 v[168:171], v252 offset:21504
    buffer_load_dwordx4 v0, s[24:27], s71 offen offset:2048 sc1 lds
    s_waitcnt lgkmcnt(10)
    v_mfma_f32_16x16x32_bf16 v[120:123], v[172:175], v[80:83], v[120:123]
    ds_read_b128 v[172:175], v252 offset:22528
    v_mfma_f32_16x16x32_bf16 v[124:127], v[176:179], v[80:83], v[124:127]
    ds_read_b128 v[176:179], v252 offset:23552
    s_waitcnt lgkmcnt(10)
    v_mfma_f32_16x16x32_bf16 v[128:131], v[180:183], v[80:83], v[128:131]
    ds_read_b128 v[180:183], v252 offset:24576
    s_waitcnt vmcnt(13)
    v_mfma_f32_16x16x32_bf16 v[104:107], v[184:187], v[84:87], v[104:107]
    ds_read_b128 v[184:187], v252 offset:25600
    buffer_load_dwordx4 v0, s[24:27], s71 offen offset:3072 sc1 lds
    s_waitcnt lgkmcnt(10)
    v_mfma_f32_16x16x32_bf16 v[108:111], v[188:191], v[84:87], v[108:111]
    ds_read_b128 v[188:191], v252 offset:26624
    v_mfma_f32_16x16x32_bf16 v[112:115], v[192:195], v[84:87], v[112:115]
    ds_read_b128 v[192:195], v252 offset:27648
    s_waitcnt lgkmcnt(10)
    v_mfma_f32_16x16x32_bf16 v[116:119], v[196:199], v[84:87], v[116:119]
    ds_read_b128 v[196:199], v252 offset:28672
    v_mfma_f32_16x16x32_bf16 v[120:123], v[200:203], v[84:87], v[120:123]
    ds_read_b128 v[200:203], v252 offset:29696
    s_add_u32 m0, s70, 0x24000
    s_add_u32 s71, s57, 0x8000
    buffer_load_dwordx4 v0, s[24:27], s71 offen offset:0 sc1 lds
    s_waitcnt lgkmcnt(10)
    v_mfma_f32_16x16x32_bf16 v[124:127], v[204:207], v[84:87], v[124:127]
    ds_read_b128 v[204:207], v252 offset:30720
    v_mfma_f32_16x16x32_bf16 v[128:131], v[208:211], v[84:87], v[128:131]
    ds_read_b128 v[208:211], v252 offset:31744
    s_waitcnt lgkmcnt(10)
    s_waitcnt vmcnt(14)
    v_mfma_f32_16x16x32_bf16 v[104:107], v[164:167], v[88:91], v[104:107]
    ds_read_b128 v[164:167], v252 offset:32768
    v_mfma_f32_16x16x32_bf16 v[108:111], v[168:171], v[88:91], v[108:111]
    ds_read_b128 v[168:171], v252 offset:33792
    buffer_load_dwordx4 v0, s[24:27], s71 offen offset:1024 sc1 lds
    s_waitcnt lgkmcnt(10)
    v_mfma_f32_16x16x32_bf16 v[112:115], v[172:175], v[88:91], v[112:115]
    ds_read_b128 v[172:175], v252 offset:34816
    v_mfma_f32_16x16x32_bf16 v[116:119], v[176:179], v[88:91], v[116:119]
    ds_read_b128 v[176:179], v252 offset:35840
    s_waitcnt lgkmcnt(10)
    v_mfma_f32_16x16x32_bf16 v[120:123], v[180:183], v[88:91], v[120:123]
    ds_read_b128 v[180:183], v252 offset:36864
    v_mfma_f32_16x16x32_bf16 v[124:127], v[184:187], v[88:91], v[124:127]
    ds_read_b128 v[184:187], v252 offset:37888
    buffer_load_dwordx4 v0, s[24:27], s71 offen offset:2048 sc1 lds
    s_waitcnt lgkmcnt(10)
    v_mfma_f32_16x16x32_bf16 v[128:131], v[188:191], v[88:91], v[128:131]
    ds_read_b128 v[188:191], v252 offset:38912
    s_waitcnt vmcnt(15)
    v_mfma_f32_16x16x32_bf16 v[104:107], v[192:195], v[92:95], v[104:107]
    ds_read_b128 v[192:195], v252 offset:39936
    s_waitcnt lgkmcnt(10)
    v_mfma_f32_16x16x32_bf16 v[108:111], v[196:199], v[92:95], v[108:111]
    ds_read_b128 v[196:199], v252 offset:40960
    v_mfma_f32_16x16x32_bf16 v[112:115], v[200:203], v[92:95], v[112:115]
    ds_read_b128 v[200:203], v252 offset:41984
    buffer_load_dwordx4 v0, s[24:27], s71 offen offset:3072 sc1 lds
    s_waitcnt lgkmcnt(10)
    v_mfma_f32_16x16x32_bf16 v[116:119], v[204:207], v[92:95], v[116:119]
    ds_read_b128 v[204:207], v252 offset:43008
    v_mfma_f32_16x16x32_bf16 v[120:123], v[208:211], v[92:95], v[120:123]
    ds_read_b128 v[208:211], v252 offset:44032
    s_waitcnt lgkmcnt(10)
    v_mfma_f32_16x16x32_bf16 v[124:127], v[164:167], v[92:95], v[124:127]
    ds_read_b128 v[164:167], v252 offset:45056
    s_cmp_eq_u32 s43, 0
    s_cbranch_scc0 skip_63
    v_mov_b32 v132, -1
    v_mov_b32 v133, -1
    v_mov_b32 v134, -1
    v_mov_b32 v135, -1
    s_add_u32 s99, s51, 0x1000000
    buffer_store_dwordx4 v[132:135], v7, s[36:39], s99 offen sc1
skip_63:
    v_mfma_f32_16x16x32_bf16 v[128:131], v[168:171], v[92:95], v[128:131]
    ds_read_b128 v[168:171], v252 offset:46080
    s_waitcnt lgkmcnt(10)
    s_waitcnt vmcnt(15)
    v_mfma_f32_16x16x32_bf16 v[104:107], v[172:175], v[96:99], v[104:107]
    ds_read_b128 v[172:175], v252 offset:47104
    v_mfma_f32_16x16x32_bf16 v[108:111], v[176:179], v[96:99], v[108:111]
    ds_read_b128 v[176:179], v252 offset:48128
    s_waitcnt lgkmcnt(10)
    v_mfma_f32_16x16x32_bf16 v[112:115], v[180:183], v[96:99], v[112:115]
    v_mfma_f32_16x16x32_bf16 v[116:119], v[184:187], v[96:99], v[116:119]
    s_waitcnt lgkmcnt(8)
    v_mfma_f32_16x16x32_bf16 v[120:123], v[188:191], v[96:99], v[120:123]
    v_mfma_f32_16x16x32_bf16 v[124:127], v[192:195], v[96:99], v[124:127]
    s_waitcnt lgkmcnt(6)
    v_mfma_f32_16x16x32_bf16 v[128:131], v[196:199], v[96:99], v[128:131]
    s_waitcnt vmcnt(14)
    v_mfma_f32_16x16x32_bf16 v[104:107], v[200:203], v[100:103], v[104:107]
    s_waitcnt lgkmcnt(4)
    v_mfma_f32_16x16x32_bf16 v[108:111], v[204:207], v[100:103], v[108:111]
    v_mfma_f32_16x16x32_bf16 v[112:115], v[208:211], v[100:103], v[112:115]
    s_waitcnt lgkmcnt(2)
    v_mfma_f32_16x16x32_bf16 v[116:119], v[164:167], v[100:103], v[116:119]
    v_mfma_f32_16x16x32_bf16 v[120:123], v[168:171], v[100:103], v[120:123]
    s_waitcnt lgkmcnt(0)
    v_mfma_f32_16x16x32_bf16 v[124:127], v[172:175], v[100:103], v[124:127]
    v_mfma_f32_16x16x32_bf16 v[128:131], v[176:179], v[100:103], v[128:131]
    s_waitcnt vmcnt(12)
    s_barrier
    s_add_u32 m0, s70, 0x0
    s_add_u32 s71, s57, 0xc000
    buffer_load_dwordx4 v0, s[24:27], s71 offen offset:0 sc1 lds
    buffer_load_dwordx4 v0, s[24:27], s71 offen offset:1024 sc1 lds
    v_pk_mul_f32 v[232:233], v[104:105], v[104:105]
    v_pk_mul_f32 v[234:235], v[106:107], v[106:107]
    v_pk_fma_f32 v[232:233], v[232:233], v[26:27], v[26:27] op_sel:[0,0,1] op_sel_hi:[1,0,1]
    v_pk_fma_f32 v[234:235], v[234:235], v[26:27], v[26:27] op_sel:[0,0,1] op_sel_hi:[1,0,1]
    v_pk_mul_f32 v[232:233], v[232:233], v[104:105]
    v_pk_mul_f32 v[234:235], v[234:235], v[106:107]
    v_exp_f32 v232, v232
    v_exp_f32 v233, v233
    v_exp_f32 v234, v234
    v_exp_f32 v235, v235
    v_pk_add_f32 v[232:233], v[232:233], 1.0 op_sel_hi:[1,0]
    v_pk_add_f32 v[234:235], v[234:235], 1.0 op_sel_hi:[1,0]
    v_rcp_f32 v232, v232
    v_rcp_f32 v233, v233
    v_rcp_f32 v234, v234
    v_rcp_f32 v235, v235
    buffer_load_dwordx4 v0, s[24:27], s71 offen offset:2048 sc1 lds
    v_pk_mul_f32 v[104:105], v[232:233], v[104:105]
    v_pk_mul_f32 v[106:107], v[234:235], v[106:107]
    v_pk_mul_f32 v[236:237], v[108:109], v[108:109]
    v_pk_mul_f32 v[238:239], v[110:111], v[110:111]
    v_pk_fma_f32 v[236:237], v[236:237], v[26:27], v[26:27] op_sel:[0,0,1] op_sel_hi:[1,0,1]
    v_pk_fma_f32 v[238:239], v[238:239], v[26:27], v[26:27] op_sel:[0,0,1] op_sel_hi:[1,0,1]
    v_pk_mul_f32 v[236:237], v[236:237], v[108:109]
    v_pk_mul_f32 v[238:239], v[238:239], v[110:111]
    v_exp_f32 v236, v236
    v_exp_f32 v237, v237
    v_exp_f32 v238, v238
    v_exp_f32 v239, v239
    v_pk_add_f32 v[236:237], v[236:237], 1.0 op_sel_hi:[1,0]
    v_pk_add_f32 v[238:239], v[238:239], 1.0 op_sel_hi:[1,0]
    v_rcp_f32 v236, v236
    v_rcp_f32 v237, v237
    buffer_load_dwordx4 v0, s[24:27], s71 offen offset:3072 sc1 lds
    v_rcp_f32 v238, v238
    v_rcp_f32 v239, v239
    v_pk_mul_f32 v[108:109], v[236:237], v[108:109]
    v_pk_mul_f32 v[110:111], v[238:239], v[110:111]
    v_pk_mul_f32 v[232:233], v[112:113], v[112:113]
    v_pk_mul_f32 v[234:235], v[114:115], v[114:115]
    v_pk_fma_f32 v[232:233], v[232:233], v[26:27], v[26:27] op_sel:[0,0,1] op_sel_hi:[1,0,1]
    v_pk_fma_f32 v[234:235], v[234:235], v[26:27], v[26:27] op_sel:[0,0,1] op_sel_hi:[1,0,1]
    v_pk_mul_f32 v[232:233], v[232:233], v[112:113]
    v_pk_mul_f32 v[234:235], v[234:235], v[114:115]
    v_exp_f32 v232, v232
    v_exp_f32 v233, v233
    v_exp_f32 v234, v234
    v_exp_f32 v235, v235
    v_pk_add_f32 v[232:233], v[232:233], 1.0 op_sel_hi:[1,0]
    v_pk_add_f32 v[234:235], v[234:235], 1.0 op_sel_hi:[1,0]
    s_add_u32 m0, s70, 0x4000
    s_add_u32 s71, s57, 0x10000
    buffer_load_dwordx4 v0, s[24:27], s71 offen offset:0 sc1 lds
    v_rcp_f32 v232, v232
    v_rcp_f32 v233, v233
    v_rcp_f32 v234, v234
    v_rcp_f32 v235, v235
    v_pk_mul_f32 v[112:113], v[232:233], v[112:113]
    v_pk_mul_f32 v[114:115], v[234:235], v[114:115]
    v_pk_mul_f32 v[236:237], v[116:117], v[116:117]
    v_pk_mul_f32 v[238:239], v[118:119], v[118:119]
    v_pk_fma_f32 v[236:237], v[236:237], v[26:27], v[26:27] op_sel:[0,0,1] op_sel_hi:[1,0,1]
    v_pk_fma_f32 v[238:239], v[238:239], v[26:27], v[26:27] op_sel:[0,0,1] op_sel_hi:[1,0,1]
    v_pk_mul_f32 v[236:237], v[236:237], v[116:117]
    v_pk_mul_f32 v[238:239], v[238:239], v[118:119]
    v_exp_f32 v236, v236
    v_exp_f32 v237, v237
    v_exp_f32 v238, v238
    v_exp_f32 v239, v239
    buffer_load_dwordx4 v0, s[24:27], s71 offen offset:1024 sc1 lds
    v_pk_add_f32 v[236:237], v[236:237], 1.0 op_sel_hi:[1,0]
    v_pk_add_f32 v[238:239], v[238:239], 1.0 op_sel_hi:[1,0]
    v_rcp_f32 v236, v236
    v_rcp_f32 v237, v237
    v_rcp_f32 v238, v238
    v_rcp_f32 v239, v239
    v_pk_mul_f32 v[116:117], v[236:237], v[116:117]
    v_pk_mul_f32 v[118:119], v[238:239], v[118:119]
    v_pk_mul_f32 v[232:233], v[120:121], v[120:121]
    v_pk_mul_f32 v[234:235], v[122:123], v[122:123]
    v_pk_fma_f32 v[232:233], v[232:233], v[26:27], v[26:27] op_sel:[0,0,1] op_sel_hi:[1,0,1]
    v_pk_fma_f32 v[234:235], v[234:235], v[26:27], v[26:27] op_sel:[0,0,1] op_sel_hi:[1,0,1]
    v_pk_mul_f32 v[232:233], v[232:233], v[120:121]
    v_pk_mul_f32 v[234:235], v[234:235], v[122:123]
    v_exp_f32 v232, v232
    v_exp_f32 v233, v233
    buffer_load_dwordx4 v0, s[24:27], s71 offen offset:2048 sc1 lds
    v_exp_f32 v234, v234
    v_exp_f32 v235, v235
    v_pk_add_f32 v[232:233], v[232:233], 1.0 op_sel_hi:[1,0]
    v_pk_add_f32 v[234:235], v[234:235], 1.0 op_sel_hi:[1,0]
    v_rcp_f32 v232, v232
    v_rcp_f32 v233, v233
    v_rcp_f32 v234, v234
    v_rcp_f32 v235, v235
    v_pk_mul_f32 v[120:121], v[232:233], v[120:121]
    v_pk_mul_f32 v[122:123], v[234:235], v[122:123]
    v_pk_mul_f32 v[236:237], v[124:125], v[124:125]
    v_pk_mul_f32 v[238:239], v[126:127], v[126:127]
    v_pk_fma_f32 v[236:237], v[236:237], v[26:27], v[26:27] op_sel:[0,0,1] op_sel_hi:[1,0,1]
    v_pk_fma_f32 v[238:239], v[238:239], v[26:27], v[26:27] op_sel:[0,0,1] op_sel_hi:[1,0,1]
    v_pk_mul_f32 v[236:237], v[236:237], v[124:125]
    v_pk_mul_f32 v[238:239], v[238:239], v[126:127]
    buffer_load_dwordx4 v0, s[24:27], s71 offen offset:3072 sc1 lds
    v_exp_f32 v236, v236
    v_exp_f32 v237, v237
    v_exp_f32 v238, v238
    v_exp_f32 v239, v239
    v_pk_add_f32 v[236:237], v[236:237], 1.0 op_sel_hi:[1,0]
    v_pk_add_f32 v[238:239], v[238:239], 1.0 op_sel_hi:[1,0]
    v_rcp_f32 v236, v236
    v_rcp_f32 v237, v237
    v_rcp_f32 v238, v238
    v_rcp_f32 v239, v239
    v_pk_mul_f32 v[124:125], v[236:237], v[124:125]
    v_pk_mul_f32 v[126:127], v[238:239], v[126:127]
    v_pk_mul_f32 v[232:233], v[128:129], v[128:129]
    v_pk_mul_f32 v[234:235], v[130:131], v[130:131]
    v_pk_fma_f32 v[232:233], v[232:233], v[26:27], v[26:27] op_sel:[0,0,1] op_sel_hi:[1,0,1]
    v_pk_fma_f32 v[234:235], v[234:235], v[26:27], v[26:27] op_sel:[0,0,1] op_sel_hi:[1,0,1]
    s_add_u32 m0, s70, 0x8000
    s_add_u32 s71, s57, 0x14000
    buffer_load_dwordx4 v0, s[24:27], s71 offen offset:0 sc1 lds
    v_pk_mul_f32 v[232:233], v[232:233], v[128:129]
    v_pk_mul_f32 v[234:235], v[234:235], v[130:131]
    v_exp_f32 v232, v232
    v_exp_f32 v233, v233
    v_exp_f32 v234, v234
    v_exp_f32 v235, v235
    v_pk_add_f32 v[232:233], v[232:233], 1.0 op_sel_hi:[1,0]
    v_pk_add_f32 v[234:235], v[234:235], 1.0 op_sel_hi:[1,0]
    v_rcp_f32 v232, v232
    v_rcp_f32 v233, v233
    v_rcp_f32 v234, v234
    v_rcp_f32 v235, v235
    v_pk_mul_f32 v[128:129], v[232:233], v[128:129]
    v_pk_mul_f32 v[130:131], v[234:235], v[130:131]
    v_pk_add_f32 v[34:35], v[104:105], v[106:107]
    v_pk_mul_f32 v[36:37], v[104:105], v[104:105]
    buffer_load_dwordx4 v0, s[24:27], s71 offen offset:1024 sc1 lds
    v_pk_fma_f32 v[36:37], v[106:107], v[106:107], v[36:37]
    v_pk_add_f32 v[34:35], v[34:35], v[108:109]
    v_pk_fma_f32 v[36:37], v[108:109], v[108:109], v[36:37]
    v_pk_add_f32 v[34:35], v[34:35], v[110:111]
    v_pk_fma_f32 v[36:37], v[110:111], v[110:111], v[36:37]
    v_pk_add_f32 v[34:35], v[34:35], v[112:113]
    v_pk_fma_f32 v[36:37], v[112:113], v[112:113], v[36:37]
    v_pk_add_f32 v[34:35], v[34:35], v[114:115]
    v_pk_fma_f32 v[36:37], v[114:115], v[114:115], v[36:37]
    v_pk_add_f32 v[34:35], v[34:35], v[116:117]
    v_pk_fma_f32 v[36:37], v[116:117], v[116:117], v[36:37]
    v_pk_add_f32 v[34:35], v[34:35], v[118:119]
    v_pk_fma_f32 v[36:37], v[118:119], v[118:119], v[36:37]
    v_pk_add_f32 v[34:35], v[34:35], v[120:121]
    v_pk_fma_f32 v[36:37], v[120:121], v[120:121], v[36:37]
    v_pk_add_f32 v[34:35], v[34:35], v[122:123]
    buffer_load_dwordx4 v0, s[24:27], s71 offen offset:2048 sc1 lds
    v_pk_fma_f32 v[36:37], v[122:123], v[122:123], v[36:37]
    v_pk_add_f32 v[34:35], v[34:35], v[124:125]
    v_pk_fma_f32 v[36:37], v[124:125], v[124:125], v[36:37]
    v_pk_add_f32 v[34:35], v[34:35], v[126:127]
    v_pk_fma_f32 v[36:37], v[126:127], v[126:127], v[36:37]
    v_pk_add_f32 v[34:35], v[34:35], v[128:129]
    v_pk_fma_f32 v[36:37], v[128:129], v[128:129], v[36:37]
    v_pk_add_f32 v[34:35], v[34:35], v[130:131]
    v_pk_fma_f32 v[36:37], v[130:131], v[130:131], v[36:37]
    v_add_f32 v32, v34, v35
    v_add_f32 v33, v36, v37
    s_nop 1
    v_permlane16_swap_b32 v32, v33
    v_add_f32 v32, v32, v33
    v_mov_b32 v33, v32
    s_nop 1
    v_permlane32_swap_b32 v32, v33
    v_add_f32 v32, v32, v33
    v_mov_b32 v33, v32
    s_nop 1
    v_permlane16_swap_b32 v32, v33
    s_add_u32 s72, s56, s69
    s_mov_b64 exec, 0xffff
    s_cmp_eq_u32 s55, 0
    s_cbranch_scc1 ool_64
    buffer_store_dwordx2 v[32:33], v20, s[24:27], s72 offen
back_65:
    s_mov_b64 exec, -1
    buffer_load_dwordx4 v0, s[24:27], s71 offen offset:3072 sc1 lds
    s_add_u32 m0, s70, 0xc000
    s_add_u32 s71, s57, 0x18000
    buffer_load_dwordx4 v0, s[24:27], s71 offen offset:0 sc1 lds
    buffer_load_dwordx4 v0, s[24:27], s71 offen offset:1024 sc1 lds
    s_mov_b32 s74, s52
    v_add_u32 v246, s94, v0
    v_add_u32 v247, s95, v0
    s_add_u32 s73, s53, 8192
    s_lshl_b32 s75, s42, 10
    s_add_u32 s75, s75, s47
    s_add_u32 s84, s75, 0x400000
    s_add_u32 s85, s75, 0x402000
    s_add_u32 s76, s54, 0
    s_add_u32 s80, s47, 0x400000
    s_add_u32 s77, s54, 4096
    s_add_u32 s81, s47, 0x401000
    s_add_u32 s78, s54, 8192
    s_add_u32 s82, s47, 0x402000
    s_add_u32 s79, s54, 12288
    s_add_u32 s83, s47, 0x403000
    v_and_b32 v133, 0xf0, v0
    v_mul_u32_u24 v133, 9, v133
    v_lshrrev_b32 v134, 8, v0
    v_lshl_add_u32 v133, v134, 5, v133
    s_mul_i32 s99, s40, 2304
    s_add_u32 s99, s99, 114688
    v_add_u32 v248, s99, v133
    v_lshrrev_b32 v133, 7, v0
    v_lshl_add_u32 v134, v133, 4, v0
    v_add_u32 v249, s99, v134
    v_and_b32 v134, 0x70, v0
    v_lshl_add_u32 v253, v133, 16, v134
    s_lshl_b32 s99, s40, 9
    s_add_u32 s99, s99, s41
    s_lshl_b32 s99, s99, 10
    s_add_u32 s86, s99, s69
    s_add_u32 s87, s86, 0x8000
    s_add_u32 s99, s56, 0x0
    buffer_load_dwordx2 v[36:37], v20, s[24:27], s99 offen sc1
    buffer_load_dwordx2 v[38:39], v20, s[24:27], s99 offen offset:128 sc1
    buffer_load_dwordx4 v0, s[24:27], s71 offen offset:2048 sc1 lds
    buffer_load_dwordx4 v0, s[24:27], s71 offen offset:3072 sc1 lds
    s_add_u32 m0, s70, 0x10000
    s_add_u32 s71, s58, 0x0
    buffer_load_dwordx4 v0, s[24:27], s71 offen offset:0 sc1 lds
    buffer_load_dwordx4 v0, s[24:27], s71 offen offset:1024 sc1 lds
    buffer_load_dwordx4 v0, s[24:27], s71 offen offset:2048 sc1 lds
    buffer_load_dwordx4 v0, s[24:27], s71 offen offset:3072 sc1 lds
    s_add_u32 m0, s70, 0x14000
    s_add_u32 s71, s58, 0x4000
    buffer_load_dwordx4 v0, s[24:27], s71 offen offset:0 sc1 lds
    buffer_load_dwordx4 v0, s[24:27], s71 offen offset:1024 sc1 lds
    buffer_load_dwordx4 v0, s[24:27], s71 offen offset:2048 sc1 lds
    buffer_load_dwordx4 v0, s[24:27], s71 offen offset:3072 sc1 lds
    s_waitcnt vmcnt(10)
    v_add_f32 v32, v36, v38
    v_add_f32 v33, v37, v39
    v_cmp_u_f32 vcc, v32, v33
    s_cbranch_vccnz ool_66
back_67:
    v_permlane16_swap_b32 v32, v33
    v_add_f32 v32, v32, v33
    v_mov_b32 v33, v32
    s_nop 1
    v_permlane32_swap_b32 v32, v33
    v_add_f32 v32, v32, v33
    v_mov_b32 v33, v32
    s_nop 1
    v_permlane16_swap_b32 v32, v33
    v_mul_f32 v34, 0x3a924925, v32
    v_mul_f32 v33, 0x3a924925, v33
    v_fma_f32 v33, -v34, v34, v33
    v_max_f32 v33, 0, v33
    v_add_f32 v33, 0x3727c5ac, v33
    v_rsq_f32 v32, v33
    s_nop 0
    v_mul_f32 v33, -v34, v32
    v_pk_fma_f32 v[104:105], v[104:105], v[32:33], v[32:33] op_sel:[0,0,1] op_sel_hi:[1,0,1]
    v_pk_fma_f32 v[106:107], v[106:107], v[32:33], v[32:33] op_sel:[0,0,1] op_sel_hi:[1,0,1]
    v_pk_fma_f32 v[108:109], v[108:109], v[32:33], v[32:33] op_sel:[0,0,1] op_sel_hi:[1,0,1]
    v_pk_fma_f32 v[110:111], v[110:111], v[32:33], v[32:33] op_sel:[0,0,1] op_sel_hi:[1,0,1]
    v_pk_fma_f32 v[112:113], v[112:113], v[32:33], v[32:33] op_sel:[0,0,1] op_sel_hi:[1,0,1]
    v_pk_fma_f32 v[114:115], v[114:115], v[32:33], v[32:33] op_sel:[0,0,1] op_sel_hi:[1,0,1]
    v_pk_fma_f32 v[116:117], v[116:117], v[32:33], v[32:33] op_sel:[0,0,1] op_sel_hi:[1,0,1]
    v_pk_fma_f32 v[118:119], v[118:119], v[32:33], v[32:33] op_sel:[0,0,1] op_sel_hi:[1,0,1]
    v_pk_fma_f32 v[120:121], v[120:121], v[32:33], v[32:33] op_sel:[0,0,1] op_sel_hi:[1,0,1]
    v_pk_fma_f32 v[122:123], v[122:123], v[32:33], v[32:33] op_sel:[0,0,1] op_sel_hi:[1,0,1]
    v_pk_fma_f32 v[124:125], v[124:125], v[32:33], v[32:33] op_sel:[0,0,1] op_sel_hi:[1,0,1]
    v_pk_fma_f32 v[126:127], v[126:127], v[32:33], v[32:33] op_sel:[0,0,1] op_sel_hi:[1,0,1]
    v_pk_fma_f32 v[128:129], v[128:129], v[32:33], v[32:33] op_sel:[0,0,1] op_sel_hi:[1,0,1]
    v_pk_fma_f32 v[130:131], v[130:131], v[32:33], v[32:33] op_sel:[0,0,1] op_sel_hi:[1,0,1]
    v_cvt_pk_bf16_f32 v228, v104, v105
    v_cvt_pk_bf16_f32 v229, v106, v107
    v_cvt_pk_bf16_f32 v230, v108, v109
    v_cvt_pk_bf16_f32 v231, v110, v111
    s_nop 1
    v_mfma_f32_16x16x32_bf16 v[164:167], v[228:231], v[214:217], 0
    v_mfma_f32_16x16x32_bf16 v[168:171], v[228:231], v[212:215], 0
    v_cvt_pk_bf16_f32 v232, v112, v113
    v_cvt_pk_bf16_f32 v233, v114, v115
    v_cvt_pk_bf16_f32 v234, v116, v117
    v_cvt_pk_bf16_f32 v235, v118, v119
    s_nop 1
    v_mfma_f32_16x16x32_bf16 v[172:175], v[232:235], v[214:217], 0
    v_mfma_f32_16x16x32_bf16 v[176:179], v[232:235], v[212:215], 0
    v_cvt_pk_bf16_f32 v236, v120, v121
    v_cvt_pk_bf16_f32 v237, v122, v123
    v_cvt_pk_bf16_f32 v238, v124, v125
    v_cvt_pk_bf16_f32 v239, v126, v127
    v_cvt_pk_bf16_f32 v192, v164, v165
    v_cvt_pk_bf16_f32 v193, v166, v167
    v_cvt_pk_bf16_f32 v194, v168, v169
    v_cvt_pk_bf16_f32 v195, v170, v171
    s_add_u32 s72, s51, 0x0
    v_mfma_f32_16x16x32_bf16 v[180:183], v[236:239], v[214:217], 0
    v_mfma_f32_16x16x32_bf16 v[184:187], v[236:239], v[212:215], 0
    v_permlane16_swap_b32 v192, v194
    v_permlane16_swap_b32 v193, v195
    buffer_store_dwordx4 v[192:195], v7, s[36:39], s72 offen sc1
    v_cvt_pk_bf16_f32 v240, v128, v129
    v_cvt_pk_bf16_f32 v241, v130, v131
    v_cvt_pk_bf16_f32 v196, v172, v173
    v_cvt_pk_bf16_f32 v197, v174, v175
    v_cvt_pk_bf16_f32 v198, v176, v177
    v_cvt_pk_bf16_f32 v199, v178, v179
    s_add_u32 s72, s51, 0x8000
    v_mfma_f32_16x16x32_bf16 v[188:191], v[240:243], v[214:217], 0
    v_permlane16_swap_b32 v196, v198
    v_permlane16_swap_b32 v197, v199
    buffer_store_dwordx4 v[196:199], v7, s[36:39], s72 offen sc1
    v_cvt_pk_bf16_f32 v200, v180, v181
    v_cvt_pk_bf16_f32 v201, v182, v183
    v_cvt_pk_bf16_f32 v202, v184, v185
    v_cvt_pk_bf16_f32 v203, v186, v187
    s_add_u32 s72, s51, 0x10000
    v_permlane16_swap_b32 v200, v202
    v_permlane16_swap_b32 v201, v203
    buffer_store_dwordx4 v[200:203], v7, s[36:39], s72 offen sc1
    v_cvt_pk_bf16_f32 v204, v188, v189
    v_cvt_pk_bf16_f32 v205, v190, v191
    s_add_u32 s72, s51, 0x18000
    v_permlane16_swap_b32 v204, v206
    v_permlane16_swap_b32 v205, v207
    s_mov_b32 exec_lo, 0xffff
    s_mov_b32 exec_hi, 0xffff
    buffer_store_dwordx4 v[204:207], v7, s[36:39], s72 offen sc1
    s_mov_b64 exec, -1
    s_waitcnt vmcnt(12)
    s_barrier
    ds_read_b128 v[164:167], v252 offset:49152
    ds_read_b128 v[168:171], v252 offset:50176
    ds_read_b128 v[172:175], v252 offset:51200
    ds_read_b128 v[176:179], v252 offset:52224
    ds_read_b128 v[180:183], v252 offset:53248
    ds_read_b128 v[184:187], v252 offset:54272
    ds_read_b128 v[188:191], v252 offset:55296
    ds_read_b128 v[192:195], v252 offset:56320
    ds_read_b128 v[196:199], v252 offset:57344
    ds_read_b128 v[200:203], v252 offset:58368
    ds_read_b128 v[204:207], v252 offset:59392
    ds_read_b128 v[208:211], v252 offset:60416
    s_waitcnt lgkmcnt(10)
    v_mfma_f32_16x16x32_bf16 v[136:139], v[164:167], v[40:43], 0
    ds_read_b128 v[164:167], v252 offset:61440
    v_mfma_f32_16x16x32_bf16 v[140:143], v[168:171], v[40:43], 0
    ds_read_b128 v[168:171], v252 offset:62464
    s_add_u32 m0, s70, 0x18000
    s_add_u32 s71, s58, 0x8000
    buffer_load_dwordx4 v0, s[24:27], s71 offen offset:0 sc1 lds
    s_waitcnt lgkmcnt(10)
    v_mfma_f32_16x16x32_bf16 v[144:147], v[172:175], v[40:43], 0
    ds_read_b128 v[172:175], v252 offset:63488
    v_mfma_f32_16x16x32_bf16 v[148:151], v[176:179], v[40:43], 0
    ds_read_b128 v[176:179], v252 offset:64512
    s_waitcnt lgkmcnt(10)
    v_mfma_f32_16x16x32_bf16 v[152:155], v[180:183], v[40:43], 0
    ds_read_b128 v[180:183], v255 offset:0
    v_mfma_f32_16x16x32_bf16 v[156:159], v[184:187], v[40:43], 0
    ds_read_b128 v[184:187], v255 offset:1024
    buffer_load_dwordx4 v0, s[24:27], s71 offen offset:1024 sc1 lds
    s_waitcnt lgkmcnt(10)
    v_mfma_f32_16x16x32_bf16 v[160:163], v[188:191], v[40:43], 0
    ds_read_b128 v[188:191], v255 offset:2048
    v_mfma_f32_16x16x32_bf16 v[136:139], v[192:195], v[44:47], v[136:139]
    ds_read_b128 v[192:195], v255 offset:3072
    s_waitcnt lgkmcnt(10)
    v_mfma_f32_16x16x32_bf16 v[140:143], v[196:199], v[44:47], v[140:143]
    ds_read_b128 v[196:199], v255 offset:4096
    v_mfma_f32_16x16x32_bf16 v[144:147], v[200:203], v[44:47], v[144:147]
    ds_read_b128 v[200:203], v255 offset:5120
    buffer_load_dwordx4 v0, s[24:27], s71 offen offset:2048 sc1 lds
    s_waitcnt lgkmcnt(10)
    v_mfma_f32_16x16x32_bf16 v[148:151], v[204:207], v[44:47], v[148:151]
    ds_read_b128 v[204:207], v255 offset:6144
    v_mfma_f32_16x16x32_bf16 v[152:155], v[208:211], v[44:47], v[152:155]
    ds_read_b128 v[208:211], v255 offset:7168
    s_waitcnt lgkmcnt(10)
    v_mfma_f32_16x16x32_bf16 v[156:159], v[164:167], v[44:47], v[156:159]
    ds_read_b128 v[164:167], v255 offset:8192
    v_mfma_f32_16x16x32_bf16 v[160:163], v[168:171], v[44:47], v[160:163]
    ds_read_b128 v[168:171], v255 offset:9216
    buffer_load_dwordx4 v0, s[24:27], s71 offen offset:3072 sc1 lds
    s_waitcnt lgkmcnt(10)
    v_mfma_f32_16x16x32_bf16 v[136:139], v[172:175], v[48:51], v[136:139]
    ds_read_b128 v[172:175], v255 offset:10240
    v_mfma_f32_16x16x32_bf16 v[140:143], v[176:179], v[48:51], v[140:143]
    ds_read_b128 v[176:179], v255 offset:11264
    s_waitcnt lgkmcnt(10)
    v_mfma_f32_16x16x32_bf16 v[144:147], v[180:183], v[48:51], v[144:147]
    ds_read_b128 v[180:183], v255 offset:12288
    v_mfma_f32_16x16x32_bf16 v[148:151], v[184:187], v[48:51], v[148:151]
    ds_read_b128 v[184:187], v255 offset:13312
    s_add_u32 s71, s58, 0xc000
    buffer_load_dwordx4 v[104:107], v23, s[24:27], s71 offen offset:0 sc1
    s_waitcnt lgkmcnt(10)
    v_mfma_f32_16x16x32_bf16 v[152:155], v[188:191], v[48:51], v[152:155]
    ds_read_b128 v[188:191], v255 offset:14336
    v_mfma_f32_16x16x32_bf16 v[156:159], v[192:195], v[48:51], v[156:159]
    ds_read_b128 v[192:195], v255 offset:15360
    s_waitcnt lgkmcnt(10)
    v_mfma_f32_16x16x32_bf16 v[160:163], v[196:199], v[48:51], v[160:163]
    ds_read_b128 v[196:199], v255 offset:16384
    v_mfma_f32_16x16x32_bf16 v[136:139], v[200:203], v[52:55], v[136:139]
    ds_read_b128 v[200:203], v255 offset:17408
    buffer_load_dwordx4 v[108:111], v251, s[24:27], s71 offen offset:0 sc1
    s_waitcnt lgkmcnt(10)
    v_mfma_f32_16x16x32_bf16 v[140:143], v[204:207], v[52:55], v[140:143]
    ds_read_b128 v[204:207], v255 offset:18432
    v_mfma_f32_16x16x32_bf16 v[144:147], v[208:211], v[52:55], v[144:147]
    ds_read_b128 v[208:211], v255 offset:19456
    s_waitcnt lgkmcnt(10)
    v_mfma_f32_16x16x32_bf16 v[148:151], v[164:167], v[52:55], v[148:151]
    ds_read_b128 v[164:167], v255 offset:20480
    v_mfma_f32_16x16x32_bf16 v[152:155], v[168:171], v[52:55], v[152:155]
    ds_read_b128 v[168:171], v255 offset:21504
    buffer_load_dwordx4 v[112:115], v23, s[24:27], s71 offen offset:2048 sc1
    s_waitcnt lgkmcnt(10)
    v_mfma_f32_16x16x32_bf16 v[156:159], v[172:175], v[52:55], v[156:159]
    ds_read_b128 v[172:175], v255 offset:22528
    v_mfma_f32_16x16x32_bf16 v[160:163], v[176:179], v[52:55], v[160:163]
    ds_read_b128 v[176:179], v255 offset:23552
    s_waitcnt lgkmcnt(10)
    v_mfma_f32_16x16x32_bf16 v[136:139], v[180:183], v[56:59], v[136:139]
    ds_read_b128 v[180:183], v255 offset:24576
    v_mfma_f32_16x16x32_bf16 v[140:143], v[184:187], v[56:59], v[140:143]
    ds_read_b128 v[184:187], v255 offset:25600
    buffer_load_dwordx4 v[116:119], v251, s[24:27], s71 offen offset:2048 sc1
    s_waitcnt lgkmcnt(10)
    v_mfma_f32_16x16x32_bf16 v[144:147], v[188:191], v[56:59], v[144:147]
    ds_read_b128 v[188:191], v255 offset:26624
    v_mfma_f32_16x16x32_bf16 v[148:151], v[192:195], v[56:59], v[148:151]
    ds_read_b128 v[192:195], v255 offset:27648
    s_waitcnt lgkmcnt(10)
    v_mfma_f32_16x16x32_bf16 v[152:155], v[196:199], v[56:59], v[152:155]
    ds_read_b128 v[196:199], v255 offset:28672
    v_mfma_f32_16x16x32_bf16 v[156:159], v[200:203], v[56:59], v[156:159]
    ds_read_b128 v[200:203], v255 offset:29696
    s_add_u32 s71, s58, 0x10000
    buffer_load_dwordx4 v[120:123], v23, s[24:27], s71 offen offset:0 sc1
    s_waitcnt lgkmcnt(10)
    v_mfma_f32_16x16x32_bf16 v[160:163], v[204:207], v[56:59], v[160:163]
    ds_read_b128 v[204:207], v255 offset:30720
    v_mfma_f32_16x16x32_bf16 v[136:139], v[208:211], v[60:63], v[136:139]
    ds_read_b128 v[208:211], v255 offset:31744
    s_waitcnt lgkmcnt(10)
    v_mfma_f32_16x16x32_bf16 v[140:143], v[164:167], v[60:63], v[140:143]
    ds_read_b128 v[164:167], v0 offset:0
    v_mfma_f32_16x16x32_bf16 v[144:147], v[168:171], v[60:63], v[144:147]
    ds_read_b128 v[168:171], v0 offset:1024
    buffer_load_dwordx4 v[124:127], v251, s[24:27], s71 offen offset:0 sc1
    s_waitcnt lgkmcnt(10)
    v_mfma_f32_16x16x32_bf16 v[148:151], v[172:175], v[60:63], v[148:151]
    ds_read_b128 v[172:175], v0 offset:2048
    v_mfma_f32_16x16x32_bf16 v[152:155], v[176:179], v[60:63], v[152:155]
    ds_read_b128 v[176:179], v0 offset:3072
    s_waitcnt lgkmcnt(10)
    v_mfma_f32_16x16x32_bf16 v[156:159], v[180:183], v[60:63], v[156:159]
    ds_read_b128 v[180:183], v0 offset:4096
    v_mfma_f32_16x16x32_bf16 v[160:163], v[184:187], v[60:63], v[160:163]
    ds_read_b128 v[184:187], v0 offset:5120
    buffer_load_dwordx4 v[128:131], v23, s[24:27], s71 offen offset:2048 sc1
    s_waitcnt vmcnt(11)
    s_barrier
    s_cmp_eq_u32 s40, 0
    s_cbranch_scc0 skip_70
    v_mov_b32 v32, 1
    s_mov_b64 exec, 0xff
    buffer_atomic_add v32, v24, s[24:27], s67 offen sc1
    s_mov_b64 exec, -1
skip_70:
    s_cmp_eq_u32 s43, 0
    s_cbranch_scc0 skip_71
    s_lshr_b32 s99, s2, 3
    s_lshl_b32 s99, s99, 2
    s_add_u32 s99, s99, s40
    s_lshl_b32 s99, s99, 7
    s_sub_u32 s98, s92, L_table-L_k4
    s_subb_u32 s97, s93, 0
    s_add_u32 s98, s98, s99
    s_addc_u32 s97, s97, 0
    v_mov_b32 v38, s98
    v_mov_b32 v39, s97
    s_mov_b64 exec, 1
    global_load_dword v38, v[38:39], off
    s_mov_b64 exec, -1
skip_71:
    s_waitcnt lgkmcnt(10)
    v_mfma_f32_16x16x32_bf16 v[136:139], v[188:191], v[64:67], v[136:139]
    ds_read_b128 v[188:191], v0 offset:6144
    v_mfma_f32_16x16x32_bf16 v[140:143], v[192:195], v[64:67], v[140:143]
    ds_read_b128 v[192:195], v0 offset:7168
    s_waitcnt lgkmcnt(10)
    v_mfma_f32_16x16x32_bf16 v[144:147], v[196:199], v[64:67], v[144:147]
    ds_read_b128 v[196:199], v0 offset:8192
    v_mfma_f32_16x16x32_bf16 v[148:151], v[200:203], v[64:67], v[148:151]
    ds_read_b128 v[200:203], v0 offset:9216
    buffer_load_dwordx4 v[132:135], v251, s[24:27], s71 offen offset:2048 sc1
    s_waitcnt lgkmcnt(10)
    v_mfma_f32_16x16x32_bf16 v[152:155], v[204:207], v[64:67], v[152:155]
    ds_read_b128 v[204:207], v0 offset:10240
    v_mfma_f32_16x16x32_bf16 v[156:159], v[208:211], v[64:67], v[156:159]
    ds_read_b128 v[208:211], v0 offset:11264
    s_waitcnt lgkmcnt(10)
    v_mfma_f32_16x16x32_bf16 v[160:163], v[164:167], v[64:67], v[160:163]
    ds_read_b128 v[164:167], v0 offset:12288
    v_mfma_f32_16x16x32_bf16 v[136:139], v[168:171], v[68:71], v[136:139]
    ds_read_b128 v[168:171], v0 offset:13312
    s_add_u32 s71, s58, 0x14000
    buffer_load_dwordx4 v[212:215], v23, s[24:27], s71 offen offset:0 sc1
    s_waitcnt lgkmcnt(10)
    v_mfma_f32_16x16x32_bf16 v[140:143], v[172:175], v[68:71], v[140:143]
    ds_read_b128 v[172:175], v0 offset:14336
    v_mfma_f32_16x16x32_bf16 v[144:147], v[176:179], v[68:71], v[144:147]
    ds_read_b128 v[176:179], v0 offset:15360
    s_waitcnt lgkmcnt(10)
    v_mfma_f32_16x16x32_bf16 v[148:151], v[180:183], v[68:71], v[148:151]
    ds_read_b128 v[180:183], v0 offset:16384
    v_mfma_f32_16x16x32_bf16 v[152:155], v[184:187], v[68:71], v[152:155]
    ds_read_b128 v[184:187], v0 offset:17408
    buffer_load_dwordx4 v[216:219], v251, s[24:27], s71 offen offset:0 sc1
    s_waitcnt lgkmcnt(10)
    v_mfma_f32_16x16x32_bf16 v[156:159], v[188:191], v[68:71], v[156:159]
    ds_read_b128 v[188:191], v0 offset:18432
    v_mfma_f32_16x16x32_bf16 v[160:163], v[192:195], v[68:71], v[160:163]
    ds_read_b128 v[192:195], v0 offset:19456
    s_waitcnt lgkmcnt(10)
    v_mfma_f32_16x16x32_bf16 v[136:139], v[196:199], v[72:75], v[136:139]
    ds_read_b128 v[196:199], v0 offset:20480
    v_mfma_f32_16x16x32_bf16 v[140:143], v[200:203], v[72:75], v[140:143]
    ds_read_b128 v[200:203], v0 offset:21504
    buffer_load_dwordx4 v[220:223], v23, s[24:27], s71 offen offset:2048 sc1
    s_waitcnt lgkmcnt(10)
    v_mfma_f32_16x16x32_bf16 v[144:147], v[204:207], v[72:75], v[144:147]
    ds_read_b128 v[204:207], v0 offset:22528
    v_mfma_f32_16x16x32_bf16 v[148:151], v[208:211], v[72:75], v[148:151]
    ds_read_b128 v[208:211], v0 offset:23552
    s_waitcnt lgkmcnt(10)
    v_mfma_f32_16x16x32_bf16 v[152:155], v[164:167], v[72:75], v[152:155]
    ds_read_b128 v[164:167], v0 offset:24576
    v_mfma_f32_16x16x32_bf16 v[156:159], v[168:171], v[72:75], v[156:159]
    ds_read_b128 v[168:171], v0 offset:25600
    buffer_load_dwordx4 v[224:227], v251, s[24:27], s71 offen offset:2048 sc1
    s_waitcnt lgkmcnt(10)
    v_mfma_f32_16x16x32_bf16 v[160:163], v[172:175], v[72:75], v[160:163]
    ds_read_b128 v[172:175], v0 offset:26624
    v_mfma_f32_16x16x32_bf16 v[136:139], v[176:179], v[76:79], v[136:139]
    ds_read_b128 v[176:179], v0 offset:27648
    s_waitcnt lgkmcnt(10)
    v_mfma_f32_16x16x32_bf16 v[140:143], v[180:183], v[76:79], v[140:143]
    ds_read_b128 v[180:183], v0 offset:28672
    v_mfma_f32_16x16x32_bf16 v[144:147], v[184:187], v[76:79], v[144:147]
    ds_read_b128 v[184:187], v0 offset:29696
    s_add_u32 s71, s58, 0x18000
    buffer_load_dwordx4 v[228:231], v23, s[24:27], s71 offen offset:0 sc1
    s_waitcnt lgkmcnt(10)
    v_mfma_f32_16x16x32_bf16 v[148:151], v[188:191], v[76:79], v[148:151]
    ds_read_b128 v[188:191], v0 offset:30720
    v_mfma_f32_16x16x32_bf16 v[152:155], v[192:195], v[76:79], v[152:155]
    ds_read_b128 v[192:195], v0 offset:31744
    s_waitcnt lgkmcnt(10)
    v_mfma_f32_16x16x32_bf16 v[156:159], v[196:199], v[76:79], v[156:159]
    ds_read_b128 v[196:199], v0 offset:32768
    v_mfma_f32_16x16x32_bf16 v[160:163], v[200:203], v[76:79], v[160:163]
    ds_read_b128 v[200:203], v0 offset:33792
    buffer_load_dwordx4 v[232:235], v251, s[24:27], s71 offen offset:0 sc1
    s_waitcnt lgkmcnt(10)
    v_mfma_f32_16x16x32_bf16 v[136:139], v[204:207], v[80:83], v[136:139]
    ds_read_b128 v[204:207], v0 offset:34816
    v_mfma_f32_16x16x32_bf16 v[140:143], v[208:211], v[80:83], v[140:143]
    ds_read_b128 v[208:211], v0 offset:35840
    s_waitcnt lgkmcnt(10)
    v_mfma_f32_16x16x32_bf16 v[144:147], v[164:167], v[80:83], v[144:147]
    ds_read_b128 v[164:167], v0 offset:36864
    v_mfma_f32_16x16x32_bf16 v[148:151], v[168:171], v[80:83], v[148:151]
    ds_read_b128 v[168:171], v0 offset:37888
    buffer_load_dwordx4 v[236:239], v23, s[24:27], s71 offen offset:2048 sc1
    s_waitcnt lgkmcnt(10)
    v_mfma_f32_16x16x32_bf16 v[152:155], v[172:175], v[80:83], v[152:155]
    ds_read_b128 v[172:175], v0 offset:38912
    v_mfma_f32_16x16x32_bf16 v[156:159], v[176:179], v[80:83], v[156:159]
    ds_read_b128 v[176:179], v0 offset:39936
    s_waitcnt lgkmcnt(10)
    v_mfma_f32_16x16x32_bf16 v[160:163], v[180:183], v[80:83], v[160:163]
    ds_read_b128 v[180:183], v0 offset:40960
    v_mfma_f32_16x16x32_bf16 v[136:139], v[184:187], v[84:87], v[136:139]
    ds_read_b128 v[184:187], v0 offset:41984
    buffer_load_dwordx4 v[240:243], v251, s[24:27], s71 offen offset:2048 sc1
    s_waitcnt lgkmcnt(10)
    v_mfma_f32_16x16x32_bf16 v[140:143], v[188:191], v[84:87], v[140:143]
    ds_read_b128 v[188:191], v0 offset:43008
    v_mfma_f32_16x16x32_bf16 v[144:147], v[192:195], v[84:87], v[144:147]
    ds_read_b128 v[192:195], v0 offset:44032
    s_waitcnt lgkmcnt(10)
    v_mfma_f32_16x16x32_bf16 v[148:151], v[196:199], v[84:87], v[148:151]
    ds_read_b128 v[196:199], v0 offset:45056
    v_mfma_f32_16x16x32_bf16 v[152:155], v[200:203], v[84:87], v[152:155]
    ds_read_b128 v[200:203], v0 offset:46080
    buffer_load_dwordx4 v[56:59], v23, s[36:39], s74 offen offset:0 sc1
    s_waitcnt lgkmcnt(10)
    v_mfma_f32_16x16x32_bf16 v[156:159], v[204:207], v[84:87], v[156:159]
    ds_read_b128 v[204:207], v0 offset:47104
    v_mfma_f32_16x16x32_bf16 v[160:163], v[208:211], v[84:87], v[160:163]
    ds_read_b128 v[208:211], v0 offset:48128
    s_waitcnt lgkmcnt(10)
    v_mfma_f32_16x16x32_bf16 v[136:139], v[164:167], v[88:91], v[136:139]
    ds_read_b128 v[164:167], v0 offset:49152
    buffer_load_dwordx4 v[60:63], v251, s[36:39], s74 offen offset:0 sc1
    v_mfma_f32_16x16x32_bf16 v[140:143], v[168:171], v[88:91], v[140:143]
    ds_read_b128 v[168:171], v0 offset:50176
    s_waitcnt lgkmcnt(10)
    v_mfma_f32_16x16x32_bf16 v[144:147], v[172:175], v[88:91], v[144:147]
    ds_read_b128 v[172:175], v0 offset:51200
    v_mfma_f32_16x16x32_bf16 v[148:151], v[176:179], v[88:91], v[148:151]
    ds_read_b128 v[176:179], v0 offset:52224
    buffer_load_dwordx4 v[64:67], v23, s[36:39], s74 offen offset:2048 sc1
    s_waitcnt lgkmcnt(10)
    v_mfma_f32_16x16x32_bf16 v[152:155], v[180:183], v[88:91], v[152:155]
    ds_read_b128 v[180:183], v0 offset:53248
    v_mfma_f32_16x16x32_bf16 v[156:159], v[184:187], v[88:91], v[156:159]
    ds_read_b128 v[184:187], v0 offset:54272
    s_waitcnt lgkmcnt(10)
    v_mfma_f32_16x16x32_bf16 v[160:163], v[188:191], v[88:91], v[160:163]
    ds_read_b128 v[188:191], v0 offset:55296
    buffer_load_dwordx4 v[68:71], v251, s[36:39], s74 offen offset:2048 sc1
    v_mfma_f32_16x16x32_bf16 v[136:139], v[192:195], v[92:95], v[136:139]
    ds_read_b128 v[192:195], v0 offset:56320
    s_waitcnt lgkmcnt(10)
    v_mfma_f32_16x16x32_bf16 v[140:143], v[196:199], v[92:95], v[140:143]
    ds_read_b128 v[196:199], v0 offset:57344
    v_mfma_f32_16x16x32_bf16 v[144:147], v[200:203], v[92:95], v[144:147]
    ds_read_b128 v[200:203], v0 offset:58368
    s_add_u32 s74, s74, 4096
    buffer_load_dwordx4 v[72:75], v23, s[36:39], s74 offen offset:0 sc1
    s_waitcnt lgkmcnt(10)
    v_mfma_f32_16x16x32_bf16 v[148:151], v[204:207], v[92:95], v[148:151]
    ds_read_b128 v[204:207], v0 offset:59392
    v_mfma_f32_16x16x32_bf16 v[152:155], v[208:211], v[92:95], v[152:155]
    ds_read_b128 v[208:211], v0 offset:60416
    s_waitcnt lgkmcnt(10)
    v_mfma_f32_16x16x32_bf16 v[156:159], v[164:167], v[92:95], v[156:159]
    ds_read_b128 v[164:167], v0 offset:61440
    buffer_load_dwordx4 v[76:79], v251, s[36:39], s74 offen offset:0 sc1
    v_mfma_f32_16x16x32_bf16 v[160:163], v[168:171], v[92:95], v[160:163]
    ds_read_b128 v[168:171], v0 offset:62464
    s_waitcnt lgkmcnt(10)
    v_mfma_f32_16x16x32_bf16 v[136:139], v[172:175], v[96:99], v[136:139]
    ds_read_b128 v[172:175], v0 offset:63488
    v_mfma_f32_16x16x32_bf16 v[140:143], v[176:179], v[96:99], v[140:143]
    ds_read_b128 v[176:179], v0 offset:64512
    buffer_load_dwordx4 v[80:83], v23, s[36:39], s74 offen offset:2048 sc1
    s_waitcnt lgkmcnt(10)
    v_mfma_f32_16x16x32_bf16 v[144:147], v[180:183], v[96:99], v[144:147]
    v_mfma_f32_16x16x32_bf16 v[148:151], v[184:187], v[96:99], v[148:151]
    s_waitcnt lgkmcnt(8)
    v_mfma_f32_16x16x32_bf16 v[152:155], v[188:191], v[96:99], v[152:155]
    buffer_load_dwordx4 v[84:87], v251, s[36:39], s74 offen offset:2048 sc1
    v_mfma_f32_16x16x32_bf16 v[156:159], v[192:195], v[96:99], v[156:159]
    s_waitcnt lgkmcnt(6)
    v_mfma_f32_16x16x32_bf16 v[160:163], v[196:199], v[96:99], v[160:163]
    v_mfma_f32_16x16x32_bf16 v[136:139], v[200:203], v[100:103], v[136:139]
    s_add_u32 s74, s74, 4096
    buffer_load_dwordx4 v[88:91], v23, s[36:39], s74 offen offset:0 sc1
    s_waitcnt lgkmcnt(4)
    v_mfma_f32_16x16x32_bf16 v[140:143], v[204:207], v[100:103], v[140:143]
    v_mfma_f32_16x16x32_bf16 v[144:147], v[208:211], v[100:103], v[144:147]
    s_waitcnt lgkmcnt(2)
    v_mfma_f32_16x16x32_bf16 v[148:151], v[164:167], v[100:103], v[148:151]
    buffer_load_dwordx4 v[92:95], v251, s[36:39], s74 offen offset:0 sc1
    v_mfma_f32_16x16x32_bf16 v[152:155], v[168:171], v[100:103], v[152:155]
    s_waitcnt lgkmcnt(0)
    v_mfma_f32_16x16x32_bf16 v[156:159], v[172:175], v[100:103], v[156:159]
    v_mfma_f32_16x16x32_bf16 v[160:163], v[176:179], v[100:103], v[160:163]
    buffer_load_dwordx4 v[96:99], v23, s[36:39], s74 offen offset:2048 sc1
    buffer_load_dwordx4 v[100:103], v251, s[36:39], s74 offen offset:2048 sc1
    v_pk_mul_f32 v[164:165], v[136:137], v[136:137]
    v_pk_mul_f32 v[166:167], v[138:139], v[138:139]
    v_pk_fma_f32 v[164:165], v[164:165], v[26:27], v[26:27] op_sel:[0,0,1] op_sel_hi:[1,0,1]
    v_pk_fma_f32 v[166:167], v[166:167], v[26:27], v[26:27] op_sel:[0,0,1] op_sel_hi:[1,0,1]
    v_pk_mul_f32 v[164:165], v[164:165], v[136:137]
    v_pk_mul_f32 v[166:167], v[166:167], v[138:139]
    v_exp_f32 v164, v164
    v_exp_f32 v165, v165
    v_exp_f32 v166, v166
    v_exp_f32 v167, v167
    v_pk_add_f32 v[164:165], v[164:165], 1.0 op_sel_hi:[1,0]
    v_pk_add_f32 v[166:167], v[166:167], 1.0 op_sel_hi:[1,0]
    v_rcp_f32 v164, v164
    v_rcp_f32 v165, v165
    v_rcp_f32 v166, v166
    v_rcp_f32 v167, v167
    v_pk_mul_f32 v[136:137], v[164:165], v[136:137]
    v_pk_mul_f32 v[138:139], v[166:167], v[138:139]
    v_mov_b32 v36, 1
    s_add_u32 s96, s68, s3
    v_mov_b32 v188, v6
    v_mov_b32 v189, v6
    v_mov_b32 v190, v6
    v_mov_b32 v191, v6
    s_barrier
L_k4:
    s_waitcnt vmcnt(10)
    v_cmp_u_f32 vcc, v59, v63
    s_cbranch_vccnz ool_72
back_73:
    v_mfma_f32_16x16x32_bf16 v[196:199], v[56:59], a[0:3], v[188:191]
    v_mfma_f32_16x16x32_bf16 v[200:203], v[56:59], a[64:67], 0
    ds_write_b128 v247, v[240:243] offset:51200
    v_mfma_f32_16x16x32_bf16 v[204:207], v[56:59], a[128:131], 0
    v_mfma_f32_16x16x32_bf16 v[208:211], v[56:59], a[192:195], 0
    s_add_u32 s74, s74, 4096
    buffer_load_dwordx4 v[56:59], v23, s[36:39], s74 offen offset:0 sc1
    v_mfma_f32_16x16x32_bf16 v[196:199], v[60:63], a[4:7], v[196:199]
    v_mfma_f32_16x16x32_bf16 v[200:203], v[60:63], a[68:71], v[200:203]
    ds_write_b128 v246, v[236:239] offset:51200
    v_mfma_f32_16x16x32_bf16 v[204:207], v[60:63], a[132:135], v[204:207]
    s_waitcnt vmcnt(9)
    v_cmp_u_f32 vcc, v67, v71
    v_mfma_f32_16x16x32_bf16 v[208:211], v[60:63], a[196:199], v[208:211]
    s_cbranch_vccnz ool_76
back_77:
    buffer_load_dwordx4 v[60:63], v251, s[36:39], s74 offen offset:0 sc1
    v_mfma_f32_16x16x32_bf16 v[196:199], v[64:67], a[8:11], v[196:199]
    v_mfma_f32_16x16x32_bf16 v[200:203], v[64:67], a[72:75], v[200:203]
    ds_write_b128 v247, v[232:235] offset:49152
    v_mfma_f32_16x16x32_bf16 v[204:207], v[64:67], a[136:139], v[204:207]
    v_mfma_f32_16x16x32_bf16 v[208:211], v[64:67], a[200:203], v[208:211]
    buffer_load_dwordx4 v[64:67], v23, s[36:39], s74 offen offset:2048 sc1
    v_mfma_f32_16x16x32_bf16 v[196:199], v[68:71], a[12:15], v[196:199]
    v_mfma_f32_16x16x32_bf16 v[200:203], v[68:71], a[76:79], v[200:203]
    ds_write_b128 v246, v[228:231] offset:49152
    v_mfma_f32_16x16x32_bf16 v[204:207], v[68:71], a[140:143], v[204:207]
    s_waitcnt vmcnt(9)
    v_cmp_u_f32 vcc, v75, v79
    v_mfma_f32_16x16x32_bf16 v[208:211], v[68:71], a[204:207], v[208:211]
    s_cbranch_vccnz ool_80
back_81:
    buffer_load_dwordx4 v[68:71], v251, s[36:39], s74 offen offset:2048 sc1
    v_mfma_f32_16x16x32_bf16 v[196:199], v[72:75], a[16:19], v[196:199]
    v_mfma_f32_16x16x32_bf16 v[200:203], v[72:75], a[80:83], v[200:203]
    ds_write_b128 v247, v[224:227] offset:34816
    v_mfma_f32_16x16x32_bf16 v[204:207], v[72:75], a[144:147], v[204:207]
    v_mfma_f32_16x16x32_bf16 v[208:211], v[72:75], a[208:211], v[208:211]
    s_add_u32 s74, s74, 4096
    buffer_load_dwordx4 v[72:75], v23, s[36:39], s74 offen offset:0 sc1
    v_mfma_f32_16x16x32_bf16 v[196:199], v[76:79], a[20:23], v[196:199]
    v_mfma_f32_16x16x32_bf16 v[200:203], v[76:79], a[84:87], v[200:203]
    ds_write_b128 v246, v[220:223] offset:34816
    v_mfma_f32_16x16x32_bf16 v[204:207], v[76:79], a[148:151], v[204:207]
    s_waitcnt vmcnt(9)
    v_cmp_u_f32 vcc, v83, v87
    v_mfma_f32_16x16x32_bf16 v[208:211], v[76:79], a[212:215], v[208:211]
    s_cbranch_vccnz ool_84
back_85:
    buffer_load_dwordx4 v[76:79], v251, s[36:39], s74 offen offset:0 sc1
    v_mfma_f32_16x16x32_bf16 v[196:199], v[80:83], a[24:27], v[196:199]
    v_mfma_f32_16x16x32_bf16 v[200:203], v[80:83], a[88:91], v[200:203]
    ds_write_b128 v247, v[216:219] offset:32768
    v_mfma_f32_16x16x32_bf16 v[204:207], v[80:83], a[152:155], v[204:207]
    v_mfma_f32_16x16x32_bf16 v[208:211], v[80:83], a[216:219], v[208:211]
    buffer_load_dwordx4 v[80:83], v23, s[36:39], s74 offen offset:2048 sc1
    v_mfma_f32_16x16x32_bf16 v[196:199], v[84:87], a[28:31], v[196:199]
    v_mfma_f32_16x16x32_bf16 v[200:203], v[84:87], a[92:95], v[200:203]
    ds_write_b128 v246, v[212:215] offset:32768
    v_mfma_f32_16x16x32_bf16 v[204:207], v[84:87], a[156:159], v[204:207]
    s_waitcnt vmcnt(9)
    v_cmp_u_f32 vcc, v91, v95
    v_mfma_f32_16x16x32_bf16 v[208:211], v[84:87], a[220:223], v[208:211]
    s_cbranch_vccnz ool_88
back_89:
    buffer_load_dwordx4 v[84:87], v251, s[36:39], s74 offen offset:2048 sc1
    v_mfma_f32_16x16x32_bf16 v[196:199], v[88:91], a[32:35], v[196:199]
    v_mfma_f32_16x16x32_bf16 v[200:203], v[88:91], a[96:99], v[200:203]
    ds_write_b128 v247, v[132:135] offset:18432
    v_mfma_f32_16x16x32_bf16 v[204:207], v[88:91], a[160:163], v[204:207]
    v_mfma_f32_16x16x32_bf16 v[208:211], v[88:91], a[224:227], v[208:211]
    buffer_load_dword v244, off, s[24:27], s88 sc1
    s_add_u32 s74, s74, 4096
    buffer_load_dwordx4 v[88:91], v23, s[36:39], s74 offen offset:0 sc1
    v_mfma_f32_16x16x32_bf16 v[196:199], v[92:95], a[36:39], v[196:199]
    v_mfma_f32_16x16x32_bf16 v[200:203], v[92:95], a[100:103], v[200:203]
    ds_write_b128 v246, v[128:131] offset:18432
    v_mfma_f32_16x16x32_bf16 v[204:207], v[92:95], a[164:167], v[204:207]
    s_waitcnt vmcnt(10)
    v_cmp_u_f32 vcc, v99, v103
    v_mfma_f32_16x16x32_bf16 v[208:211], v[92:95], a[228:231], v[208:211]
    s_cbranch_vccnz ool_92
back_93:
    buffer_load_dwordx4 v[92:95], v251, s[36:39], s74 offen offset:0 sc1
    v_mfma_f32_16x16x32_bf16 v[196:199], v[96:99], a[40:43], v[196:199]
    v_mfma_f32_16x16x32_bf16 v[200:203], v[96:99], a[104:107], v[200:203]
    ds_write_b128 v247, v[124:127] offset:16384
    v_mfma_f32_16x16x32_bf16 v[204:207], v[96:99], a[168:171], v[204:207]
    v_mfma_f32_16x16x32_bf16 v[208:211], v[96:99], a[232:235], v[208:211]
    buffer_load_dwordx4 v[96:99], v23, s[36:39], s74 offen offset:2048 sc1
    v_mfma_f32_16x16x32_bf16 v[196:199], v[100:103], a[44:47], v[196:199]
    v_mfma_f32_16x16x32_bf16 v[200:203], v[100:103], a[108:111], v[200:203]
    ds_write_b128 v246, v[120:123] offset:16384
    v_mfma_f32_16x16x32_bf16 v[204:207], v[100:103], a[172:175], v[204:207]
    s_waitcnt vmcnt(10)
    v_cmp_u_f32 vcc, v59, v63
    v_mfma_f32_16x16x32_bf16 v[208:211], v[100:103], a[236:239], v[208:211]
    s_cbranch_vccnz ool_96
back_97:
    buffer_load_dwordx4 v[100:103], v251, s[36:39], s74 offen offset:2048 sc1
    v_mfma_f32_16x16x32_bf16 v[196:199], v[56:59], a[48:51], v[196:199]
    v_mfma_f32_16x16x32_bf16 v[200:203], v[56:59], a[112:115], v[200:203]
    ds_write_b128 v247, v[116:119] offset:2048
    v_mfma_f32_16x16x32_bf16 v[204:207], v[56:59], a[176:179], v[204:207]
    v_mfma_f32_16x16x32_bf16 v[208:211], v[56:59], a[240:243], v[208:211]
    s_add_u32 s74, s74, 4096
    buffer_load_dwordx4 v[56:59], v23, s[36:39], s74 offen offset:0 sc1
    v_mfma_f32_16x16x32_bf16 v[196:199], v[60:63], a[52:55], v[196:199]
    v_mfma_f32_16x16x32_bf16 v[200:203], v[60:63], a[116:119], v[200:203]
    ds_write_b128 v246, v[112:115] offset:2048
    v_mfma_f32_16x16x32_bf16 v[204:207], v[60:63], a[180:183], v[204:207]
    s_waitcnt vmcnt(10)
    v_cmp_u_f32 vcc, v67, v71
    v_mfma_f32_16x16x32_bf16 v[208:211], v[60:63], a[244:247], v[208:211]
    s_cbranch_vccnz ool_100
back_101:
    buffer_load_dwordx4 v[60:63], v251, s[36:39], s74 offen offset:0 sc1
    v_mfma_f32_16x16x32_bf16 v[196:199], v[64:67], a[56:59], v[196:199]
    v_mfma_f32_16x16x32_bf16 v[200:203], v[64:67], a[120:123], v[200:203]
    ds_write_b128 v247, v[108:111] offset:0
    v_mfma_f32_16x16x32_bf16 v[204:207], v[64:67], a[184:187], v[204:207]
    v_mfma_f32_16x16x32_bf16 v[208:211], v[64:67], a[248:251], v[208:211]
    buffer_load_dwordx4 v[64:67], v23, s[36:39], s74 offen offset:2048 sc1
    v_mfma_f32_16x16x32_bf16 v[196:199], v[68:71], a[60:63], v[196:199]
    v_mfma_f32_16x16x32_bf16 v[200:203], v[68:71], a[124:127], v[200:203]
    ds_write_b128 v246, v[104:107] offset:0
    v_mfma_f32_16x16x32_bf16 v[204:207], v[68:71], a[188:191], v[204:207]
    s_waitcnt vmcnt(10)
    v_cmp_u_f32 vcc, v75, v79
    v_mfma_f32_16x16x32_bf16 v[208:211], v[68:71], a[252:255], v[208:211]
    s_cbranch_vccnz ool_104
back_105:
    buffer_load_dwordx4 v[68:71], v251, s[36:39], s74 offen offset:2048 sc1
    v_mfma_f32_16x16x32_bf16 v[212:215], v[72:75], a[0:3], v[188:191]
    v_mul_f32 v32, v140, v140
    v_mfma_f32_16x16x32_bf16 v[216:219], v[72:75], a[64:67], 0
    v_mul_f32 v33, v141, v141
    v_mfma_f32_16x16x32_bf16 v[220:223], v[72:75], a[128:131], 0
    v_mul_f32 v34, v142, v142
    v_mfma_f32_16x16x32_bf16 v[224:227], v[72:75], a[192:195], 0
    v_mul_f32 v35, v143, v143
    s_add_u32 s74, s74, 4096
    buffer_load_dwordx4 v[72:75], v23, s[36:39], s74 offen offset:0 sc1
    v_mfma_f32_16x16x32_bf16 v[212:215], v[76:79], a[4:7], v[212:215]
    ds_write_b128 v28, v[200:203] offset:0
    v_mfma_f32_16x16x32_bf16 v[216:219], v[76:79], a[68:71], v[216:219]
    ds_write_b128 v29, v[204:207] offset:0
    v_mfma_f32_16x16x32_bf16 v[220:223], v[76:79], a[132:135], v[220:223]
    ds_write_b128 v30, v[208:211] offset:0
    s_waitcnt vmcnt(10)
    v_cmp_u_f32 vcc, v83, v87
    v_mfma_f32_16x16x32_bf16 v[224:227], v[76:79], a[196:199], v[224:227]
    v_fma_f32 v32, v32, v26, v27
    s_cbranch_vccnz ool_108
back_109:
    buffer_load_dwordx4 v[76:79], v251, s[36:39], s74 offen offset:0 sc1
    v_mfma_f32_16x16x32_bf16 v[212:215], v[80:83], a[8:11], v[212:215]
    v_fma_f32 v33, v33, v26, v27
    v_mfma_f32_16x16x32_bf16 v[216:219], v[80:83], a[72:75], v[216:219]
    v_fma_f32 v34, v34, v26, v27
    v_mfma_f32_16x16x32_bf16 v[220:223], v[80:83], a[136:139], v[220:223]
    v_fma_f32 v35, v35, v26, v27
    v_mfma_f32_16x16x32_bf16 v[224:227], v[80:83], a[200:203], v[224:227]
    v_mul_f32 v32, v32, v140
    buffer_load_dwordx4 v[80:83], v23, s[36:39], s74 offen offset:2048 sc1
    v_mfma_f32_16x16x32_bf16 v[212:215], v[84:87], a[12:15], v[212:215]
    v_mul_f32 v33, v33, v141
    v_mfma_f32_16x16x32_bf16 v[216:219], v[84:87], a[76:79], v[216:219]
    v_mul_f32 v34, v34, v142
    v_mfma_f32_16x16x32_bf16 v[220:223], v[84:87], a[140:143], v[220:223]
    v_mul_f32 v35, v35, v143
    s_waitcnt vmcnt(9)
    v_cmp_u_f32 vcc, v91, v95
    v_mfma_f32_16x16x32_bf16 v[224:227], v[84:87], a[204:207], v[224:227]
    v_exp_f32 v32, v32
    s_cbranch_vccnz ool_112
back_113:
    buffer_load_dwordx4 v[84:87], v251, s[36:39], s74 offen offset:2048 sc1
    v_mfma_f32_16x16x32_bf16 v[212:215], v[88:91], a[16:19], v[212:215]
    v_exp_f32 v33, v33
    v_mfma_f32_16x16x32_bf16 v[216:219], v[88:91], a[80:83], v[216:219]
    v_exp_f32 v34, v34
    v_mfma_f32_16x16x32_bf16 v[220:223], v[88:91], a[144:147], v[220:223]
    v_exp_f32 v35, v35
    v_mfma_f32_16x16x32_bf16 v[224:227], v[88:91], a[208:211], v[224:227]
    v_add_f32 v32, 1.0, v32
    v_cmp_ne_u32 vcc, 32, v244
    s_cbranch_vccnz ool_116
back_117:
    s_add_u32 s74, s74, 4096
    buffer_load_dwordx4 v[88:91], v23, s[36:39], s74 offen offset:0 sc1
    v_mfma_f32_16x16x32_bf16 v[212:215], v[92:95], a[20:23], v[212:215]
    v_add_f32 v33, 1.0, v33
    v_mfma_f32_16x16x32_bf16 v[216:219], v[92:95], a[84:87], v[216:219]
    v_add_f32 v34, 1.0, v34
    v_mfma_f32_16x16x32_bf16 v[220:223], v[92:95], a[148:151], v[220:223]
    v_add_f32 v35, 1.0, v35
    s_waitcnt vmcnt(9)
    v_cmp_u_f32 vcc, v99, v103
    v_mfma_f32_16x16x32_bf16 v[224:227], v[92:95], a[212:215], v[224:227]
    v_rcp_f32 v32, v32
    s_cbranch_vccnz ool_120
back_121:
    buffer_load_dwordx4 v[92:95], v251, s[36:39], s74 offen offset:0 sc1
    v_mfma_f32_16x16x32_bf16 v[212:215], v[96:99], a[24:27], v[212:215]
    v_rcp_f32 v33, v33
    v_mfma_f32_16x16x32_bf16 v[216:219], v[96:99], a[88:91], v[216:219]
    v_rcp_f32 v34, v34
    v_mfma_f32_16x16x32_bf16 v[220:223], v[96:99], a[152:155], v[220:223]
    v_rcp_f32 v35, v35
    v_mfma_f32_16x16x32_bf16 v[224:227], v[96:99], a[216:219], v[224:227]
    v_mul_f32 v140, v32, v140
    buffer_load_dwordx4 v[96:99], v23, s[36:39], s74 offen offset:2048 sc1
    v_mfma_f32_16x16x32_bf16 v[212:215], v[100:103], a[28:31], v[212:215]
    v_mul_f32 v141, v33, v141
    v_mfma_f32_16x16x32_bf16 v[216:219], v[100:103], a[92:95], v[216:219]
    v_mul_f32 v142, v34, v142
    v_mfma_f32_16x16x32_bf16 v[220:223], v[100:103], a[156:159], v[220:223]
    v_mul_f32 v143, v35, v143
    s_waitcnt vmcnt(9)
    v_cmp_u_f32 vcc, v59, v63
    v_mfma_f32_16x16x32_bf16 v[224:227], v[100:103], a[220:223], v[224:227]
    v_mul_f32 v32, v160, v160
    s_cbranch_vccnz ool_124
back_125:
    buffer_load_dwordx4 v[100:103], v251, s[36:39], s74 offen offset:2048 sc1
    v_mfma_f32_16x16x32_bf16 v[212:215], v[56:59], a[32:35], v[212:215]
    v_mul_f32 v33, v161, v161
    v_mfma_f32_16x16x32_bf16 v[216:219], v[56:59], a[96:99], v[216:219]
    v_mul_f32 v34, v162, v162
    v_mfma_f32_16x16x32_bf16 v[220:223], v[56:59], a[160:163], v[220:223]
    v_mul_f32 v35, v163, v163
    v_mfma_f32_16x16x32_bf16 v[224:227], v[56:59], a[224:227], v[224:227]
    v_fma_f32 v32, v32, v26, v27
    s_add_u32 s74, s74, 4096
    buffer_load_dwordx4 v[56:59], v23, s[36:39], s74 offen offset:0 sc1
    v_mfma_f32_16x16x32_bf16 v[212:215], v[60:63], a[36:39], v[212:215]
    v_fma_f32 v33, v33, v26, v27
    v_mfma_f32_16x16x32_bf16 v[216:219], v[60:63], a[100:103], v[216:219]
    v_fma_f32 v34, v34, v26, v27
    v_mfma_f32_16x16x32_bf16 v[220:223], v[60:63], a[164:167], v[220:223]
    v_fma_f32 v35, v35, v26, v27
    s_waitcnt vmcnt(9)
    v_cmp_u_f32 vcc, v67, v71
    v_mfma_f32_16x16x32_bf16 v[224:227], v[60:63], a[228:231], v[224:227]
    v_mul_f32 v32, v32, v160
    s_cbranch_vccnz ool_128
back_129:
    buffer_load_dwordx4 v[60:63], v251, s[36:39], s74 offen offset:0 sc1
    v_mfma_f32_16x16x32_bf16 v[212:215], v[64:67], a[40:43], v[212:215]
    v_mul_f32 v33, v33, v161
    v_mfma_f32_16x16x32_bf16 v[216:219], v[64:67], a[104:107], v[216:219]
    v_mul_f32 v34, v34, v162
    v_mfma_f32_16x16x32_bf16 v[220:223], v[64:67], a[168:171], v[220:223]
    v_mul_f32 v35, v35, v163
    v_mfma_f32_16x16x32_bf16 v[224:227], v[64:67], a[232:235], v[224:227]
    v_exp_f32 v32, v32
    buffer_load_dwordx4 v[64:67], v23, s[36:39], s74 offen offset:2048 sc1
    v_mfma_f32_16x16x32_bf16 v[212:215], v[68:71], a[44:47], v[212:215]
    v_exp_f32 v33, v33
    v_mfma_f32_16x16x32_bf16 v[216:219], v[68:71], a[108:111], v[216:219]
    v_exp_f32 v34, v34
    v_mfma_f32_16x16x32_bf16 v[220:223], v[68:71], a[172:175], v[220:223]
    v_exp_f32 v35, v35
    s_waitcnt vmcnt(9)
    v_cmp_u_f32 vcc, v75, v79
    v_mfma_f32_16x16x32_bf16 v[224:227], v[68:71], a[236:239], v[224:227]
    v_add_f32 v32, 1.0, v32
    s_cbranch_vccnz ool_132
back_133:
    buffer_load_dwordx4 v[68:71], v251, s[36:39], s74 offen offset:2048 sc1
    v_mfma_f32_16x16x32_bf16 v[212:215], v[72:75], a[48:51], v[212:215]
    v_add_f32 v33, 1.0, v33
    v_mfma_f32_16x16x32_bf16 v[216:219], v[72:75], a[112:115], v[216:219]
    v_add_f32 v34, 1.0, v34
    v_mfma_f32_16x16x32_bf16 v[220:223], v[72:75], a[176:179], v[220:223]
    v_add_f32 v35, 1.0, v35
    v_mfma_f32_16x16x32_bf16 v[224:227], v[72:75], a[240:243], v[224:227]
    v_rcp_f32 v32, v32
    s_add_u32 s74, s74, 4096
    buffer_load_dwordx4 v[72:75], v23, s[36:39], s74 offen offset:0 sc1
    v_mfma_f32_16x16x32_bf16 v[212:215], v[76:79], a[52:55], v[212:215]
    v_rcp_f32 v33, v33
    v_mfma_f32_16x16x32_bf16 v[216:219], v[76:79], a[116:119], v[216:219]
    v_rcp_f32 v34, v34
    v_mfma_f32_16x16x32_bf16 v[220:223], v[76:79], a[180:183], v[220:223]
    v_rcp_f32 v35, v35
    s_waitcnt vmcnt(9)
    v_cmp_u_f32 vcc, v83, v87
    v_mfma_f32_16x16x32_bf16 v[224:227], v[76:79], a[244:247], v[224:227]
    v_mul_f32 v160, v32, v160
    s_cbranch_vccnz ool_136
back_137:
    buffer_load_dwordx4 v[76:79], v251, s[36:39], s74 offen offset:0 sc1
    v_mfma_f32_16x16x32_bf16 v[212:215], v[80:83], a[56:59], v[212:215]
    v_mul_f32 v161, v33, v161
    v_mfma_f32_16x16x32_bf16 v[216:219], v[80:83], a[120:123], v[216:219]
    v_mul_f32 v162, v34, v162
    v_mfma_f32_16x16x32_bf16 v[220:223], v[80:83], a[184:187], v[220:223]
    v_mul_f32 v163, v35, v163
    v_mfma_f32_16x16x32_bf16 v[224:227], v[80:83], a[248:251], v[224:227]
    buffer_load_dwordx4 v[80:83], v23, s[36:39], s74 offen offset:2048 sc1
    v_mfma_f32_16x16x32_bf16 v[212:215], v[84:87], a[60:63], v[212:215]
    v_mfma_f32_16x16x32_bf16 v[216:219], v[84:87], a[124:127], v[216:219]
    v_mfma_f32_16x16x32_bf16 v[220:223], v[84:87], a[188:191], v[220:223]
    v_mfma_f32_16x16x32_bf16 v[224:227], v[84:87], a[252:255], v[224:227]
    buffer_load_dwordx4 v[84:87], v251, s[36:39], s74 offen offset:2048 sc1
    s_waitcnt vmcnt(10)
    v_mfma_f32_16x16x32_bf16 v[192:195], v[88:91], a[0:3], v[188:191]
    v_mfma_f32_16x16x32_bf16 v[200:203], v[88:91], a[64:67], 0
    v_mfma_f32_16x16x32_bf16 v[204:207], v[88:91], a[128:131], 0
    v_mfma_f32_16x16x32_bf16 v[208:211], v[88:91], a[192:195], 0
    s_add_u32 s74, s74, 4096
    buffer_load_dwordx4 v[88:91], v23, s[36:39], s74 offen offset:0 sc1
    v_mfma_f32_16x16x32_bf16 v[192:195], v[92:95], a[4:7], v[192:195]
    ds_write_b128 v28, v[216:219] offset:12288
    v_mfma_f32_16x16x32_bf16 v[200:203], v[92:95], a[68:71], v[200:203]
    ds_write_b128 v29, v[220:223] offset:12288
    v_mfma_f32_16x16x32_bf16 v[204:207], v[92:95], a[132:135], v[204:207]
    ds_write_b128 v30, v[224:227] offset:12288
    v_mfma_f32_16x16x32_bf16 v[208:211], v[92:95], a[196:199], v[208:211]
    buffer_load_dwordx4 v[92:95], v251, s[36:39], s74 offen offset:0 sc1
    s_waitcnt vmcnt(10)
    v_mfma_f32_16x16x32_bf16 v[192:195], v[96:99], a[8:11], v[192:195]
    v_mfma_f32_16x16x32_bf16 v[200:203], v[96:99], a[72:75], v[200:203]
    v_mfma_f32_16x16x32_bf16 v[204:207], v[96:99], a[136:139], v[204:207]
    v_mfma_f32_16x16x32_bf16 v[208:211], v[96:99], a[200:203], v[208:211]
    buffer_load_dwordx4 v[96:99], v23, s[36:39], s74 offen offset:2048 sc1
    v_mfma_f32_16x16x32_bf16 v[192:195], v[100:103], a[12:15], v[192:195]
    v_mfma_f32_16x16x32_bf16 v[200:203], v[100:103], a[76:79], v[200:203]
    v_mfma_f32_16x16x32_bf16 v[204:207], v[100:103], a[140:143], v[204:207]
    v_mfma_f32_16x16x32_bf16 v[208:211], v[100:103], a[204:207], v[208:211]
    buffer_load_dwordx4 v[100:103], v251, s[36:39], s74 offen offset:2048 sc1
    s_waitcnt vmcnt(10)
    v_mfma_f32_16x16x32_bf16 v[192:195], v[56:59], a[16:19], v[192:195]
    s_waitcnt lgkmcnt(0)
    v_mfma_f32_16x16x32_bf16 v[200:203], v[56:59], a[80:83], v[200:203]
    s_barrier
    v_mfma_f32_16x16x32_bf16 v[204:207], v[56:59], a[144:147], v[204:207]
    ds_read_b128 v[164:167], v31 offset:0
    v_mfma_f32_16x16x32_bf16 v[208:211], v[56:59], a[208:211], v[208:211]
    ds_read_b128 v[168:171], v31 offset:1024
    s_add_u32 s74, s74, 4096
    buffer_load_dwordx4 v[56:59], v23, s[36:39], s74 offen offset:0 sc1
    v_mfma_f32_16x16x32_bf16 v[192:195], v[60:63], a[20:23], v[192:195]
    ds_read_b128 v[172:175], v31 offset:2048
    v_mfma_f32_16x16x32_bf16 v[200:203], v[60:63], a[84:87], v[200:203]
    ds_read_b128 v[228:231], v31 offset:12288
    v_mfma_f32_16x16x32_bf16 v[204:207], v[60:63], a[148:151], v[204:207]
    ds_read_b128 v[232:235], v31 offset:13312
    v_mfma_f32_16x16x32_bf16 v[208:211], v[60:63], a[212:215], v[208:211]
    ds_read_b128 v[236:239], v31 offset:14336
    buffer_load_dwordx4 v[60:63], v251, s[36:39], s74 offen offset:0 sc1
    s_waitcnt vmcnt(10)
    v_mfma_f32_16x16x32_bf16 v[192:195], v[64:67], a[24:27], v[192:195]
    v_mfma_f32_16x16x32_bf16 v[200:203], v[64:67], a[88:91], v[200:203]
    v_mfma_f32_16x16x32_bf16 v[204:207], v[64:67], a[152:155], v[204:207]
    s_waitcnt lgkmcnt(5)
    v_add_f32 v196, v164, v196
    v_add_f32 v197, v165, v197
    v_mfma_f32_16x16x32_bf16 v[208:211], v[64:67], a[216:219], v[208:211]
    v_add_f32 v198, v166, v198
    buffer_load_dwordx4 v[64:67], v23, s[36:39], s74 offen offset:2048 sc1
    v_mfma_f32_16x16x32_bf16 v[192:195], v[68:71], a[28:31], v[192:195]
    v_add_f32 v199, v167, v199
    s_waitcnt lgkmcnt(4)
    v_add_f32 v196, v168, v196
    v_mfma_f32_16x16x32_bf16 v[200:203], v[68:71], a[92:95], v[200:203]
    v_add_f32 v197, v169, v197
    v_add_f32 v198, v170, v198
    v_mfma_f32_16x16x32_bf16 v[204:207], v[68:71], a[156:159], v[204:207]
    v_add_f32 v199, v171, v199
    s_waitcnt lgkmcnt(3)
    v_add_f32 v196, v172, v196
    v_mfma_f32_16x16x32_bf16 v[208:211], v[68:71], a[220:223], v[208:211]
    v_add_f32 v197, v173, v197
    buffer_load_dwordx4 v[68:71], v251, s[36:39], s74 offen offset:2048 sc1
    s_waitcnt vmcnt(10)
    v_mfma_f32_16x16x32_bf16 v[192:195], v[72:75], a[32:35], v[192:195]
    v_add_f32 v198, v174, v198
    v_add_f32 v199, v175, v199
    v_mfma_f32_16x16x32_bf16 v[200:203], v[72:75], a[96:99], v[200:203]
    v_mul_f32 v196, v136, v196
    v_mul_f32 v197, v137, v197
    v_mfma_f32_16x16x32_bf16 v[204:207], v[72:75], a[160:163], v[204:207]
    v_mul_f32 v198, v138, v198
    v_mul_f32 v199, v139, v199
    v_mfma_f32_16x16x32_bf16 v[208:211], v[72:75], a[224:227], v[208:211]
    v_cvt_pk_bf16_f32 v240, v196, v197
    s_add_u32 s74, s74, 4096
    buffer_load_dwordx4 v[72:75], v23, s[36:39], s74 offen offset:0 sc1
    v_mfma_f32_16x16x32_bf16 v[192:195], v[76:79], a[36:39], v[192:195]
    v_cvt_pk_bf16_f32 v241, v198, v199
    s_waitcnt lgkmcnt(2)
    v_add_f32 v212, v228, v212
    v_mfma_f32_16x16x32_bf16 v[200:203], v[76:79], a[100:103], v[200:203]
    v_add_f32 v213, v229, v213
    v_add_f32 v214, v230, v214
    v_mfma_f32_16x16x32_bf16 v[204:207], v[76:79], a[164:167], v[204:207]
    v_add_f32 v215, v231, v215
    s_waitcnt lgkmcnt(1)
    v_add_f32 v212, v232, v212
    v_mfma_f32_16x16x32_bf16 v[208:211], v[76:79], a[228:231], v[208:211]
    v_add_f32 v213, v233, v213
    buffer_load_dwordx4 v[76:79], v251, s[36:39], s74 offen offset:0 sc1
    s_waitcnt vmcnt(10)
    v_mfma_f32_16x16x32_bf16 v[192:195], v[80:83], a[40:43], v[192:195]
    v_add_f32 v214, v234, v214
    v_add_f32 v215, v235, v215
    v_mfma_f32_16x16x32_bf16 v[200:203], v[80:83], a[104:107], v[200:203]
    s_waitcnt lgkmcnt(0)
    v_add_f32 v212, v236, v212
    v_add_f32 v213, v237, v213
    v_mfma_f32_16x16x32_bf16 v[204:207], v[80:83], a[168:171], v[204:207]
    v_add_f32 v214, v238, v214
    v_add_f32 v215, v239, v215
    v_mfma_f32_16x16x32_bf16 v[208:211], v[80:83], a[232:235], v[208:211]
    v_mul_f32 v212, v140, v212
    buffer_load_dwordx4 v[80:83], v23, s[36:39], s74 offen offset:2048 sc1
    v_mfma_f32_16x16x32_bf16 v[192:195], v[84:87], a[44:47], v[192:195]
    v_mul_f32 v213, v141, v213
    v_mul_f32 v214, v142, v214
    v_mfma_f32_16x16x32_bf16 v[200:203], v[84:87], a[108:111], v[200:203]
    v_mul_f32 v215, v143, v215
    v_cvt_pk_bf16_f32 v242, v212, v213
    v_mfma_f32_16x16x32_bf16 v[204:207], v[84:87], a[172:175], v[204:207]
    v_cvt_pk_bf16_f32 v243, v214, v215
    s_cmp_eq_u32 s55, 0
    s_cbranch_scc1 ool_140
    buffer_store_dwordx4 v[240:243], v0, s[36:39], s53 offen offset:0
back_141:
    v_mfma_f32_16x16x32_bf16 v[208:211], v[84:87], a[236:239], v[208:211]
    buffer_load_dwordx4 v[84:87], v251, s[36:39], s74 offen offset:2048 sc1
    s_waitcnt vmcnt(11)
    v_mfma_f32_16x16x32_bf16 v[192:195], v[88:91], a[48:51], v[192:195]
    v_mfma_f32_16x16x32_bf16 v[200:203], v[88:91], a[112:115], v[200:203]
    v_mfma_f32_16x16x32_bf16 v[204:207], v[88:91], a[176:179], v[204:207]
    v_mfma_f32_16x16x32_bf16 v[208:211], v[88:91], a[240:243], v[208:211]
    s_add_u32 s74, s74, 4096
    buffer_load_dwordx4 v[88:91], v23, s[36:39], s74 offen offset:0 sc1
    v_mfma_f32_16x16x32_bf16 v[192:195], v[92:95], a[52:55], v[192:195]
    v_mfma_f32_16x16x32_bf16 v[200:203], v[92:95], a[116:119], v[200:203]
    v_mfma_f32_16x16x32_bf16 v[204:207], v[92:95], a[180:183], v[204:207]
    v_mfma_f32_16x16x32_bf16 v[208:211], v[92:95], a[244:247], v[208:211]
    buffer_load_dwordx4 v[92:95], v251, s[36:39], s74 offen offset:0 sc1
    s_waitcnt vmcnt(11)
    v_mfma_f32_16x16x32_bf16 v[192:195], v[96:99], a[56:59], v[192:195]
    v_mfma_f32_16x16x32_bf16 v[200:203], v[96:99], a[120:123], v[200:203]
    v_mfma_f32_16x16x32_bf16 v[204:207], v[96:99], a[184:187], v[204:207]
    v_mfma_f32_16x16x32_bf16 v[208:211], v[96:99], a[248:251], v[208:211]
    buffer_load_dwordx4 v[96:99], v23, s[36:39], s74 offen offset:2048 sc1
    v_mfma_f32_16x16x32_bf16 v[192:195], v[100:103], a[60:63], v[192:195]
    v_mfma_f32_16x16x32_bf16 v[200:203], v[100:103], a[124:127], v[200:203]
    v_mfma_f32_16x16x32_bf16 v[204:207], v[100:103], a[188:191], v[204:207]
    v_mfma_f32_16x16x32_bf16 v[208:211], v[100:103], a[252:255], v[208:211]
    buffer_load_dwordx4 v[100:103], v251, s[36:39], s74 offen offset:2048 sc1
    s_waitcnt vmcnt(11)
    v_mfma_f32_16x16x32_bf16 v[196:199], v[56:59], a[0:3], v[188:191]
    v_mul_f32 v32, v144, v144
    v_mfma_f32_16x16x32_bf16 v[216:219], v[56:59], a[64:67], 0
    v_mul_f32 v33, v145, v145
    v_mfma_f32_16x16x32_bf16 v[220:223], v[56:59], a[128:131], 0
    v_mul_f32 v34, v146, v146
    v_mfma_f32_16x16x32_bf16 v[224:227], v[56:59], a[192:195], 0
    v_mul_f32 v35, v147, v147
    s_add_u32 s74, s74, 4096
    buffer_load_dwordx4 v[56:59], v23, s[36:39], s74 offen offset:0 sc1
    v_mfma_f32_16x16x32_bf16 v[196:199], v[60:63], a[4:7], v[196:199]
    ds_write_b128 v28, v[200:203] offset:24576
    v_mfma_f32_16x16x32_bf16 v[216:219], v[60:63], a[68:71], v[216:219]
    ds_write_b128 v29, v[204:207] offset:24576
    v_mfma_f32_16x16x32_bf16 v[220:223], v[60:63], a[132:135], v[220:223]
    ds_write_b128 v30, v[208:211] offset:24576
    v_mfma_f32_16x16x32_bf16 v[224:227], v[60:63], a[196:199], v[224:227]
    v_fma_f32 v32, v32, v26, v27
    buffer_load_dwordx4 v[60:63], v251, s[36:39], s74 offen offset:0 sc1
    s_waitcnt vmcnt(11)
    v_mfma_f32_16x16x32_bf16 v[196:199], v[64:67], a[8:11], v[196:199]
    v_fma_f32 v33, v33, v26, v27
    v_mfma_f32_16x16x32_bf16 v[216:219], v[64:67], a[72:75], v[216:219]
    v_fma_f32 v34, v34, v26, v27
    v_mfma_f32_16x16x32_bf16 v[220:223], v[64:67], a[136:139], v[220:223]
    v_fma_f32 v35, v35, v26, v27
    v_mfma_f32_16x16x32_bf16 v[224:227], v[64:67], a[200:203], v[224:227]
    v_mul_f32 v32, v32, v144
    buffer_load_dwordx4 v[64:67], v23, s[36:39], s74 offen offset:2048 sc1
    v_mfma_f32_16x16x32_bf16 v[196:199], v[68:71], a[12:15], v[196:199]
    v_mul_f32 v33, v33, v145
    v_mfma_f32_16x16x32_bf16 v[216:219], v[68:71], a[76:79], v[216:219]
    v_mul_f32 v34, v34, v146
    v_mfma_f32_16x16x32_bf16 v[220:223], v[68:71], a[140:143], v[220:223]
    v_mul_f32 v35, v35, v147
    v_mfma_f32_16x16x32_bf16 v[224:227], v[68:71], a[204:207], v[224:227]
    v_exp_f32 v32, v32
    buffer_load_dwordx4 v[68:71], v251, s[36:39], s74 offen offset:2048 sc1
    s_waitcnt vmcnt(11)
    v_mfma_f32_16x16x32_bf16 v[196:199], v[72:75], a[16:19], v[196:199]
    v_exp_f32 v33, v33
    v_mfma_f32_16x16x32_bf16 v[216:219], v[72:75], a[80:83], v[216:219]
    v_exp_f32 v34, v34
    v_mfma_f32_16x16x32_bf16 v[220:223], v[72:75], a[144:147], v[220:223]
    v_exp_f32 v35, v35
    v_mfma_f32_16x16x32_bf16 v[224:227], v[72:75], a[208:211], v[224:227]
    v_add_f32 v32, 1.0, v32
    s_add_u32 s74, s74, 4096
    buffer_load_dwordx4 v[72:75], v23, s[36:39], s74 offen offset:0 sc1
    v_mfma_f32_16x16x32_bf16 v[196:199], v[76:79], a[20:23], v[196:199]
    v_add_f32 v33, 1.0, v33
    v_mfma_f32_16x16x32_bf16 v[216:219], v[76:79], a[84:87], v[216:219]
    v_add_f32 v34, 1.0, v34
    v_mfma_f32_16x16x32_bf16 v[220:223], v[76:79], a[148:151], v[220:223]
    v_add_f32 v35, 1.0, v35
    v_mfma_f32_16x16x32_bf16 v[224:227], v[76:79], a[212:215], v[224:227]
    v_rcp_f32 v32, v32
    buffer_load_dwordx4 v[76:79], v251, s[36:39], s74 offen offset:0 sc1
    s_waitcnt vmcnt(10)
    v_mfma_f32_16x16x32_bf16 v[196:199], v[80:83], a[24:27], v[196:199]
    v_rcp_f32 v33, v33
    v_mfma_f32_16x16x32_bf16 v[216:219], v[80:83], a[88:91], v[216:219]
    v_rcp_f32 v34, v34
    v_mfma_f32_16x16x32_bf16 v[220:223], v[80:83], a[152:155], v[220:223]
    v_rcp_f32 v35, v35
    v_mfma_f32_16x16x32_bf16 v[224:227], v[80:83], a[216:219], v[224:227]
    v_mul_f32 v144, v32, v144
    buffer_load_dwordx4 v[80:83], v23, s[36:39], s74 offen offset:2048 sc1
    v_mfma_f32_16x16x32_bf16 v[196:199], v[84:87], a[28:31], v[196:199]
    v_mul_f32 v145, v33, v145
    v_mfma_f32_16x16x32_bf16 v[216:219], v[84:87], a[92:95], v[216:219]
    v_mul_f32 v146, v34, v146
    v_mfma_f32_16x16x32_bf16 v[220:223], v[84:87], a[156:159], v[220:223]
    v_mul_f32 v147, v35, v147
    v_mfma_f32_16x16x32_bf16 v[224:227], v[84:87], a[220:223], v[224:227]
    v_mul_f32 v32, v148, v148
    buffer_load_dwordx4 v[84:87], v251, s[36:39], s74 offen offset:2048 sc1
    s_waitcnt vmcnt(10)
    v_mfma_f32_16x16x32_bf16 v[196:199], v[88:91], a[32:35], v[196:199]
    v_mul_f32 v33, v149, v149
    v_mfma_f32_16x16x32_bf16 v[216:219], v[88:91], a[96:99], v[216:219]
    v_mul_f32 v34, v150, v150
    v_mfma_f32_16x16x32_bf16 v[220:223], v[88:91], a[160:163], v[220:223]
    v_mul_f32 v35, v151, v151
    v_mfma_f32_16x16x32_bf16 v[224:227], v[88:91], a[224:227], v[224:227]
    v_fma_f32 v32, v32, v26, v27
    s_add_u32 s74, s74, 4096
    buffer_load_dwordx4 v[88:91], v23, s[36:39], s74 offen offset:0 sc1
    s_mov_b64 exec, 1
    s_cmp_eq_u32 s55, 0
    s_cbranch_scc1 ool_142
    buffer_store_dword v36, off, s[24:27], s96 offset:96
back_143:
    s_mov_b64 exec, -1
    v_mfma_f32_16x16x32_bf16 v[196:199], v[92:95], a[36:39], v[196:199]
    v_fma_f32 v33, v33, v26, v27
    v_mfma_f32_16x16x32_bf16 v[216:219], v[92:95], a[100:103], v[216:219]
    v_fma_f32 v34, v34, v26, v27
    v_mfma_f32_16x16x32_bf16 v[220:223], v[92:95], a[164:167], v[220:223]
    v_fma_f32 v35, v35, v26, v27
    v_mfma_f32_16x16x32_bf16 v[224:227], v[92:95], a[228:231], v[224:227]
    v_mul_f32 v32, v32, v148
    buffer_load_dwordx4 v[92:95], v251, s[36:39], s74 offen offset:0 sc1
    s_waitcnt vmcnt(11)
    v_mfma_f32_16x16x32_bf16 v[196:199], v[96:99], a[40:43], v[196:199]
    v_mul_f32 v33, v33, v149
    v_mfma_f32_16x16x32_bf16 v[216:219], v[96:99], a[104:107], v[216:219]
    v_mul_f32 v34, v34, v150
    v_mfma_f32_16x16x32_bf16 v[220:223], v[96:99], a[168:171], v[220:223]
    v_mul_f32 v35, v35, v151
    v_mfma_f32_16x16x32_bf16 v[224:227], v[96:99], a[232:235], v[224:227]
    v_exp_f32 v32, v32
    buffer_load_dwordx4 v[96:99], v23, s[36:39], s74 offen offset:2048 sc1
    buffer_load_dwordx4 v[136:139], v0, s[36:39], s84 offen sc1
    buffer_load_dwordx4 v[140:143], v0, s[36:39], s85 offen sc1
    v_mfma_f32_16x16x32_bf16 v[196:199], v[100:103], a[44:47], v[196:199]
    v_exp_f32 v33, v33
    v_mfma_f32_16x16x32_bf16 v[216:219], v[100:103], a[108:111], v[216:219]
    v_exp_f32 v34, v34
    v_mfma_f32_16x16x32_bf16 v[220:223], v[100:103], a[172:175], v[220:223]
    v_exp_f32 v35, v35
    v_mfma_f32_16x16x32_bf16 v[224:227], v[100:103], a[236:239], v[224:227]
    v_add_f32 v32, 1.0, v32
    buffer_load_dwordx4 v[100:103], v251, s[36:39], s74 offen offset:2048 sc1
    s_waitcnt vmcnt(13)
    v_mfma_f32_16x16x32_bf16 v[196:199], v[56:59], a[48:51], v[196:199]
    v_add_f32 v33, 1.0, v33
    v_mfma_f32_16x16x32_bf16 v[216:219], v[56:59], a[112:115], v[216:219]
    v_add_f32 v34, 1.0, v34
    v_mfma_f32_16x16x32_bf16 v[220:223], v[56:59], a[176:179], v[220:223]
    v_add_f32 v35, 1.0, v35
    v_mfma_f32_16x16x32_bf16 v[224:227], v[56:59], a[240:243], v[224:227]
    v_rcp_f32 v32, v32
    s_add_u32 s74, s74, 4096
    buffer_load_dwordx4 v[56:59], v23, s[36:39], s74 offen offset:0 sc1
    v_mfma_f32_16x16x32_bf16 v[196:199], v[60:63], a[52:55], v[196:199]
    v_rcp_f32 v33, v33
    v_mfma_f32_16x16x32_bf16 v[216:219], v[60:63], a[116:119], v[216:219]
    v_rcp_f32 v34, v34
    v_mfma_f32_16x16x32_bf16 v[220:223], v[60:63], a[180:183], v[220:223]
    v_rcp_f32 v35, v35
    v_mfma_f32_16x16x32_bf16 v[224:227], v[60:63], a[244:247], v[224:227]
    v_mul_f32 v148, v32, v148
    buffer_load_dwordx4 v[60:63], v251, s[36:39], s74 offen offset:0 sc1
    s_waitcnt vmcnt(13)
    v_mfma_f32_16x16x32_bf16 v[196:199], v[64:67], a[56:59], v[196:199]
    v_mul_f32 v149, v33, v149
    v_mfma_f32_16x16x32_bf16 v[216:219], v[64:67], a[120:123], v[216:219]
    v_mul_f32 v150, v34, v150
    v_mfma_f32_16x16x32_bf16 v[220:223], v[64:67], a[184:187], v[220:223]
    v_mul_f32 v151, v35, v151
    v_mfma_f32_16x16x32_bf16 v[224:227], v[64:67], a[248:251], v[224:227]
    buffer_load_dwordx4 v[64:67], v23, s[36:39], s74 offen offset:2048 sc1
    v_mfma_f32_16x16x32_bf16 v[196:199], v[68:71], a[60:63], v[196:199]
    v_mfma_f32_16x16x32_bf16 v[216:219], v[68:71], a[124:127], v[216:219]
    v_mfma_f32_16x16x32_bf16 v[220:223], v[68:71], a[188:191], v[220:223]
    v_mfma_f32_16x16x32_bf16 v[224:227], v[68:71], a[252:255], v[224:227]
    buffer_load_dwordx4 v[68:71], v251, s[36:39], s74 offen offset:2048 sc1
    s_waitcnt vmcnt(13)
    v_mfma_f32_16x16x32_bf16 v[212:215], v[72:75], a[0:3], v[188:191]
    v_mfma_f32_16x16x32_bf16 v[200:203], v[72:75], a[64:67], 0
    v_mfma_f32_16x16x32_bf16 v[204:207], v[72:75], a[128:131], 0
    v_mfma_f32_16x16x32_bf16 v[208:211], v[72:75], a[192:195], 0
    s_add_u32 s74, s74, 4096
    buffer_load_dwordx4 v[72:75], v23, s[36:39], s74 offen offset:0 sc1
    s_cmp_eq_u32 s43, 0
    s_cbranch_scc0 skip_144
    s_lshr_b32 s99, s2, 3
    s_lshl_b32 s99, s99, 2
    s_add_u32 s99, s99, s40
    s_lshl_b32 s99, s99, 7
    s_sub_u32 s98, s92, L_table-L_k5
    s_subb_u32 s97, s93, 0
    s_add_u32 s98, s98, s99
    s_addc_u32 s97, s97, 0
    v_mov_b32 v38, s98
    v_mov_b32 v39, s97
    s_mov_b64 exec, 1
    global_load_dword v38, v[38:39], off
    s_mov_b64 exec, -1
skip_144:
    v_mfma_f32_16x16x32_bf16 v[212:215], v[76:79], a[4:7], v[212:215]
    ds_write_b128 v28, v[216:219] offset:36864
    v_mfma_f32_16x16x32_bf16 v[200:203], v[76:79], a[68:71], v[200:203]
    ds_write_b128 v29, v[220:223] offset:36864
    v_mfma_f32_16x16x32_bf16 v[204:207], v[76:79], a[132:135], v[204:207]
    ds_write_b128 v30, v[224:227] offset:36864
    v_mfma_f32_16x16x32_bf16 v[208:211], v[76:79], a[196:199], v[208:211]
    buffer_load_dwordx4 v[76:79], v251, s[36:39], s74 offen offset:0 sc1
    s_waitcnt vmcnt(13)
    v_mfma_f32_16x16x32_bf16 v[212:215], v[80:83], a[8:11], v[212:215]
    v_mfma_f32_16x16x32_bf16 v[200:203], v[80:83], a[72:75], v[200:203]
    v_mfma_f32_16x16x32_bf16 v[204:207], v[80:83], a[136:139], v[204:207]
    v_mfma_f32_16x16x32_bf16 v[208:211], v[80:83], a[200:203], v[208:211]
    buffer_load_dwordx4 v[80:83], v23, s[36:39], s74 offen offset:2048 sc1
    v_mfma_f32_16x16x32_bf16 v[212:215], v[84:87], a[12:15], v[212:215]
    v_mfma_f32_16x16x32_bf16 v[200:203], v[84:87], a[76:79], v[200:203]
    v_mfma_f32_16x16x32_bf16 v[204:207], v[84:87], a[140:143], v[204:207]
    v_mfma_f32_16x16x32_bf16 v[208:211], v[84:87], a[204:207], v[208:211]
    buffer_load_dwordx4 v[84:87], v251, s[36:39], s74 offen offset:2048 sc1
    s_waitcnt vmcnt(12)
    v_mfma_f32_16x16x32_bf16 v[212:215], v[88:91], a[16:19], v[212:215]
    s_waitcnt lgkmcnt(0)
    v_mfma_f32_16x16x32_bf16 v[200:203], v[88:91], a[80:83], v[200:203]
    s_barrier
    v_mfma_f32_16x16x32_bf16 v[204:207], v[88:91], a[144:147], v[204:207]
    ds_read_b128 v[164:167], v31 offset:24576
    v_mfma_f32_16x16x32_bf16 v[208:211], v[88:91], a[208:211], v[208:211]
    ds_read_b128 v[168:171], v31 offset:25600
    s_add_u32 s74, s74, 4096
    buffer_load_dwordx4 v[88:91], v23, s[36:39], s74 offen offset:0 sc1
    v_mfma_f32_16x16x32_bf16 v[212:215], v[92:95], a[20:23], v[212:215]
    ds_read_b128 v[172:175], v31 offset:26624
    v_mfma_f32_16x16x32_bf16 v[200:203], v[92:95], a[84:87], v[200:203]
    ds_read_b128 v[228:231], v31 offset:36864
    v_mfma_f32_16x16x32_bf16 v[204:207], v[92:95], a[148:151], v[204:207]
    ds_read_b128 v[232:235], v31 offset:37888
    v_mfma_f32_16x16x32_bf16 v[208:211], v[92:95], a[212:215], v[208:211]
    ds_read_b128 v[236:239], v31 offset:38912
    buffer_load_dwordx4 v[92:95], v251, s[36:39], s74 offen offset:0 sc1
    s_waitcnt vmcnt(10)
    v_mfma_f32_16x16x32_bf16 v[212:215], v[96:99], a[24:27], v[212:215]
    v_mfma_f32_16x16x32_bf16 v[200:203], v[96:99], a[88:91], v[200:203]
    v_mfma_f32_16x16x32_bf16 v[204:207], v[96:99], a[152:155], v[204:207]
    s_waitcnt lgkmcnt(5)
    v_add_f32 v192, v164, v192
    v_add_f32 v193, v165, v193
    v_mfma_f32_16x16x32_bf16 v[208:211], v[96:99], a[216:219], v[208:211]
    v_add_f32 v194, v166, v194
    buffer_load_dwordx4 v[96:99], v23, s[36:39], s74 offen offset:2048 sc1
    buffer_load_dword v244, v254, s[24:27], s68 offen offset:96 sc1
    v_mfma_f32_16x16x32_bf16 v[212:215], v[100:103], a[28:31], v[212:215]
    v_add_f32 v195, v167, v195
    s_waitcnt lgkmcnt(4)
    v_add_f32 v192, v168, v192
    v_mfma_f32_16x16x32_bf16 v[200:203], v[100:103], a[92:95], v[200:203]
    v_add_f32 v193, v169, v193
    v_add_f32 v194, v170, v194
    v_mfma_f32_16x16x32_bf16 v[204:207], v[100:103], a[156:159], v[204:207]
    v_add_f32 v195, v171, v195
    s_waitcnt lgkmcnt(3)
    v_add_f32 v192, v172, v192
    v_mfma_f32_16x16x32_bf16 v[208:211], v[100:103], a[220:223], v[208:211]
    v_add_f32 v193, v173, v193
    buffer_load_dwordx4 v[100:103], v251, s[36:39], s74 offen offset:2048 sc1
    s_waitcnt vmcnt(11)
    v_mfma_f32_16x16x32_bf16 v[212:215], v[56:59], a[32:35], v[212:215]
    v_add_f32 v194, v174, v194
    v_add_f32 v195, v175, v195
    v_mfma_f32_16x16x32_bf16 v[200:203], v[56:59], a[96:99], v[200:203]
    v_mul_f32 v192, v144, v192
    v_mul_f32 v193, v145, v193
    v_mfma_f32_16x16x32_bf16 v[204:207], v[56:59], a[160:163], v[204:207]
    v_mul_f32 v194, v146, v194
    v_mul_f32 v195, v147, v195
    v_mfma_f32_16x16x32_bf16 v[208:211], v[56:59], a[224:227], v[208:211]
    v_cvt_pk_bf16_f32 v240, v192, v193
    s_add_u32 s74, s74, 4096
    buffer_load_dwordx4 v[56:59], v23, s[36:39], s74 offen offset:0 sc1
    v_mfma_f32_16x16x32_bf16 v[212:215], v[60:63], a[36:39], v[212:215]
    v_cvt_pk_bf16_f32 v241, v194, v195
    s_waitcnt lgkmcnt(2)
    v_add_f32 v196, v228, v196
    v_mfma_f32_16x16x32_bf16 v[200:203], v[60:63], a[100:103], v[200:203]
    v_add_f32 v197, v229, v197
    v_add_f32 v198, v230, v198
    v_mfma_f32_16x16x32_bf16 v[204:207], v[60:63], a[164:167], v[204:207]
    v_add_f32 v199, v231, v199
    s_waitcnt lgkmcnt(1)
    v_add_f32 v196, v232, v196
    v_mfma_f32_16x16x32_bf16 v[208:211], v[60:63], a[228:231], v[208:211]
    v_add_f32 v197, v233, v197
    buffer_load_dwordx4 v[60:63], v251, s[36:39], s74 offen offset:0 sc1
    s_waitcnt vmcnt(11)
    v_mfma_f32_16x16x32_bf16 v[212:215], v[64:67], a[40:43], v[212:215]
    v_add_f32 v198, v234, v198
    v_add_f32 v199, v235, v199
    v_mfma_f32_16x16x32_bf16 v[200:203], v[64:67], a[104:107], v[200:203]
    s_waitcnt lgkmcnt(0)
    v_add_f32 v196, v236, v196
    v_add_f32 v197, v237, v197
    v_mfma_f32_16x16x32_bf16 v[204:207], v[64:67], a[168:171], v[204:207]
    v_add_f32 v198, v238, v198
    v_add_f32 v199, v239, v199
    v_lshlrev_b32 v40, 16, v136
    v_mfma_f32_16x16x32_bf16 v[208:211], v[64:67], a[232:235], v[208:211]
    v_mul_f32 v196, v148, v196
    buffer_load_dwordx4 v[64:67], v23, s[36:39], s74 offen offset:2048 sc1
    v_mfma_f32_16x16x32_bf16 v[212:215], v[68:71], a[44:47], v[212:215]
    v_mul_f32 v197, v149, v197
    v_mul_f32 v198, v150, v198
    v_and_b32 v41, 0xffff0000, v136
    v_mfma_f32_16x16x32_bf16 v[200:203], v[68:71], a[108:111], v[200:203]
    v_mul_f32 v199, v151, v199
    v_cvt_pk_bf16_f32 v242, v196, v197
    v_lshlrev_b32 v42, 16, v137
    v_mfma_f32_16x16x32_bf16 v[204:207], v[68:71], a[172:175], v[204:207]
    v_cvt_pk_bf16_f32 v243, v198, v199
    s_cmp_eq_u32 s55, 0
    s_cbranch_scc1 ool_145
    buffer_store_dwordx4 v[240:243], v0, s[36:39], s73 offen offset:0
back_146:
    v_and_b32 v43, 0xffff0000, v137
    v_mfma_f32_16x16x32_bf16 v[208:211], v[68:71], a[236:239], v[208:211]
    buffer_load_dwordx4 v[68:71], v251, s[36:39], s74 offen offset:2048 sc1
    s_waitcnt vmcnt(12)
    v_mfma_f32_16x16x32_bf16 v[212:215], v[72:75], a[48:51], v[212:215]
    v_lshlrev_b32 v44, 16, v138
    v_mfma_f32_16x16x32_bf16 v[200:203], v[72:75], a[112:115], v[200:203]
    v_and_b32 v45, 0xffff0000, v138
    v_mfma_f32_16x16x32_bf16 v[204:207], v[72:75], a[176:179], v[204:207]
    v_lshlrev_b32 v46, 16, v139
    v_mfma_f32_16x16x32_bf16 v[208:211], v[72:75], a[240:243], v[208:211]
    s_add_u32 s74, s74, 4096
    buffer_load_dwordx4 v[72:75], v23, s[36:39], s74 offen offset:0 sc1
    v_mfma_f32_16x16x32_bf16 v[212:215], v[76:79], a[52:55], v[212:215]
    v_and_b32 v47, 0xffff0000, v139
    v_mfma_f32_16x16x32_bf16 v[200:203], v[76:79], a[116:119], v[200:203]
    v_lshlrev_b32 v48, 16, v140
    v_mfma_f32_16x16x32_bf16 v[204:207], v[76:79], a[180:183], v[204:207]
    v_and_b32 v49, 0xffff0000, v140
    v_mfma_f32_16x16x32_bf16 v[208:211], v[76:79], a[244:247], v[208:211]
    buffer_load_dwordx4 v[76:79], v251, s[36:39], s74 offen offset:0 sc1
    s_waitcnt vmcnt(12)
    v_mfma_f32_16x16x32_bf16 v[212:215], v[80:83], a[56:59], v[212:215]
    v_lshlrev_b32 v50, 16, v141
    v_mfma_f32_16x16x32_bf16 v[200:203], v[80:83], a[120:123], v[200:203]
    v_and_b32 v51, 0xffff0000, v141
    v_mfma_f32_16x16x32_bf16 v[204:207], v[80:83], a[184:187], v[204:207]
    v_lshlrev_b32 v52, 16, v142
    v_mfma_f32_16x16x32_bf16 v[208:211], v[80:83], a[248:251], v[208:211]
    buffer_load_dwordx4 v[80:83], v23, s[36:39], s74 offen offset:2048 sc1
    v_mfma_f32_16x16x32_bf16 v[212:215], v[84:87], a[60:63], v[212:215]
    v_and_b32 v53, 0xffff0000, v142
    v_mfma_f32_16x16x32_bf16 v[200:203], v[84:87], a[124:127], v[200:203]
    v_lshlrev_b32 v54, 16, v143
    v_mfma_f32_16x16x32_bf16 v[204:207], v[84:87], a[188:191], v[204:207]
    v_and_b32 v55, 0xffff0000, v143
    v_mfma_f32_16x16x32_bf16 v[208:211], v[84:87], a[252:255], v[208:211]
    buffer_load_dwordx4 v[84:87], v251, s[36:39], s74 offen offset:2048 sc1
    s_waitcnt vmcnt(12)
    v_mfma_f32_16x16x32_bf16 v[192:195], v[88:91], a[0:3], v[188:191]
    v_mul_f32 v32, v152, v152
    v_mfma_f32_16x16x32_bf16 v[216:219], v[88:91], a[64:67], 0
    v_mul_f32 v33, v153, v153
    v_mfma_f32_16x16x32_bf16 v[220:223], v[88:91], a[128:131], 0
    v_mul_f32 v34, v154, v154
    v_mfma_f32_16x16x32_bf16 v[224:227], v[88:91], a[192:195], 0
    v_mul_f32 v35, v155, v155
    s_add_u32 s74, s74, 4096
    buffer_load_dwordx4 v[88:91], v23, s[36:39], s74 offen offset:0 sc1
L_k5:
    v_mfma_f32_16x16x32_bf16 v[192:195], v[92:95], a[4:7], v[192:195]
    ds_write_b128 v28, v[200:203] offset:0
    v_mfma_f32_16x16x32_bf16 v[216:219], v[92:95], a[68:71], v[216:219]
    ds_write_b128 v29, v[204:207] offset:0
    v_mfma_f32_16x16x32_bf16 v[220:223], v[92:95], a[132:135], v[220:223]
    ds_write_b128 v30, v[208:211] offset:0
    v_mfma_f32_16x16x32_bf16 v[224:227], v[92:95], a[196:199], v[224:227]
    v_fma_f32 v32, v32, v26, v27
    buffer_load_dwordx4 v[92:95], v251, s[36:39], s74 offen offset:0 sc1
    s_waitcnt vmcnt(11)
    v_mfma_f32_16x16x32_bf16 v[192:195], v[96:99], a[8:11], v[192:195]
    v_fma_f32 v33, v33, v26, v27
    v_mfma_f32_16x16x32_bf16 v[216:219], v[96:99], a[72:75], v[216:219]
    v_fma_f32 v34, v34, v26, v27
    v_mfma_f32_16x16x32_bf16 v[220:223], v[96:99], a[136:139], v[220:223]
    v_fma_f32 v35, v35, v26, v27
    v_mfma_f32_16x16x32_bf16 v[224:227], v[96:99], a[200:203], v[224:227]
    v_mul_f32 v32, v32, v152
    buffer_load_dwordx4 v[96:99], v23, s[36:39], s74 offen offset:2048 sc1
    v_mfma_f32_16x16x32_bf16 v[192:195], v[100:103], a[12:15], v[192:195]
    v_mul_f32 v33, v33, v153
    v_mfma_f32_16x16x32_bf16 v[216:219], v[100:103], a[76:79], v[216:219]
    v_mul_f32 v34, v34, v154
    v_mfma_f32_16x16x32_bf16 v[220:223], v[100:103], a[140:143], v[220:223]
    v_mul_f32 v35, v35, v155
    v_mfma_f32_16x16x32_bf16 v[224:227], v[100:103], a[204:207], v[224:227]
    v_exp_f32 v32, v32
    buffer_load_dwordx4 v[100:103], v251, s[36:39], s74 offen offset:2048 sc1
    s_waitcnt vmcnt(11)
    v_mfma_f32_16x16x32_bf16 v[192:195], v[56:59], a[16:19], v[192:195]
    v_exp_f32 v33, v33
    v_mfma_f32_16x16x32_bf16 v[216:219], v[56:59], a[80:83], v[216:219]
    v_exp_f32 v34, v34
    v_mfma_f32_16x16x32_bf16 v[220:223], v[56:59], a[144:147], v[220:223]
    v_exp_f32 v35, v35
    v_mfma_f32_16x16x32_bf16 v[224:227], v[56:59], a[208:211], v[224:227]
    v_add_f32 v32, 1.0, v32
    s_add_u32 s74, s74, 4096
    buffer_load_dwordx4 v[56:59], v23, s[36:39], s74 offen offset:0 sc1
    v_cmp_ne_u32 vcc, 1, v244
    s_cbranch_vccnz ool_147
back_148:
    v_mfma_f32_16x16x32_bf16 v[192:195], v[60:63], a[20:23], v[192:195]
    v_add_f32 v33, 1.0, v33
    v_mfma_f32_16x16x32_bf16 v[216:219], v[60:63], a[84:87], v[216:219]
    v_add_f32 v34, 1.0, v34
    v_mfma_f32_16x16x32_bf16 v[220:223], v[60:63], a[148:151], v[220:223]
    v_add_f32 v35, 1.0, v35
    v_mfma_f32_16x16x32_bf16 v[224:227], v[60:63], a[212:215], v[224:227]
    v_rcp_f32 v32, v32
    buffer_load_dwordx4 v[60:63], v251, s[36:39], s74 offen offset:0 sc1
    s_waitcnt vmcnt(10)
    v_mfma_f32_16x16x32_bf16 v[192:195], v[64:67], a[24:27], v[192:195]
    v_rcp_f32 v33, v33
    v_mfma_f32_16x16x32_bf16 v[216:219], v[64:67], a[88:91], v[216:219]
    v_rcp_f32 v34, v34
    v_mfma_f32_16x16x32_bf16 v[220:223], v[64:67], a[152:155], v[220:223]
    v_rcp_f32 v35, v35
    v_mfma_f32_16x16x32_bf16 v[224:227], v[64:67], a[216:219], v[224:227]
    v_mul_f32 v152, v32, v152
    buffer_load_dwordx4 v[64:67], v23, s[36:39], s74 offen offset:2048 sc1
    v_mfma_f32_16x16x32_bf16 v[192:195], v[68:71], a[28:31], v[192:195]
    v_mul_f32 v153, v33, v153
    v_mfma_f32_16x16x32_bf16 v[216:219], v[68:71], a[92:95], v[216:219]
    v_mul_f32 v154, v34, v154
    v_mfma_f32_16x16x32_bf16 v[220:223], v[68:71], a[156:159], v[220:223]
    v_mul_f32 v155, v35, v155
    v_mfma_f32_16x16x32_bf16 v[224:227], v[68:71], a[220:223], v[224:227]
    v_mul_f32 v32, v156, v156
    buffer_load_dwordx4 v[68:71], v251, s[36:39], s74 offen offset:2048 sc1
    s_mov_b64 exec, 1
    s_cmp_eq_u32 s55, 0
    s_cbranch_scc1 ool_151
    buffer_store_dword v36, off, s[24:27], s96 offset:0
back_152:
    s_mov_b64 exec, -1
    s_waitcnt vmcnt(11)
    v_mfma_f32_16x16x32_bf16 v[192:195], v[72:75], a[32:35], v[192:195]
    v_mul_f32 v33, v157, v157
    v_mfma_f32_16x16x32_bf16 v[216:219], v[72:75], a[96:99], v[216:219]
    v_mul_f32 v34, v158, v158
    v_mfma_f32_16x16x32_bf16 v[220:223], v[72:75], a[160:163], v[220:223]
    v_mul_f32 v35, v159, v159
    v_mfma_f32_16x16x32_bf16 v[224:227], v[72:75], a[224:227], v[224:227]
    v_fma_f32 v32, v32, v26, v27
    s_add_u32 s74, s74, 4096
    buffer_load_dwordx4 v[72:75], v23, s[36:39], s74 offen offset:0 sc1
    v_mfma_f32_16x16x32_bf16 v[192:195], v[76:79], a[36:39], v[192:195]
    v_fma_f32 v33, v33, v26, v27
    v_mfma_f32_16x16x32_bf16 v[216:219], v[76:79], a[100:103], v[216:219]
    v_fma_f32 v34, v34, v26, v27
    v_mfma_f32_16x16x32_bf16 v[220:223], v[76:79], a[164:167], v[220:223]
    v_fma_f32 v35, v35, v26, v27
    v_mfma_f32_16x16x32_bf16 v[224:227], v[76:79], a[228:231], v[224:227]
    v_mul_f32 v32, v32, v156
    buffer_load_dwordx4 v[76:79], v251, s[36:39], s74 offen offset:0 sc1
    s_waitcnt vmcnt(11)
    v_mfma_f32_16x16x32_bf16 v[192:195], v[80:83], a[40:43], v[192:195]
    v_mul_f32 v33, v33, v157
    v_mfma_f32_16x16x32_bf16 v[216:219], v[80:83], a[104:107], v[216:219]
    v_mul_f32 v34, v34, v158
    v_mfma_f32_16x16x32_bf16 v[220:223], v[80:83], a[168:171], v[220:223]
    v_mul_f32 v35, v35, v159
    v_mfma_f32_16x16x32_bf16 v[224:227], v[80:83], a[232:235], v[224:227]
    v_exp_f32 v32, v32
    buffer_load_dwordx4 v[80:83], v23, s[36:39], s74 offen offset:2048 sc1
    v_mfma_f32_16x16x32_bf16 v[192:195], v[84:87], a[44:47], v[192:195]
    v_exp_f32 v33, v33
    v_mfma_f32_16x16x32_bf16 v[216:219], v[84:87], a[108:111], v[216:219]
    v_exp_f32 v34, v34
    v_mfma_f32_16x16x32_bf16 v[220:223], v[84:87], a[172:175], v[220:223]
    v_exp_f32 v35, v35
    v_mfma_f32_16x16x32_bf16 v[224:227], v[84:87], a[236:239], v[224:227]
    v_add_f32 v32, 1.0, v32
    buffer_load_dwordx4 v[84:87], v251, s[36:39], s74 offen offset:2048 sc1
    s_waitcnt vmcnt(11)
    v_mfma_f32_16x16x32_bf16 v[192:195], v[88:91], a[48:51], v[192:195]
    v_add_f32 v33, 1.0, v33
    v_mfma_f32_16x16x32_bf16 v[216:219], v[88:91], a[112:115], v[216:219]
    v_add_f32 v34, 1.0, v34
    v_mfma_f32_16x16x32_bf16 v[220:223], v[88:91], a[176:179], v[220:223]
    v_add_f32 v35, 1.0, v35
    v_mfma_f32_16x16x32_bf16 v[224:227], v[88:91], a[240:243], v[224:227]
    v_rcp_f32 v32, v32
    s_add_u32 s74, s74, 4096
    buffer_load_dwordx4 v[88:91], v23, s[36:39], s74 offen offset:0 sc1
    v_mfma_f32_16x16x32_bf16 v[192:195], v[92:95], a[52:55], v[192:195]
    v_rcp_f32 v33, v33
    v_mfma_f32_16x16x32_bf16 v[216:219], v[92:95], a[116:119], v[216:219]
    v_rcp_f32 v34, v34
    v_mfma_f32_16x16x32_bf16 v[220:223], v[92:95], a[180:183], v[220:223]
    v_rcp_f32 v35, v35
    v_mfma_f32_16x16x32_bf16 v[224:227], v[92:95], a[244:247], v[224:227]
    v_mul_f32 v156, v32, v156
    buffer_load_dwordx4 v[92:95], v251, s[36:39], s74 offen offset:0 sc1
    s_waitcnt vmcnt(11)
    v_mfma_f32_16x16x32_bf16 v[192:195], v[96:99], a[56:59], v[192:195]
    v_mul_f32 v157, v33, v157
    v_mfma_f32_16x16x32_bf16 v[216:219], v[96:99], a[120:123], v[216:219]
    v_mul_f32 v158, v34, v158
    v_mfma_f32_16x16x32_bf16 v[220:223], v[96:99], a[184:187], v[220:223]
    v_mul_f32 v159, v35, v159
    v_mfma_f32_16x16x32_bf16 v[224:227], v[96:99], a[248:251], v[224:227]
    buffer_load_dwordx4 v[96:99], v23, s[36:39], s74 offen offset:2048 sc1
    v_mfma_f32_16x16x32_bf16 v[192:195], v[100:103], a[60:63], v[192:195]
    v_mfma_f32_16x16x32_bf16 v[216:219], v[100:103], a[124:127], v[216:219]
    v_mfma_f32_16x16x32_bf16 v[220:223], v[100:103], a[188:191], v[220:223]
    v_mfma_f32_16x16x32_bf16 v[224:227], v[100:103], a[252:255], v[224:227]
    buffer_load_dwordx4 v[100:103], v251, s[36:39], s74 offen offset:2048 sc1
    buffer_load_dword v244, v254, s[24:27], s68 offen offset:0 sc1
    s_waitcnt vmcnt(12)
    v_mfma_f32_16x16x32_bf16 v[196:199], v[56:59], a[0:3], v[188:191]
    v_mfma_f32_16x16x32_bf16 v[200:203], v[56:59], a[64:67], 0
    v_mfma_f32_16x16x32_bf16 v[204:207], v[56:59], a[128:131], 0
    v_mfma_f32_16x16x32_bf16 v[208:211], v[56:59], a[192:195], 0
    s_add_u32 s74, s74, 4096
    buffer_load_dwordx4 v[56:59], v23, s[36:39], s74 offen offset:0 sc1
    v_mfma_f32_16x16x32_bf16 v[196:199], v[60:63], a[4:7], v[196:199]
    ds_write_b128 v28, v[216:219] offset:12288
    v_mfma_f32_16x16x32_bf16 v[200:203], v[60:63], a[68:71], v[200:203]
    ds_write_b128 v29, v[220:223] offset:12288
    v_mfma_f32_16x16x32_bf16 v[204:207], v[60:63], a[132:135], v[204:207]
    ds_write_b128 v30, v[224:227] offset:12288
    v_mfma_f32_16x16x32_bf16 v[208:211], v[60:63], a[196:199], v[208:211]
    buffer_load_dwordx4 v[60:63], v251, s[36:39], s74 offen offset:0 sc1
    s_waitcnt vmcnt(12)
    v_mfma_f32_16x16x32_bf16 v[196:199], v[64:67], a[8:11], v[196:199]
    v_mfma_f32_16x16x32_bf16 v[200:203], v[64:67], a[72:75], v[200:203]
    v_mfma_f32_16x16x32_bf16 v[204:207], v[64:67], a[136:139], v[204:207]
    v_mfma_f32_16x16x32_bf16 v[208:211], v[64:67], a[200:203], v[208:211]
    buffer_load_dwordx4 v[64:67], v23, s[36:39], s74 offen offset:2048 sc1
    v_mfma_f32_16x16x32_bf16 v[196:199], v[68:71], a[12:15], v[196:199]
    v_mfma_f32_16x16x32_bf16 v[200:203], v[68:71], a[76:79], v[200:203]
    v_mfma_f32_16x16x32_bf16 v[204:207], v[68:71], a[140:143], v[204:207]
    v_mfma_f32_16x16x32_bf16 v[208:211], v[68:71], a[204:207], v[208:211]
    buffer_load_dwordx4 v[68:71], v251, s[36:39], s74 offen offset:2048 sc1
    s_waitcnt vmcnt(11)
    v_mfma_f32_16x16x32_bf16 v[196:199], v[72:75], a[16:19], v[196:199]
    s_waitcnt lgkmcnt(0)
    v_mfma_f32_16x16x32_bf16 v[200:203], v[72:75], a[80:83], v[200:203]
    s_barrier
    v_mfma_f32_16x16x32_bf16 v[204:207], v[72:75], a[144:147], v[204:207]
    ds_read_b128 v[164:167], v31 offset:0
    v_mfma_f32_16x16x32_bf16 v[208:211], v[72:75], a[208:211], v[208:211]
    ds_read_b128 v[168:171], v31 offset:1024
    buffer_load_dwordx4 v[104:107], v0, s[36:39], s76 offen offset:0 sc1
    ds_read_b128 v[72:75], v252 offset:0
    v_mfma_f32_16x16x32_bf16 v[196:199], v[76:79], a[20:23], v[196:199]
    ds_read_b128 v[172:175], v31 offset:2048
    v_mfma_f32_16x16x32_bf16 v[200:203], v[76:79], a[84:87], v[200:203]
    ds_read_b128 v[228:231], v31 offset:12288
    v_mfma_f32_16x16x32_bf16 v[204:207], v[76:79], a[148:151], v[204:207]
    ds_read_b128 v[232:235], v31 offset:13312
    v_mfma_f32_16x16x32_bf16 v[208:211], v[76:79], a[212:215], v[208:211]
    ds_read_b128 v[236:239], v31 offset:14336
    buffer_load_dwordx4 v[108:111], v0, s[36:39], s76 offen offset:1024 sc1
    ds_read_b128 v[76:79], v252 offset:1024
    s_waitcnt vmcnt(11)
    v_mfma_f32_16x16x32_bf16 v[196:199], v[80:83], a[24:27], v[196:199]
    v_mfma_f32_16x16x32_bf16 v[200:203], v[80:83], a[88:91], v[200:203]
    v_mfma_f32_16x16x32_bf16 v[204:207], v[80:83], a[152:155], v[204:207]
    s_waitcnt lgkmcnt(7)
    v_add_f32 v212, v164, v212
    v_add_f32 v213, v165, v213
    v_mfma_f32_16x16x32_bf16 v[208:211], v[80:83], a[216:219], v[208:211]
    v_add_f32 v214, v166, v214
    buffer_load_dwordx4 v[112:115], v0, s[36:39], s76 offen offset:2048 sc1
    ds_read_b128 v[80:83], v252 offset:2048
    v_mfma_f32_16x16x32_bf16 v[196:199], v[84:87], a[28:31], v[196:199]
    v_add_f32 v215, v167, v215
    s_waitcnt lgkmcnt(7)
    v_add_f32 v212, v168, v212
    v_mfma_f32_16x16x32_bf16 v[200:203], v[84:87], a[92:95], v[200:203]
    v_add_f32 v213, v169, v213
    v_add_f32 v214, v170, v214
    v_mfma_f32_16x16x32_bf16 v[204:207], v[84:87], a[156:159], v[204:207]
    v_add_f32 v215, v171, v215
    s_waitcnt lgkmcnt(5)
    v_add_f32 v212, v172, v212
    v_mfma_f32_16x16x32_bf16 v[208:211], v[84:87], a[220:223], v[208:211]
    v_add_f32 v213, v173, v213
    buffer_load_dwordx4 v[116:119], v0, s[36:39], s76 offen offset:3072 sc1
    ds_read_b128 v[84:87], v252 offset:3072
    s_waitcnt vmcnt(11)
    v_mfma_f32_16x16x32_bf16 v[196:199], v[88:91], a[32:35], v[196:199]
    v_add_f32 v214, v174, v214
    v_add_f32 v215, v175, v215
    v_mfma_f32_16x16x32_bf16 v[200:203], v[88:91], a[96:99], v[200:203]
    v_mul_f32 v212, v152, v212
    v_mul_f32 v213, v153, v213
    v_mfma_f32_16x16x32_bf16 v[204:207], v[88:91], a[160:163], v[204:207]
    v_mul_f32 v214, v154, v214
    v_mul_f32 v215, v155, v215
    v_mfma_f32_16x16x32_bf16 v[208:211], v[88:91], a[224:227], v[208:211]
    v_cvt_pk_bf16_f32 v240, v212, v213
    buffer_load_dwordx4 v[120:123], v0, s[36:39], s77 offen offset:0 sc1
    ds_read_b128 v[88:91], v252 offset:4096
    v_mfma_f32_16x16x32_bf16 v[196:199], v[92:95], a[36:39], v[196:199]
    v_cvt_pk_bf16_f32 v241, v214, v215
    s_waitcnt lgkmcnt(6)
    v_add_f32 v192, v228, v192
    v_mfma_f32_16x16x32_bf16 v[200:203], v[92:95], a[100:103], v[200:203]
    v_add_f32 v193, v229, v193
    v_add_f32 v194, v230, v194
    v_mfma_f32_16x16x32_bf16 v[204:207], v[92:95], a[164:167], v[204:207]
    v_add_f32 v195, v231, v195
    s_waitcnt lgkmcnt(5)
    v_add_f32 v192, v232, v192
    v_mfma_f32_16x16x32_bf16 v[208:211], v[92:95], a[228:231], v[208:211]
    v_add_f32 v193, v233, v193
    buffer_load_dwordx4 v[124:127], v0, s[36:39], s77 offen offset:1024 sc1
    ds_read_b128 v[92:95], v252 offset:5120
    s_waitcnt vmcnt(11)
    v_mfma_f32_16x16x32_bf16 v[196:199], v[96:99], a[40:43], v[196:199]
    v_add_f32 v194, v234, v194
    v_add_f32 v195, v235, v195
    v_mfma_f32_16x16x32_bf16 v[200:203], v[96:99], a[104:107], v[200:203]
    s_waitcnt lgkmcnt(5)
    v_add_f32 v192, v236, v192
    v_add_f32 v193, v237, v193
    v_mfma_f32_16x16x32_bf16 v[204:207], v[96:99], a[168:171], v[204:207]
    v_add_f32 v194, v238, v194
    v_add_f32 v195, v239, v195
    v_mfma_f32_16x16x32_bf16 v[208:211], v[96:99], a[232:235], v[208:211]
    v_mul_f32 v192, v156, v192
    buffer_load_dwordx4 v[128:131], v0, s[36:39], s77 offen offset:2048 sc1
    ds_read_b128 v[96:99], v252 offset:6144
    v_mfma_f32_16x16x32_bf16 v[196:199], v[100:103], a[44:47], v[196:199]
    v_mul_f32 v193, v157, v193
    v_mul_f32 v194, v158, v194
    v_mfma_f32_16x16x32_bf16 v[200:203], v[100:103], a[108:111], v[200:203]
    v_mul_f32 v195, v159, v195
    v_cvt_pk_bf16_f32 v242, v192, v193
    v_mfma_f32_16x16x32_bf16 v[204:207], v[100:103], a[172:175], v[204:207]
    v_cvt_pk_bf16_f32 v243, v194, v195
    s_cmp_eq_u32 s55, 0
    s_cbranch_scc1 ool_153
    buffer_store_dwordx4 v[240:243], v0, s[36:39], s84 offen
back_154:
    v_mfma_f32_16x16x32_bf16 v[208:211], v[100:103], a[236:239], v[208:211]
    buffer_load_dwordx4 v[132:135], v0, s[36:39], s77 offen offset:3072 sc1
    ds_read_b128 v[100:103], v252 offset:7168
    s_waitcnt vmcnt(11)
    v_mfma_f32_16x16x32_bf16 v[196:199], v[56:59], a[48:51], v[196:199]
    v_mfma_f32_16x16x32_bf16 v[200:203], v[56:59], a[112:115], v[200:203]
    v_mfma_f32_16x16x32_bf16 v[204:207], v[56:59], a[176:179], v[204:207]
    v_mfma_f32_16x16x32_bf16 v[208:211], v[56:59], a[240:243], v[208:211]
    v_cmp_ne_u32 vcc, 1, v244
    s_cbranch_vccnz ool_155
back_156:
    buffer_load_dwordx4 v[164:167], v0, s[36:39], s78 offen offset:0 sc1
    ds_read_b128 v[56:59], v252 offset:8192
    v_mfma_f32_16x16x32_bf16 v[196:199], v[60:63], a[52:55], v[196:199]
    v_mfma_f32_16x16x32_bf16 v[200:203], v[60:63], a[116:119], v[200:203]
    v_mfma_f32_16x16x32_bf16 v[204:207], v[60:63], a[180:183], v[204:207]
    v_mfma_f32_16x16x32_bf16 v[208:211], v[60:63], a[244:247], v[208:211]
    buffer_load_dwordx4 v[168:171], v0, s[36:39], s78 offen offset:1024 sc1
    ds_read_b128 v[60:63], v252 offset:9216
    s_waitcnt vmcnt(11)
    v_mfma_f32_16x16x32_bf16 v[196:199], v[64:67], a[56:59], v[196:199]
    v_mfma_f32_16x16x32_bf16 v[200:203], v[64:67], a[120:123], v[200:203]
    v_mfma_f32_16x16x32_bf16 v[204:207], v[64:67], a[184:187], v[204:207]
    v_mfma_f32_16x16x32_bf16 v[208:211], v[64:67], a[248:251], v[208:211]
    buffer_load_dwordx4 v[172:175], v0, s[36:39], s78 offen offset:2048 sc1
    ds_read_b128 v[64:67], v252 offset:10240
    v_mfma_f32_16x16x32_bf16 v[196:199], v[68:71], a[60:63], v[196:199]
    v_mfma_f32_16x16x32_bf16 v[200:203], v[68:71], a[124:127], v[200:203]
    v_mfma_f32_16x16x32_bf16 v[204:207], v[68:71], a[188:191], v[204:207]
    v_mfma_f32_16x16x32_bf16 v[208:211], v[68:71], a[252:255], v[208:211]
    buffer_load_dwordx4 v[176:179], v0, s[36:39], s78 offen offset:3072 sc1
    ds_read_b128 v[68:71], v252 offset:11264
    s_waitcnt vmcnt(5)
    s_mov_b64 exec, 1
    s_cmp_eq_u32 s55, 0
    s_cbranch_scc1 ool_159
    buffer_store_dword v36, off, s[24:27], s96 offset:32
back_160:
    s_mov_b64 exec, -1
    s_waitcnt lgkmcnt(10)
    v_mfma_f32_16x16x32_bf16 v[40:43], v[72:75], v[104:107], v[40:43]
    ds_read_b128 v[72:75], v252 offset:12288
    buffer_load_dwordx4 v[180:183], v0, s[36:39], s79 offen offset:0 sc1
    v_mfma_f32_16x16x32_bf16 v[44:47], v[76:79], v[104:107], v[44:47]
    ds_read_b128 v[76:79], v252 offset:13312
    buffer_load_dwordx4 v[184:187], v0, s[36:39], s79 offen offset:1024 sc1
    s_waitcnt lgkmcnt(10)
    v_mfma_f32_16x16x32_bf16 v[48:51], v[80:83], v[104:107], v[48:51]
    ds_read_b128 v[80:83], v252 offset:14336
    buffer_load_dwordx4 v[188:191], v0, s[36:39], s79 offen offset:2048 sc1
    v_mfma_f32_16x16x32_bf16 v[52:55], v[84:87], v[104:107], v[52:55]
    ds_read_b128 v[84:87], v252 offset:15360
    ds_write_b128 v28, v[200:203] offset:24576
    buffer_load_dwordx4 v[192:195], v0, s[36:39], s79 offen offset:3072 sc1
    s_waitcnt lgkmcnt(11)
    v_mfma_f32_16x16x32_bf16 v[40:43], v[88:91], v[108:111], v[40:43]
    ds_read_b128 v[88:91], v252 offset:16384
    ds_write_b128 v29, v[204:207] offset:24576
    v_mfma_f32_16x16x32_bf16 v[44:47], v[92:95], v[108:111], v[44:47]
    ds_read_b128 v[92:95], v252 offset:17408
    ds_write_b128 v30, v[208:211] offset:24576
    s_waitcnt lgkmcnt(13)
    v_mfma_f32_16x16x32_bf16 v[48:51], v[96:99], v[108:111], v[48:51]
    ds_read_b128 v[96:99], v252 offset:18432
    v_mfma_f32_16x16x32_bf16 v[52:55], v[100:103], v[108:111], v[52:55]
    ds_read_b128 v[100:103], v252 offset:19456
    s_waitcnt lgkmcnt(13)
    v_mfma_f32_16x16x32_bf16 v[40:43], v[56:59], v[112:115], v[40:43]
    ds_read_b128 v[56:59], v252 offset:20480
    buffer_load_dword v244, v254, s[24:27], s68 offen offset:32 sc1
    v_mfma_f32_16x16x32_bf16 v[44:47], v[60:63], v[112:115], v[44:47]
    ds_read_b128 v[60:63], v252 offset:21504
    s_waitcnt lgkmcnt(4)
    s_barrier
    ds_read_b128 v[228:231], v31 offset:24576
    ds_read_b128 v[232:235], v31 offset:25600
    ds_read_b128 v[236:239], v31 offset:26624
    v_mfma_f32_16x16x32_bf16 v[48:51], v[64:67], v[112:115], v[48:51]
    ds_read_b128 v[64:67], v252 offset:22528
    v_mfma_f32_16x16x32_bf16 v[52:55], v[68:71], v[112:115], v[52:55]
    ds_read_b128 v[68:71], v252 offset:23552
    v_mfma_f32_16x16x32_bf16 v[40:43], v[72:75], v[116:119], v[40:43]
    ds_read_b128 v[72:75], v252 offset:24576
    v_mfma_f32_16x16x32_bf16 v[44:47], v[76:79], v[116:119], v[44:47]
    ds_read_b128 v[76:79], v252 offset:25600
    v_mfma_f32_16x16x32_bf16 v[48:51], v[80:83], v[116:119], v[48:51]
    ds_read_b128 v[80:83], v252 offset:26624
    v_mfma_f32_16x16x32_bf16 v[52:55], v[84:87], v[116:119], v[52:55]
    ds_read_b128 v[84:87], v252 offset:27648
    s_waitcnt lgkmcnt(8)
    v_add_f32 v196, v228, v196
    v_mfma_f32_16x16x32_bf16 v[40:43], v[88:91], v[120:123], v[40:43]
    ds_read_b128 v[88:91], v252 offset:28672
    v_add_f32 v197, v229, v197
    v_mfma_f32_16x16x32_bf16 v[44:47], v[92:95], v[120:123], v[44:47]
    ds_read_b128 v[92:95], v252 offset:29696
    v_add_f32 v198, v230, v198
    v_mfma_f32_16x16x32_bf16 v[48:51], v[96:99], v[120:123], v[48:51]
    ds_read_b128 v[96:99], v252 offset:30720
    v_add_f32 v199, v231, v199
    v_mfma_f32_16x16x32_bf16 v[52:55], v[100:103], v[120:123], v[52:55]
    ds_read_b128 v[100:103], v252 offset:31744
    s_waitcnt lgkmcnt(11)
    v_add_f32 v196, v232, v196
    v_mfma_f32_16x16x32_bf16 v[40:43], v[56:59], v[124:127], v[40:43]
    ds_read_b128 v[56:59], v252 offset:32768
    v_add_f32 v197, v233, v197
    s_waitcnt vmcnt(0)
    v_cmp_ne_u32 vcc, 1, v244
    s_cbranch_vccnz ool_161
back_162:
    buffer_load_dwordx4 v[212:215], v0, s[36:39], s80 offen offset:0 sc1
    buffer_load_dwordx4 v[216:219], v0, s[36:39], s80 offen offset:1024 sc1
    buffer_load_dwordx4 v[220:223], v0, s[36:39], s80 offen offset:2048 sc1
    buffer_load_dwordx4 v[224:227], v0, s[36:39], s80 offen offset:3072 sc1
    v_mfma_f32_16x16x32_bf16 v[44:47], v[60:63], v[124:127], v[44:47]
    ds_read_b128 v[60:63], v252 offset:33792
    v_add_f32 v198, v234, v198
    s_waitcnt lgkmcnt(10)
    v_mfma_f32_16x16x32_bf16 v[48:51], v[64:67], v[124:127], v[48:51]
    ds_read_b128 v[64:67], v252 offset:34816
    v_add_f32 v199, v235, v199
    v_mfma_f32_16x16x32_bf16 v[52:55], v[68:71], v[124:127], v[52:55]
    ds_read_b128 v[68:71], v252 offset:35840
    v_add_f32 v196, v236, v196
    s_waitcnt lgkmcnt(10)
    v_mfma_f32_16x16x32_bf16 v[40:43], v[72:75], v[128:131], v[40:43]
    ds_read_b128 v[72:75], v252 offset:36864
    v_add_f32 v197, v237, v197
    v_mfma_f32_16x16x32_bf16 v[44:47], v[76:79], v[128:131], v[44:47]
    ds_read_b128 v[76:79], v252 offset:37888
    v_add_f32 v198, v238, v198
    s_waitcnt lgkmcnt(10)
    v_mfma_f32_16x16x32_bf16 v[48:51], v[80:83], v[128:131], v[48:51]
    ds_read_b128 v[80:83], v252 offset:38912
    v_add_f32 v199, v239, v199
    v_mfma_f32_16x16x32_bf16 v[52:55], v[84:87], v[128:131], v[52:55]
    ds_read_b128 v[84:87], v252 offset:39936
    v_mul_f32 v196, v160, v196
    s_waitcnt lgkmcnt(10)
    v_mfma_f32_16x16x32_bf16 v[40:43], v[88:91], v[132:135], v[40:43]
    ds_read_b128 v[88:91], v252 offset:40960
    v_mul_f32 v197, v161, v197
    v_mfma_f32_16x16x32_bf16 v[44:47], v[92:95], v[132:135], v[44:47]
    ds_read_b128 v[92:95], v252 offset:41984
    v_mul_f32 v198, v162, v198
    s_waitcnt lgkmcnt(10)
    v_mfma_f32_16x16x32_bf16 v[48:51], v[96:99], v[132:135], v[48:51]
    ds_read_b128 v[96:99], v252 offset:43008
    v_mul_f32 v199, v163, v199
    v_mfma_f32_16x16x32_bf16 v[52:55], v[100:103], v[132:135], v[52:55]
    ds_read_b128 v[100:103], v252 offset:44032
    v_cvt_pk_bf16_f32 v240, v196, v197
    s_waitcnt lgkmcnt(10)
    v_mfma_f32_16x16x32_bf16 v[40:43], v[56:59], v[164:167], v[40:43]
    ds_read_b128 v[56:59], v252 offset:45056
    v_cvt_pk_bf16_f32 v241, v198, v199
    v_mfma_f32_16x16x32_bf16 v[44:47], v[60:63], v[164:167], v[44:47]
    ds_read_b128 v[60:63], v252 offset:46080
    s_cmp_eq_u32 s55, 0
    s_cbranch_scc1 ool_165
    buffer_store_dwordx2 v[240:241], v21, s[36:39], s85 offen
back_166:
    s_waitcnt lgkmcnt(10)
    v_mfma_f32_16x16x32_bf16 v[48:51], v[64:67], v[164:167], v[48:51]
    ds_read_b128 v[64:67], v252 offset:47104
    v_mfma_f32_16x16x32_bf16 v[52:55], v[68:71], v[164:167], v[52:55]
    ds_read_b128 v[68:71], v252 offset:48128
    s_waitcnt lgkmcnt(10)
    v_mfma_f32_16x16x32_bf16 v[40:43], v[72:75], v[168:171], v[40:43]
    ds_read_b128 v[72:75], v0 offset:0
    buffer_load_dwordx4 v[196:199], v0, s[36:39], s81 offen offset:0 sc1
    v_mfma_f32_16x16x32_bf16 v[44:47], v[76:79], v[168:171], v[44:47]
    ds_read_b128 v[76:79], v0 offset:1024
    s_waitcnt lgkmcnt(10)
    v_mfma_f32_16x16x32_bf16 v[48:51], v[80:83], v[168:171], v[48:51]
    ds_read_b128 v[80:83], v0 offset:2048
    buffer_load_dwordx4 v[200:203], v0, s[36:39], s81 offen offset:1024 sc1
    v_mfma_f32_16x16x32_bf16 v[52:55], v[84:87], v[168:171], v[52:55]
    ds_read_b128 v[84:87], v0 offset:3072
    s_waitcnt lgkmcnt(10)
    v_mfma_f32_16x16x32_bf16 v[40:43], v[88:91], v[172:175], v[40:43]
    ds_read_b128 v[88:91], v0 offset:4096
    buffer_load_dwordx4 v[204:207], v0, s[36:39], s81 offen offset:2048 sc1
    v_mfma_f32_16x16x32_bf16 v[44:47], v[92:95], v[172:175], v[44:47]
    ds_read_b128 v[92:95], v0 offset:5120
    s_waitcnt lgkmcnt(10)
    v_mfma_f32_16x16x32_bf16 v[48:51], v[96:99], v[172:175], v[48:51]
    ds_read_b128 v[96:99], v0 offset:6144
    buffer_load_dwordx4 v[208:211], v0, s[36:39], s81 offen offset:3072 sc1
    v_mfma_f32_16x16x32_bf16 v[52:55], v[100:103], v[172:175], v[52:55]
    ds_read_b128 v[100:103], v0 offset:7168
    s_waitcnt lgkmcnt(10)
    v_mfma_f32_16x16x32_bf16 v[40:43], v[56:59], v[176:179], v[40:43]
    ds_read_b128 v[56:59], v0 offset:8192
    v_mfma_f32_16x16x32_bf16 v[44:47], v[60:63], v[176:179], v[44:47]
    ds_read_b128 v[60:63], v0 offset:9216
    s_waitcnt lgkmcnt(10)
    v_mfma_f32_16x16x32_bf16 v[48:51], v[64:67], v[176:179], v[48:51]
    ds_read_b128 v[64:67], v0 offset:10240
    s_waitcnt vmcnt(4)
    s_mov_b64 exec, 1
    s_cmp_eq_u32 s55, 0
    s_cbranch_scc1 ool_167
    buffer_store_dword v36, off, s[24:27], s96 offset:64
back_168:
    s_mov_b64 exec, -1
    v_mfma_f32_16x16x32_bf16 v[52:55], v[68:71], v[176:179], v[52:55]
    ds_read_b128 v[68:71], v0 offset:11264
    s_waitcnt lgkmcnt(10)
    v_mfma_f32_16x16x32_bf16 v[40:43], v[72:75], v[180:183], v[40:43]
    ds_read_b128 v[72:75], v0 offset:12288
    v_mfma_f32_16x16x32_bf16 v[44:47], v[76:79], v[180:183], v[44:47]
    ds_read_b128 v[76:79], v0 offset:13312
    s_waitcnt lgkmcnt(10)
    v_mfma_f32_16x16x32_bf16 v[48:51], v[80:83], v[180:183], v[48:51]
    ds_read_b128 v[80:83], v0 offset:14336
    v_mfma_f32_16x16x32_bf16 v[52:55], v[84:87], v[180:183], v[52:55]
    ds_read_b128 v[84:87], v0 offset:15360
    s_waitcnt lgkmcnt(10)
    v_mfma_f32_16x16x32_bf16 v[40:43], v[88:91], v[184:187], v[40:43]
    ds_read_b128 v[88:91], v0 offset:16384
    v_mfma_f32_16x16x32_bf16 v[44:47], v[92:95], v[184:187], v[44:47]
    ds_read_b128 v[92:95], v0 offset:17408
    s_waitcnt lgkmcnt(10)
    v_mfma_f32_16x16x32_bf16 v[48:51], v[96:99], v[184:187], v[48:51]
    ds_read_b128 v[96:99], v0 offset:18432
    v_mfma_f32_16x16x32_bf16 v[52:55], v[100:103], v[184:187], v[52:55]
    ds_read_b128 v[100:103], v0 offset:19456
    s_waitcnt lgkmcnt(10)
    v_mfma_f32_16x16x32_bf16 v[40:43], v[56:59], v[188:191], v[40:43]
    ds_read_b128 v[56:59], v0 offset:20480
    v_mfma_f32_16x16x32_bf16 v[44:47], v[60:63], v[188:191], v[44:47]
    ds_read_b128 v[60:63], v0 offset:21504
    s_waitcnt lgkmcnt(10)
    v_mfma_f32_16x16x32_bf16 v[48:51], v[64:67], v[188:191], v[48:51]
    ds_read_b128 v[64:67], v0 offset:22528
    buffer_load_dword v244, v254, s[24:27], s68 offen offset:64 sc1
    v_mfma_f32_16x16x32_bf16 v[52:55], v[68:71], v[188:191], v[52:55]
    ds_read_b128 v[68:71], v0 offset:23552
    s_waitcnt lgkmcnt(10)
    v_mfma_f32_16x16x32_bf16 v[40:43], v[72:75], v[192:195], v[40:43]
    ds_read_b128 v[72:75], v0 offset:24576
    v_mfma_f32_16x16x32_bf16 v[44:47], v[76:79], v[192:195], v[44:47]
    ds_read_b128 v[76:79], v0 offset:25600
    s_waitcnt lgkmcnt(10)
    v_mfma_f32_16x16x32_bf16 v[48:51], v[80:83], v[192:195], v[48:51]
    ds_read_b128 v[80:83], v0 offset:26624
    v_mfma_f32_16x16x32_bf16 v[52:55], v[84:87], v[192:195], v[52:55]
    ds_read_b128 v[84:87], v0 offset:27648
    s_waitcnt lgkmcnt(10)
    v_mfma_f32_16x16x32_bf16 v[40:43], v[88:91], v[212:215], v[40:43]
    ds_read_b128 v[88:91], v0 offset:28672
    v_mfma_f32_16x16x32_bf16 v[44:47], v[92:95], v[212:215], v[44:47]
    ds_read_b128 v[92:95], v0 offset:29696
    s_waitcnt lgkmcnt(10)
    v_mfma_f32_16x16x32_bf16 v[48:51], v[96:99], v[212:215], v[48:51]
    ds_read_b128 v[96:99], v0 offset:30720
    v_mfma_f32_16x16x32_bf16 v[52:55], v[100:103], v[212:215], v[52:55]
    ds_read_b128 v[100:103], v0 offset:31744
    s_waitcnt lgkmcnt(10)
    v_mfma_f32_16x16x32_bf16 v[40:43], v[56:59], v[216:219], v[40:43]
    ds_read_b128 v[56:59], v0 offset:32768
    v_mfma_f32_16x16x32_bf16 v[44:47], v[60:63], v[216:219], v[44:47]
    ds_read_b128 v[60:63], v0 offset:33792
    s_waitcnt lgkmcnt(10)
    v_mfma_f32_16x16x32_bf16 v[48:51], v[64:67], v[216:219], v[48:51]
    ds_read_b128 v[64:67], v0 offset:34816
    s_waitcnt vmcnt(0)
    v_cmp_ne_u32 vcc, 1, v244
    s_cbranch_vccnz ool_169
back_170:
    buffer_load_dwordx2 v[136:137], v21, s[36:39], s82 offen offset:0 sc1
    buffer_load_dwordx2 v[138:139], v21, s[36:39], s82 offen offset:1024 sc1
    buffer_load_dwordx2 v[140:141], v21, s[36:39], s82 offen offset:2048 sc1
    buffer_load_dwordx2 v[142:143], v21, s[36:39], s82 offen offset:3072 sc1
    buffer_load_dwordx2 v[144:145], v21, s[36:39], s83 offen offset:0 sc1
    buffer_load_dwordx2 v[146:147], v21, s[36:39], s83 offen offset:1024 sc1
    buffer_load_dwordx2 v[148:149], v21, s[36:39], s83 offen offset:2048 sc1
    buffer_load_dwordx2 v[150:151], v21, s[36:39], s83 offen offset:3072 sc1
    v_mfma_f32_16x16x32_bf16 v[52:55], v[68:71], v[216:219], v[52:55]
    ds_read_b128 v[68:71], v0 offset:35840
    s_waitcnt lgkmcnt(10)
    v_mfma_f32_16x16x32_bf16 v[40:43], v[72:75], v[220:223], v[40:43]
    ds_read_b128 v[72:75], v0 offset:36864
    v_mfma_f32_16x16x32_bf16 v[44:47], v[76:79], v[220:223], v[44:47]
    ds_read_b128 v[76:79], v0 offset:37888
    s_waitcnt lgkmcnt(10)
    v_mfma_f32_16x16x32_bf16 v[48:51], v[80:83], v[220:223], v[48:51]
    ds_read_b128 v[80:83], v0 offset:38912
    s_cmp_eq_u32 s43, 0
    s_cbranch_scc0 skip_173
    s_lshl_b32 s99, s40, 11
    s_add_u32 s99, s99, 14336
    v_add_u32 v228, s99, v0
    v_mov_b32 v229, s93
    v_add_co_u32 v228, vcc, s92, v228
    s_nop 1
    v_addc_co_u32 v229, vcc, 0, v229, vcc
    global_load_dwordx4 v[184:187], v[228:229], off offset:0
    global_load_dwordx4 v[188:191], v[228:229], off offset:1024
skip_173:
    v_mfma_f32_16x16x32_bf16 v[52:55], v[84:87], v[220:223], v[52:55]
    ds_read_b128 v[84:87], v0 offset:39936
    s_waitcnt lgkmcnt(10)
    v_mfma_f32_16x16x32_bf16 v[40:43], v[88:91], v[224:227], v[40:43]
    ds_read_b128 v[88:91], v0 offset:40960
    v_mfma_f32_16x16x32_bf16 v[44:47], v[92:95], v[224:227], v[44:47]
    ds_read_b128 v[92:95], v0 offset:41984
    s_waitcnt lgkmcnt(10)
    v_mfma_f32_16x16x32_bf16 v[48:51], v[96:99], v[224:227], v[48:51]
    ds_read_b128 v[96:99], v0 offset:43008
    v_mfma_f32_16x16x32_bf16 v[52:55], v[100:103], v[224:227], v[52:55]
    ds_read_b128 v[100:103], v0 offset:44032
    s_waitcnt lgkmcnt(10)
    v_mfma_f32_16x16x32_bf16 v[40:43], v[56:59], v[196:199], v[40:43]
    ds_read_b128 v[56:59], v0 offset:45056
    v_mfma_f32_16x16x32_bf16 v[44:47], v[60:63], v[196:199], v[44:47]
    ds_read_b128 v[60:63], v0 offset:46080
    s_waitcnt lgkmcnt(10)
    v_mfma_f32_16x16x32_bf16 v[48:51], v[64:67], v[196:199], v[48:51]
    ds_read_b128 v[64:67], v0 offset:47104
    v_mfma_f32_16x16x32_bf16 v[52:55], v[68:71], v[196:199], v[52:55]
    ds_read_b128 v[68:71], v0 offset:48128
    s_waitcnt lgkmcnt(10)
    v_mfma_f32_16x16x32_bf16 v[40:43], v[72:75], v[200:203], v[40:43]
    ds_read_b128 v[72:75], v0 offset:49152
    v_mfma_f32_16x16x32_bf16 v[44:47], v[76:79], v[200:203], v[44:47]
    ds_read_b128 v[76:79], v0 offset:50176
    s_waitcnt lgkmcnt(10)
    v_mfma_f32_16x16x32_bf16 v[48:51], v[80:83], v[200:203], v[48:51]
    ds_read_b128 v[80:83], v0 offset:51200
    v_mfma_f32_16x16x32_bf16 v[52:55], v[84:87], v[200:203], v[52:55]
    ds_read_b128 v[84:87], v0 offset:52224
    s_waitcnt lgkmcnt(10)
    v_mfma_f32_16x16x32_bf16 v[40:43], v[88:91], v[204:207], v[40:43]
    ds_read_b128 v[88:91], v0 offset:53248
    v_mfma_f32_16x16x32_bf16 v[44:47], v[92:95], v[204:207], v[44:47]
    ds_read_b128 v[92:95], v0 offset:54272
    s_waitcnt lgkmcnt(10)
    v_mfma_f32_16x16x32_bf16 v[48:51], v[96:99], v[204:207], v[48:51]
    ds_read_b128 v[96:99], v0 offset:55296
    v_mfma_f32_16x16x32_bf16 v[52:55], v[100:103], v[204:207], v[52:55]
    ds_read_b128 v[100:103], v0 offset:56320
    s_waitcnt lgkmcnt(10)
    v_mfma_f32_16x16x32_bf16 v[40:43], v[56:59], v[208:211], v[40:43]
    ds_read_b128 v[56:59], v0 offset:57344
    v_mfma_f32_16x16x32_bf16 v[44:47], v[60:63], v[208:211], v[44:47]
    ds_read_b128 v[60:63], v0 offset:58368
    s_waitcnt lgkmcnt(10)
    v_mfma_f32_16x16x32_bf16 v[48:51], v[64:67], v[208:211], v[48:51]
    ds_read_b128 v[64:67], v0 offset:59392
    v_mfma_f32_16x16x32_bf16 v[52:55], v[68:71], v[208:211], v[52:55]
    ds_read_b128 v[68:71], v0 offset:60416
    s_waitcnt lgkmcnt(10)
    s_waitcnt vmcnt(6)
    v_mfma_f32_16x16x32_bf16 v[40:43], v[72:75], v[136:139], v[40:43]
    ds_read_b128 v[72:75], v0 offset:61440
    v_mfma_f32_16x16x32_bf16 v[44:47], v[76:79], v[136:139], v[44:47]
    ds_read_b128 v[76:79], v0 offset:62464
    s_waitcnt lgkmcnt(10)
    v_mfma_f32_16x16x32_bf16 v[48:51], v[80:83], v[136:139], v[48:51]
    ds_read_b128 v[80:83], v0 offset:63488
    v_mfma_f32_16x16x32_bf16 v[52:55], v[84:87], v[136:139], v[52:55]
    ds_read_b128 v[84:87], v0 offset:64512
    s_waitcnt lgkmcnt(10)
    s_waitcnt vmcnt(4)
    v_mfma_f32_16x16x32_bf16 v[40:43], v[88:91], v[140:143], v[40:43]
    v_mfma_f32_16x16x32_bf16 v[44:47], v[92:95], v[140:143], v[44:47]
    s_waitcnt lgkmcnt(8)
    v_mfma_f32_16x16x32_bf16 v[48:51], v[96:99], v[140:143], v[48:51]
    v_mfma_f32_16x16x32_bf16 v[52:55], v[100:103], v[140:143], v[52:55]
    s_waitcnt lgkmcnt(6)
    s_waitcnt vmcnt(2)
    v_mfma_f32_16x16x32_bf16 v[40:43], v[56:59], v[144:147], v[40:43]
    v_mfma_f32_16x16x32_bf16 v[44:47], v[60:63], v[144:147], v[44:47]
    s_waitcnt lgkmcnt(4)
    v_mfma_f32_16x16x32_bf16 v[48:51], v[64:67], v[144:147], v[48:51]
    v_mfma_f32_16x16x32_bf16 v[52:55], v[68:71], v[144:147], v[52:55]
    s_waitcnt lgkmcnt(2)
    s_waitcnt vmcnt(0)
    v_mfma_f32_16x16x32_bf16 v[40:43], v[72:75], v[148:151], v[40:43]
    v_mfma_f32_16x16x32_bf16 v[44:47], v[76:79], v[148:151], v[44:47]
    s_waitcnt lgkmcnt(0)
    v_mfma_f32_16x16x32_bf16 v[48:51], v[80:83], v[148:151], v[48:51]
    v_mfma_f32_16x16x32_bf16 v[52:55], v[84:87], v[148:151], v[52:55]
    s_cmp_eq_u32 s43, 1
    s_cbranch_scc0 skip_174
    s_nop 1
    v_cvt_pk_bf16_f32 v104, v40, v41
    v_cvt_pk_bf16_f32 v105, v42, v43
    v_cvt_pk_bf16_f32 v106, v44, v45
    v_cvt_pk_bf16_f32 v107, v46, v47
    v_cvt_pk_bf16_f32 v108, v48, v49
    v_cvt_pk_bf16_f32 v109, v50, v51
    v_cvt_pk_bf16_f32 v110, v52, v53
    v_cvt_pk_bf16_f32 v111, v54, v55
    ds_write_b128 v248, v[104:107] offset:0
    ds_write_b128 v248, v[108:111] offset:16
    ds_read_b128 v[232:235], v249 offset:0
    ds_read_b128 v[236:239], v249 offset:1152
    s_waitcnt lgkmcnt(1)
    buffer_store_dwordx4 v[232:235], v253, s[20:23], s86 offen sc1
    s_waitcnt lgkmcnt(0)
    buffer_store_dwordx4 v[236:239], v253, s[20:23], s87 offen sc1
L_exit:
    s_endpgm
skip_174:
    s_nop 1
    v_pk_add_f32 v[34:35], v[40:41], v[42:43]
    v_pk_mul_f32 v[36:37], v[40:41], v[40:41]
    v_pk_fma_f32 v[36:37], v[42:43], v[42:43], v[36:37]
    v_pk_add_f32 v[34:35], v[34:35], v[44:45]
    v_pk_fma_f32 v[36:37], v[44:45], v[44:45], v[36:37]
    v_pk_add_f32 v[34:35], v[34:35], v[46:47]
    v_pk_fma_f32 v[36:37], v[46:47], v[46:47], v[36:37]
    v_pk_add_f32 v[34:35], v[34:35], v[48:49]
    v_pk_fma_f32 v[36:37], v[48:49], v[48:49], v[36:37]
    v_pk_add_f32 v[34:35], v[34:35], v[50:51]
    v_pk_fma_f32 v[36:37], v[50:51], v[50:51], v[36:37]
    v_pk_add_f32 v[34:35], v[34:35], v[52:53]
    v_pk_fma_f32 v[36:37], v[52:53], v[52:53], v[36:37]
    v_pk_add_f32 v[34:35], v[34:35], v[54:55]
    v_pk_fma_f32 v[36:37], v[54:55], v[54:55], v[36:37]
    v_add_f32 v32, v34, v35
    v_add_f32 v33, v36, v37
    s_nop 1
    v_permlane16_swap_b32 v32, v33
    v_add_f32 v32, v32, v33
    v_mov_b32 v33, v32
    s_nop 1
    v_permlane32_swap_b32 v32, v33
    v_add_f32 v32, v32, v33
    v_mov_b32 v33, v32
    s_nop 1
    v_permlane16_swap_b32 v32, v33
    s_add_u32 s72, s56, s69
    s_add_u32 s72, s72, 0x40000
    s_mov_b64 exec, 0xffff
    s_cmp_eq_u32 s55, 0
    s_cbranch_scc1 ool_175
    buffer_store_dwordx2 v[32:33], v20, s[24:27], s72 offen
back_176:
    s_mov_b64 exec, -1
    s_barrier
    v_cvt_pk_bf16_f32 v104, v40, v41
    v_cvt_pk_bf16_f32 v105, v42, v43
    v_cvt_pk_bf16_f32 v106, v44, v45
    v_cvt_pk_bf16_f32 v107, v46, v47
    v_cvt_pk_bf16_f32 v108, v48, v49
    v_cvt_pk_bf16_f32 v109, v50, v51
    v_cvt_pk_bf16_f32 v110, v52, v53
    v_cvt_pk_bf16_f32 v111, v54, v55
    s_mov_b32 s43, 1
    s_mov_b32 s89, s55
    s_mov_b32 s100, 0
    s_add_u32 s36, s36, 0x1000000
    s_addc_u32 s37, s37, 0
    s_mov_b32 s38, 0x1000000
    s_mov_b32 s4, s36
    s_mov_b32 s5, s37
    s_mov_b32 s6, 0x1000000
    s_add_u32 s50, s48, 0x200000
    s_add_u32 s49, s50, 2048
    v_mov_b32 v3, v2
    v_mov_b32 v246, v22
    v_add_u32 v247, 576, v22
    v_mov_b32 v16, v250
    s_add_u32 s56, s56, 0x20000
    s_add_u32 s66, s66, 0x20000
    s_add_u32 s67, s67, 0x20000
    s_add_u32 s88, s88, 0x20000
    s_add_u32 s68, s68, 0x20000
    s_add_u32 s0, s0, 0x20000
    s_add_u32 s1, s1, 0x20000
    s_add_u32 s76, s75, 0x200000
    s_add_u32 s77, s75, 0x202000
    s_add_u32 s99, s56, 0x20000
    buffer_load_dwordx2 v[36:37], v20, s[24:27], s99 offen sc1
    buffer_load_dwordx2 v[38:39], v20, s[24:27], s99 offen offset:128 sc1
    s_waitcnt vmcnt(0)
    v_add_f32 v32, v36, v38
    v_add_f32 v33, v37, v39
    v_cmp_u_f32 vcc, v32, v33
    s_cbranch_vccnz ool_177
back_178:
    v_permlane16_swap_b32 v32, v33
    v_add_f32 v32, v32, v33
    v_mov_b32 v33, v32
    s_nop 1
    v_permlane32_swap_b32 v32, v33
    v_add_f32 v32, v32, v33
    v_mov_b32 v33, v32
    s_nop 1
    v_permlane16_swap_b32 v32, v33
    buffer_store_dwordx4 v[104:107], v0, s[36:39], s76 offen sc1
    buffer_store_dwordx4 v[108:111], v0, s[36:39], s77 offen sc1
    s_branch L_layer
ool_9:
rt_11:
    buffer_load_dword v241, off, s[28:31], 0 sc1
    s_waitcnt vmcnt(0)
    v_cmp_ne_u32 vcc, 1, v241
    s_cbranch_vccz rdone_12
    s_sub_u32 s44, s44, 1
    s_cbranch_scc0 rt_11
    s_mov_b32 s44, 0
rdone_12:
    s_branch back_10
ool_18:
    buffer_store_dword v32, off, s[24:27], s99 offset:32 sc1
    s_branch back_19
ool_23:
rt_25:
    buffer_load_dword v241, v23, s[24:27], s65 offen sc1
    s_waitcnt vmcnt(0)
    v_cmp_ne_u32 vcc, 16, v241
    s_cbranch_vccz rdone_26
    s_sub_u32 s44, s44, 1
    s_cbranch_scc0 rt_25
    s_mov_b32 s44, 0
rdone_26:
    s_branch back_24
ool_32:
rt_34:
    buffer_load_dword v248, v254, s[24:27], s66 offen offset:32 sc1
    s_waitcnt vmcnt(0)
    v_cmp_ne_u32 vcc, 1, v248
    s_cbranch_vccz rdone_35
    s_sub_u32 s44, s44, 1
    s_cbranch_scc0 rt_34
    s_mov_b32 s44, 0
rdone_35:
    s_branch back_33
ool_37:
rt_39:
    buffer_load_dwordx4 v[96:99], v4, s[36:39], s76 offen offset:0 sc1
    buffer_load_dwordx4 v[100:103], v4, s[36:39], s76 offen offset:2048 sc1
    buffer_load_dwordx4 v[104:107], v4, s[36:39], s77 offen offset:0 sc1
    buffer_load_dwordx4 v[108:111], v4, s[36:39], s77 offen offset:2048 sc1
    s_waitcnt vmcnt(0)
    v_max3_u32 v32, v99, v103, v107
    v_max_u32 v32, v32, v111
    v_cmp_eq_u32 vcc, -1, v32
    s_cbranch_vccz rdone_40
    s_sub_u32 s44, s44, 1
    s_cbranch_scc0 rt_39
    s_mov_b32 s44, 0
rdone_40:
    buffer_load_dwordx4 v[112:115], v4, s[36:39], s78 offen offset:0 sc1
    buffer_load_dwordx4 v[116:119], v4, s[36:39], s78 offen offset:2048 sc1
    buffer_load_dwordx4 v[120:123], v4, s[36:39], s79 offen offset:0 sc1
    buffer_load_dwordx4 v[124:127], v4, s[36:39], s79 offen offset:2048 sc1
    buffer_load_dwordx4 v[128:131], v4, s[36:39], s76 offen offset:256 sc1
    buffer_load_dwordx4 v[132:135], v4, s[36:39], s76 offen offset:2304 sc1
    buffer_load_dwordx4 v[136:139], v4, s[36:39], s77 offen offset:256 sc1
    buffer_load_dwordx4 v[140:143], v4, s[36:39], s77 offen offset:2304 sc1
    buffer_load_dwordx4 v[144:147], v4, s[36:39], s78 offen offset:256 sc1
    buffer_load_dwordx4 v[148:151], v4, s[36:39], s78 offen offset:2304 sc1
    buffer_load_dwordx4 v[152:155], v4, s[36:39], s79 offen offset:256 sc1
    buffer_load_dwordx4 v[156:159], v4, s[36:39], s79 offen offset:2304 sc1
    buffer_load_dwordx4 v[224:227], v3, s[4:7], s50 offen sc1
    buffer_load_dwordx4 v[228:231], v3, s[4:7], s49 offen sc1
    s_branch back_38
ool_41:
rt_43:
    buffer_load_dwordx4 v[112:115], v4, s[36:39], s78 offen offset:0 sc1
    buffer_load_dwordx4 v[116:119], v4, s[36:39], s78 offen offset:2048 sc1
    buffer_load_dwordx4 v[120:123], v4, s[36:39], s79 offen offset:0 sc1
    buffer_load_dwordx4 v[124:127], v4, s[36:39], s79 offen offset:2048 sc1
    s_waitcnt vmcnt(0)
    v_max3_u32 v32, v115, v119, v123
    v_max_u32 v32, v32, v127
    v_cmp_eq_u32 vcc, -1, v32
    s_cbranch_vccz rdone_44
    s_sub_u32 s44, s44, 1
    s_cbranch_scc0 rt_43
    s_mov_b32 s44, 0
rdone_44:
    buffer_load_dwordx4 v[128:131], v4, s[36:39], s76 offen offset:256 sc1
    buffer_load_dwordx4 v[132:135], v4, s[36:39], s76 offen offset:2304 sc1
    buffer_load_dwordx4 v[136:139], v4, s[36:39], s77 offen offset:256 sc1
    buffer_load_dwordx4 v[140:143], v4, s[36:39], s77 offen offset:2304 sc1
    buffer_load_dwordx4 v[144:147], v4, s[36:39], s78 offen offset:256 sc1
    buffer_load_dwordx4 v[148:151], v4, s[36:39], s78 offen offset:2304 sc1
    buffer_load_dwordx4 v[152:155], v4, s[36:39], s79 offen offset:256 sc1
    buffer_load_dwordx4 v[156:159], v4, s[36:39], s79 offen offset:2304 sc1
    buffer_load_dwordx4 v[224:227], v3, s[4:7], s50 offen sc1
    buffer_load_dwordx4 v[228:231], v3, s[4:7], s49 offen sc1
    s_branch back_42
ool_45:
rt_47:
    buffer_load_dwordx4 v[128:131], v4, s[36:39], s76 offen offset:256 sc1
    buffer_load_dwordx4 v[132:135], v4, s[36:39], s76 offen offset:2304 sc1
    buffer_load_dwordx4 v[136:139], v4, s[36:39], s77 offen offset:256 sc1
    buffer_load_dwordx4 v[140:143], v4, s[36:39], s77 offen offset:2304 sc1
    s_waitcnt vmcnt(0)
    v_max3_u32 v32, v131, v135, v139
    v_max_u32 v32, v32, v143
    v_cmp_eq_u32 vcc, -1, v32
    s_cbranch_vccz rdone_48
    s_sub_u32 s44, s44, 1
    s_cbranch_scc0 rt_47
    s_mov_b32 s44, 0
rdone_48:
    buffer_load_dwordx4 v[144:147], v4, s[36:39], s78 offen offset:256 sc1
    buffer_load_dwordx4 v[148:151], v4, s[36:39], s78 offen offset:2304 sc1
    buffer_load_dwordx4 v[152:155], v4, s[36:39], s79 offen offset:256 sc1
    buffer_load_dwordx4 v[156:159], v4, s[36:39], s79 offen offset:2304 sc1
    buffer_load_dwordx4 v[224:227], v3, s[4:7], s50 offen sc1
    buffer_load_dwordx4 v[228:231], v3, s[4:7], s49 offen sc1
    s_branch back_46
ool_49:
rt_51:
    buffer_load_dwordx4 v[144:147], v4, s[36:39], s78 offen offset:256 sc1
    buffer_load_dwordx4 v[148:151], v4, s[36:39], s78 offen offset:2304 sc1
    buffer_load_dwordx4 v[152:155], v4, s[36:39], s79 offen offset:256 sc1
    buffer_load_dwordx4 v[156:159], v4, s[36:39], s79 offen offset:2304 sc1
    s_waitcnt vmcnt(0)
    v_max3_u32 v32, v147, v151, v155
    v_max_u32 v32, v32, v159
    v_cmp_eq_u32 vcc, -1, v32
    s_cbranch_vccz rdone_52
    s_sub_u32 s44, s44, 1
    s_cbranch_scc0 rt_51
    s_mov_b32 s44, 0
rdone_52:
    s_branch back_50
ool_55:
    s_waitcnt lgkmcnt(3)
    buffer_store_dwordx4 v[232:235], v2, s[36:39], s73 offen offset:0 sc1
    s_waitcnt lgkmcnt(2)
    buffer_store_dwordx4 v[236:239], v2, s[36:39], s73 offen offset:2048 sc1
    s_branch back_56
ool_58:
    buffer_store_dword v32, off, s[24:27], s0 sc1
    s_branch back_59
ool_64:
    buffer_store_dwordx2 v[32:33], v20, s[24:27], s72 offen sc1
    s_branch back_65
ool_66:
rt_68:
    s_add_u32 s99, s56, 0x0
    buffer_load_dwordx2 v[36:37], v20, s[24:27], s99 offen sc1
    buffer_load_dwordx2 v[38:39], v20, s[24:27], s99 offen offset:128 sc1
    s_waitcnt vmcnt(0)
    v_add_f32 v32, v36, v38
    v_add_f32 v33, v37, v39
    v_cmp_u_f32 vcc, v32, v33
    s_cbranch_vccz rdone_69
    s_sub_u32 s44, s44, 1
    s_cbranch_scc0 rt_68
    s_mov_b32 s44, 0
rdone_69:
    s_branch back_67
ool_72:
rt_74:
    s_add_u32 s99, s52, 0x0
    buffer_load_dwordx4 v[56:59], v23, s[36:39], s99 offen sc1
    buffer_load_dwordx4 v[60:63], v251, s[36:39], s99 offen sc1
    s_waitcnt vmcnt(0)
    v_cmp_u_f32 vcc, v59, v63
    s_cbranch_vccz rdone_75
    s_sub_u32 s44, s44, 1
    s_cbranch_scc0 rt_74
    s_mov_b32 s44, 0
rdone_75:
    s_branch back_73
ool_76:
rt_78:
    s_add_u32 s99, s52, 0x800
    buffer_load_dwordx4 v[64:67], v23, s[36:39], s99 offen sc1
    buffer_load_dwordx4 v[68:71], v251, s[36:39], s99 offen sc1
    s_waitcnt vmcnt(0)
    v_cmp_u_f32 vcc, v67, v71
    s_cbranch_vccz rdone_79
    s_sub_u32 s44, s44, 1
    s_cbranch_scc0 rt_78
    s_mov_b32 s44, 0
rdone_79:
    s_branch back_77
ool_80:
rt_82:
    s_add_u32 s99, s52, 0x1000
    buffer_load_dwordx4 v[72:75], v23, s[36:39], s99 offen sc1
    buffer_load_dwordx4 v[76:79], v251, s[36:39], s99 offen sc1
    s_waitcnt vmcnt(0)
    v_cmp_u_f32 vcc, v75, v79
    s_cbranch_vccz rdone_83
    s_sub_u32 s44, s44, 1
    s_cbranch_scc0 rt_82
    s_mov_b32 s44, 0
rdone_83:
    s_branch back_81
ool_84:
rt_86:
    s_add_u32 s99, s52, 0x1800
    buffer_load_dwordx4 v[80:83], v23, s[36:39], s99 offen sc1
    buffer_load_dwordx4 v[84:87], v251, s[36:39], s99 offen sc1
    s_waitcnt vmcnt(0)
    v_cmp_u_f32 vcc, v83, v87
    s_cbranch_vccz rdone_87
    s_sub_u32 s44, s44, 1
    s_cbranch_scc0 rt_86
    s_mov_b32 s44, 0
rdone_87:
    s_branch back_85
ool_88:
rt_90:
    s_add_u32 s99, s52, 0x2000
    buffer_load_dwordx4 v[88:91], v23, s[36:39], s99 offen sc1
    buffer_load_dwordx4 v[92:95], v251, s[36:39], s99 offen sc1
    s_waitcnt vmcnt(0)
    v_cmp_u_f32 vcc, v91, v95
    s_cbranch_vccz rdone_91
    s_sub_u32 s44, s44, 1
    s_cbranch_scc0 rt_90
    s_mov_b32 s44, 0
rdone_91:
    s_branch back_89
ool_92:
rt_94:
    s_add_u32 s99, s52, 0x2800
    buffer_load_dwordx4 v[96:99], v23, s[36:39], s99 offen sc1
    buffer_load_dwordx4 v[100:103], v251, s[36:39], s99 offen sc1
    s_waitcnt vmcnt(0)
    v_cmp_u_f32 vcc, v99, v103
    s_cbranch_vccz rdone_95
    s_sub_u32 s44, s44, 1
    s_cbranch_scc0 rt_94
    s_mov_b32 s44, 0
rdone_95:
    s_branch back_93
ool_96:
rt_98:
    s_add_u32 s99, s52, 0x3000
    buffer_load_dwordx4 v[56:59], v23, s[36:39], s99 offen sc1
    buffer_load_dwordx4 v[60:63], v251, s[36:39], s99 offen sc1
    s_waitcnt vmcnt(0)
    v_cmp_u_f32 vcc, v59, v63
    s_cbranch_vccz rdone_99
    s_sub_u32 s44, s44, 1
    s_cbranch_scc0 rt_98
    s_mov_b32 s44, 0
rdone_99:
    s_branch back_97
ool_100:
rt_102:
    s_add_u32 s99, s52, 0x3800
    buffer_load_dwordx4 v[64:67], v23, s[36:39], s99 offen sc1
    buffer_load_dwordx4 v[68:71], v251, s[36:39], s99 offen sc1
    s_waitcnt vmcnt(0)
    v_cmp_u_f32 vcc, v67, v71
    s_cbranch_vccz rdone_103
    s_sub_u32 s44, s44, 1
    s_cbranch_scc0 rt_102
    s_mov_b32 s44, 0
rdone_103:
    s_branch back_101
ool_104:
rt_106:
    s_add_u32 s99, s52, 0x4000
    buffer_load_dwordx4 v[72:75], v23, s[36:39], s99 offen sc1
    buffer_load_dwordx4 v[76:79], v251, s[36:39], s99 offen sc1
    s_waitcnt vmcnt(0)
    v_cmp_u_f32 vcc, v75, v79
    s_cbranch_vccz rdone_107
    s_sub_u32 s44, s44, 1
    s_cbranch_scc0 rt_106
    s_mov_b32 s44, 0
rdone_107:
    s_branch back_105
ool_108:
rt_110:
    s_add_u32 s99, s52, 0x4800
    buffer_load_dwordx4 v[80:83], v23, s[36:39], s99 offen sc1
    buffer_load_dwordx4 v[84:87], v251, s[36:39], s99 offen sc1
    s_waitcnt vmcnt(0)
    v_cmp_u_f32 vcc, v83, v87
    s_cbranch_vccz rdone_111
    s_sub_u32 s44, s44, 1
    s_cbranch_scc0 rt_110
    s_mov_b32 s44, 0
rdone_111:
    s_branch back_109
ool_112:
rt_114:
    s_add_u32 s99, s52, 0x5000
    buffer_load_dwordx4 v[88:91], v23, s[36:39], s99 offen sc1
    buffer_load_dwordx4 v[92:95], v251, s[36:39], s99 offen sc1
    s_waitcnt vmcnt(0)
    v_cmp_u_f32 vcc, v91, v95
    s_cbranch_vccz rdone_115
    s_sub_u32 s44, s44, 1
    s_cbranch_scc0 rt_114
    s_mov_b32 s44, 0
rdone_115:
    s_branch back_113
ool_116:
rt_118:
    buffer_load_dword v244, off, s[24:27], s88 sc1
    s_waitcnt vmcnt(0)
    v_cmp_ne_u32 vcc, 32, v244
    s_cbranch_vccz rdone_119
    s_sub_u32 s44, s44, 1
    s_cbranch_scc0 rt_118
    s_mov_b32 s44, 0
rdone_119:
    s_branch back_117
ool_120:
rt_122:
    s_add_u32 s99, s52, 0x5800
    buffer_load_dwordx4 v[96:99], v23, s[36:39], s99 offen sc1
    buffer_load_dwordx4 v[100:103], v251, s[36:39], s99 offen sc1
    s_waitcnt vmcnt(0)
    v_cmp_u_f32 vcc, v99, v103
    s_cbranch_vccz rdone_123
    s_sub_u32 s44, s44, 1
    s_cbranch_scc0 rt_122
    s_mov_b32 s44, 0
rdone_123:
    s_branch back_121
ool_124:
rt_126:
    s_add_u32 s99, s52, 0x6000
    buffer_load_dwordx4 v[56:59], v23, s[36:39], s99 offen sc1
    buffer_load_dwordx4 v[60:63], v251, s[36:39], s99 offen sc1
    s_waitcnt vmcnt(0)
    v_cmp_u_f32 vcc, v59, v63
    s_cbranch_vccz rdone_127
    s_sub_u32 s44, s44, 1
    s_cbranch_scc0 rt_126
    s_mov_b32 s44, 0
rdone_127:
    s_branch back_125
ool_128:
rt_130:
    s_add_u32 s99, s52, 0x6800
    buffer_load_dwordx4 v[64:67], v23, s[36:39], s99 offen sc1
    buffer_load_dwordx4 v[68:71], v251, s[36:39], s99 offen sc1
    s_waitcnt vmcnt(0)
    v_cmp_u_f32 vcc, v67, v71
    s_cbranch_vccz rdone_131
    s_sub_u32 s44, s44, 1
    s_cbranch_scc0 rt_130
    s_mov_b32 s44, 0
rdone_131:
    s_branch back_129
ool_132:
rt_134:
    s_add_u32 s99, s52, 0x7000
    buffer_load_dwordx4 v[72:75], v23, s[36:39], s99 offen sc1
    buffer_load_dwordx4 v[76:79], v251, s[36:39], s99 offen sc1
    s_waitcnt vmcnt(0)
    v_cmp_u_f32 vcc, v75, v79
    s_cbranch_vccz rdone_135
    s_sub_u32 s44, s44, 1
    s_cbranch_scc0 rt_134
    s_mov_b32 s44, 0
rdone_135:
    s_branch back_133
ool_136:
rt_138:
    s_add_u32 s99, s52, 0x7800
    buffer_load_dwordx4 v[80:83], v23, s[36:39], s99 offen sc1
    buffer_load_dwordx4 v[84:87], v251, s[36:39], s99 offen sc1
    s_waitcnt vmcnt(0)
    v_cmp_u_f32 vcc, v83, v87
    s_cbranch_vccz rdone_139
    s_sub_u32 s44, s44, 1
    s_cbranch_scc0 rt_138
    s_mov_b32 s44, 0
rdone_139:
    s_branch back_137
ool_140:
    buffer_store_dwordx4 v[240:243], v0, s[36:39], s53 offen offset:0 sc1
    s_branch back_141
ool_142:
    buffer_store_dword v36, off, s[24:27], s96 offset:96 sc1
    s_branch back_143
ool_145:
    buffer_store_dwordx4 v[240:243], v0, s[36:39], s73 offen offset:0 sc1
    s_branch back_146
ool_147:
rt_149:
    buffer_load_dword v244, v254, s[24:27], s68 offen offset:96 sc1
    s_waitcnt vmcnt(0)
    v_cmp_ne_u32 vcc, 1, v244
    s_cbranch_vccz rdone_150
    s_sub_u32 s44, s44, 1
    s_cbranch_scc0 rt_149
    s_mov_b32 s44, 0
rdone_150:
    s_branch back_148
ool_151:
    buffer_store_dword v36, off, s[24:27], s96 offset:0 sc1
    s_branch back_152
ool_153:
    buffer_store_dwordx4 v[240:243], v0, s[36:39], s84 offen sc1
    s_branch back_154
ool_155:
rt_157:
    buffer_load_dword v244, v254, s[24:27], s68 offen offset:0 sc1
    s_waitcnt vmcnt(0)
    v_cmp_ne_u32 vcc, 1, v244
    s_cbranch_vccz rdone_158
    s_sub_u32 s44, s44, 1
    s_cbranch_scc0 rt_157
    s_mov_b32 s44, 0
rdone_158:
    s_branch back_156
ool_159:
    buffer_store_dword v36, off, s[24:27], s96 offset:32 sc1
    s_branch back_160
ool_161:
rt_163:
    buffer_load_dword v244, v254, s[24:27], s68 offen offset:32 sc1
    s_waitcnt vmcnt(0)
    v_cmp_ne_u32 vcc, 1, v244
    s_cbranch_vccz rdone_164
    s_sub_u32 s44, s44, 1
    s_cbranch_scc0 rt_163
    s_mov_b32 s44, 0
rdone_164:
    s_branch back_162
ool_165:
    buffer_store_dwordx2 v[240:241], v21, s[36:39], s85 offen sc1
    s_branch back_166
ool_167:
    buffer_store_dword v36, off, s[24:27], s96 offset:64 sc1
    s_branch back_168
ool_169:
rt_171:
    buffer_load_dword v244, v254, s[24:27], s68 offen offset:64 sc1
    s_waitcnt vmcnt(0)
    v_cmp_ne_u32 vcc, 1, v244
    s_cbranch_vccz rdone_172
    s_sub_u32 s44, s44, 1
    s_cbranch_scc0 rt_171
    s_mov_b32 s44, 0
rdone_172:
    s_branch back_170
ool_175:
    buffer_store_dwordx2 v[32:33], v20, s[24:27], s72 offen sc1
    s_branch back_176
ool_177:
rt_179:
    s_add_u32 s99, s56, 0x20000
    buffer_load_dwordx2 v[36:37], v20, s[24:27], s99 offen sc1
    buffer_load_dwordx2 v[38:39], v20, s[24:27], s99 offen offset:128 sc1
    s_waitcnt vmcnt(0)
    v_add_f32 v32, v36, v38
    v_add_f32 v33, v37, v39
    v_cmp_u_f32 vcc, v32, v33
    s_cbranch_vccz rdone_180
    s_sub_u32 s44, s44, 1
    s_cbranch_scc0 rt_179
    s_mov_b32 s44, 0
rdone_180:
    s_branch back_178

.p2align 8
.type L_table,@object
L_table:
.long 0x3f803f80,0x3f803f80,0x3f803f80,0x3f803f80,0x3f7b3f80,0x3f553f6d,0x3f0e3f35,0x3e483ec4
.long 0x3f6d3f80,0x3ec43f35,0xbec40000,0xbf6dbf35,0x3f553f80,0xbe483ec4,0xbf7bbf35,0xbf0ebf6d
.long 0xbf803f80,0xbf803f80,0xbf803f80,0xbf803f80,0xbf7b3f80,0xbf553f6d,0xbf0e3f35,0xbe483ec4
.long 0xbf6d3f80,0xbec43f35,0x3ec40000,0x3f6dbf35,0xbf553f80,0x3e483ec4,0x3f7bbf35,0x3f0ebf6d
.long 0x3f353f80,0xbf350000,0xbf35bf80,0x3f350000,0x3f0e3f80,0xbf7bbec4,0x3e48bf35,0x3f553f6d
.long 0x3ec43f80,0xbf6dbf35,0x3f6d0000,0xbec43f35,0x3e483f80,0xbf0ebf6d,0x3f553f35,0xbf7bbec4
.long 0xbf353f80,0x3f350000,0x3f35bf80,0xbf350000,0xbf0e3f80,0x3f7bbec4,0xbe48bf35,0xbf553f6d
.long 0xbec43f80,0x3f6dbf35,0xbf6d0000,0x3ec43f35,0xbe483f80,0x3f0ebf6d,0xbf553f35,0x3f7bbec4
.long 0x3f80,0xbf80,0x3f80,0xbf80,0xbe483f80,0x3f0ebf6d,0xbf553f35,0x3f7bbec4
.long 0xbec43f80,0x3f6dbf35,0xbf6d0000,0x3ec43f35,0xbf0e3f80,0x3f7bbec4,0xbe48bf35,0xbf553f6d
.long 0x3f80,0xbf80,0x3f80,0xbf80,0x3e483f80,0xbf0ebf6d,0x3f553f35,0xbf7bbec4
.long 0x3ec43f80,0xbf6dbf35,0x3f6d0000,0xbec43f35,0x3f0e3f80,0xbf7bbec4,0x3e48bf35,0x3f553f6d
.long 0xbf353f80,0x3f350000,0x3f35bf80,0xbf350000,0xbf553f80,0x3e483ec4,0x3f7bbf35,0x3f0ebf6d
.long 0xbf6d3f80,0xbec43f35,0x3ec40000,0x3f6dbf35,0xbf7b3f80,0xbf553f6d,0xbf0e3f35,0xbe483ec4
.long 0x3f353f80,0xbf350000,0xbf35bf80,0x3f350000,0x3f553f80,0xbe483ec4,0xbf7bbf35,0xbf0ebf6d
.long 0x3f6d3f80,0x3ec43f35,0xbec40000,0xbf6dbf35,0x3f7b3f80,0x3f553f6d,0x3f0e3f35,0x3e483ec4
.long 0x3f803f80,0x3f803f80,0x3f803f80,0x3f803f80,0xbe480000,0xbf0ebec4,0xbf55bf35,0xbf7bbf6d
.long 0xbf6dbf80,0xbec4bf35,0x3ec40000,0x3f6d3f35,0x3f0e0000,0x3f7b3f6d,0x3e483f35,0xbf55bec4
.long 0xbf803f80,0xbf803f80,0xbf803f80,0xbf803f80,0x3e480000,0x3f0ebec4,0x3f55bf35,0x3f7bbf6d
.long 0x3f6dbf80,0x3ec4bf35,0xbec40000,0xbf6d3f35,0xbf0e0000,0xbf7b3f6d,0xbe483f35,0x3f55bec4
.long 0x3f353f80,0xbf350000,0xbf35bf80,0x3f350000,0xbf550000,0xbe48bf6d,0x3f7b3f35,0xbf0e3ec4
.long 0xbec4bf80,0x3f6d3f35,0xbf6d0000,0x3ec4bf35,0x3f7b0000,0xbf553ec4,0x3f0ebf35,0xbe483f6d
.long 0xbf353f80,0x3f350000,0x3f35bf80,0xbf350000,0x3f550000,0x3e48bf6d,0xbf7b3f35,0x3f0e3ec4
.long 0x3ec4bf80,0xbf6d3f35,0x3f6d0000,0xbec4bf35,0xbf7b0000,0x3f553ec4,0xbf0ebf35,0x3e483f6d
.long 0x3f80,0xbf80,0x3f80,0xbf80,0xbf7b0000,0x3f553ec4,0xbf0ebf35,0x3e483f6d
.long 0x3ec4bf80,0xbf6d3f35,0x3f6d0000,0xbec4bf35,0x3f550000,0x3e48bf6d,0xbf7b3f35,0x3f0e3ec4
.long 0x3f80,0xbf80,0x3f80,0xbf80,0x3f7b0000,0xbf553ec4,0x3f0ebf35,0xbe483f6d
.long 0xbec4bf80,0x3f6d3f35,0xbf6d0000,0x3ec4bf35,0xbf550000,0xbe48bf6d,0x3f7b3f35,0xbf0e3ec4
.long 0xbf353f80,0x3f350000,0x3f35bf80,0xbf350000,0xbf0e0000,0xbf7b3f6d,0xbe483f35,0x3f55bec4
.long 0x3f6dbf80,0x3ec4bf35,0xbec40000,0xbf6d3f35,0x3e480000,0x3f0ebec4,0x3f55bf35,0x3f7bbf6d
.long 0x3f353f80,0xbf350000,0xbf35bf80,0x3f350000,0x3f0e0000,0x3f7b3f6d,0x3e483f35,0xbf55bec4
.long 0xbf6dbf80,0xbec4bf35,0x3ec40000,0x3f6d3f35,0xbe480000,0xbf0ebec4,0xbf55bf35,0xbf7bbf6d
.long 0x3f803f80,0x3f803f80,0x3f803f80,0x3f803f80,0xbf7bbf80,0xbf55bf6d,0xbf0ebf35,0xbe48bec4
.long 0x3f6d3f80,0x3ec43f35,0xbec40000,0xbf6dbf35,0xbf55bf80,0x3e48bec4,0x3f7b3f35,0x3f0e3f6d
.long 0xbf803f80,0xbf803f80,0xbf803f80,0xbf803f80,0x3f7bbf80,0x3f55bf6d,0x3f0ebf35,0x3e48bec4
.long 0xbf6d3f80,0xbec43f35,0x3ec40000,0x3f6dbf35,0x3f55bf80,0xbe48bec4,0xbf7b3f35,0xbf0e3f6d
.long 0x3f353f80,0xbf350000,0xbf35bf80,0x3f350000,0xbf0ebf80,0x3f7b3ec4,0xbe483f35,0xbf55bf6d
.long 0x3ec43f80,0xbf6dbf35,0x3f6d0000,0xbec43f35,0xbe48bf80,0x3f0e3f6d,0xbf55bf35,0x3f7b3ec4
.long 0xbf353f80,0x3f350000,0x3f35bf80,0xbf350000,0x3f0ebf80,0xbf7b3ec4,0x3e483f35,0x3f55bf6d
.long 0xbec43f80,0x3f6dbf35,0xbf6d0000,0x3ec43f35,0x3e48bf80,0xbf0e3f6d,0x3f55bf35,0xbf7b3ec4
.long 0x3f80,0xbf80,0x3f80,0xbf80,0x3e48bf80,0xbf0e3f6d,0x3f55bf35,0xbf7b3ec4
.long 0xbec43f80,0x3f6dbf35,0xbf6d0000,0x3ec43f35,0x3f0ebf80,0xbf7b3ec4,0x3e483f35,0x3f55bf6d
.long 0x3f80,0xbf80,0x3f80,0xbf80,0xbe48bf80,0x3f0e3f6d,0xbf55bf35,0x3f7b3ec4
.long 0x3ec43f80,0xbf6dbf35,0x3f6d0000,0xbec43f35,0xbf0ebf80,0x3f7b3ec4,0xbe483f35,0xbf55bf6d
.long 0xbf353f80,0x3f350000,0x3f35bf80,0xbf350000,0x3f55bf80,0xbe48bec4,0xbf7b3f35,0xbf0e3f6d
.long 0xbf6d3f80,0xbec43f35,0x3ec40000,0x3f6dbf35,0x3f7bbf80,0x3f55bf6d,0x3f0ebf35,0x3e48bec4
.long 0x3f353f80,0xbf350000,0xbf35bf80,0x3f350000,0xbf55bf80,0x3e48bec4,0x3f7b3f35,0x3f0e3f6d
.long 0x3f6d3f80,0x3ec43f35,0xbec40000,0xbf6dbf35,0xbf7bbf80,0xbf55bf6d,0xbf0ebf35,0xbe48bec4
.long 0x3f803f80,0x3f803f80,0x3f803f80,0x3f803f80,0x3e480000,0x3f0e3ec4,0x3f553f35,0x3f7b3f6d
.long 0xbf6dbf80,0xbec4bf35,0x3ec40000,0x3f6d3f35,0xbf0e0000,0xbf7bbf6d,0xbe48bf35,0x3f553ec4
.long 0xbf803f80,0xbf803f80,0xbf803f80,0xbf803f80,0xbe480000,0xbf0e3ec4,0xbf553f35,0xbf7b3f6d
.long 0x3f6dbf80,0x3ec4bf35,0xbec40000,0xbf6d3f35,0x3f0e0000,0x3f7bbf6d,0x3e48bf35,0xbf553ec4
.long 0x3f353f80,0xbf350000,0xbf35bf80,0x3f350000,0x3f550000,0x3e483f6d,0xbf7bbf35,0x3f0ebec4
.long 0xbec4bf80,0x3f6d3f35,0xbf6d0000,0x3ec4bf35,0xbf7b0000,0x3f55bec4,0xbf0e3f35,0x3e48bf6d
.long 0xbf353f80,0x3f350000,0x3f35bf80,0xbf350000,0xbf550000,0xbe483f6d,0x3f7bbf35,0xbf0ebec4
.long 0x3ec4bf80,0xbf6d3f35,0x3f6d0000,0xbec4bf35,0x3f7b0000,0xbf55bec4,0x3f0e3f35,0xbe48bf6d
.long 0x3f80,0xbf80,0x3f80,0xbf80,0x3f7b0000,0xbf55bec4,0x3f0e3f35,0xbe48bf6d
.long 0x3ec4bf80,0xbf6d3f35,0x3f6d0000,0xbec4bf35,0xbf550000,0xbe483f6d,0x3f7bbf35,0xbf0ebec4
.long 0x3f80,0xbf80,0x3f80,0xbf80,0xbf7b0000,0x3f55bec4,0xbf0e3f35,0x3e48bf6d
.long 0xbec4bf80,0x3f6d3f35,0xbf6d0000,0x3ec4bf35,0x3f550000,0x3e483f6d,0xbf7bbf35,0x3f0ebec4
.long 0xbf353f80,0x3f350000,0x3f35bf80,0xbf350000,0x3f0e0000,0x3f7bbf6d,0x3e48bf35,0xbf553ec4
.long 0x3f6dbf80,0x3ec4bf35,0xbec40000,0xbf6d3f35,0xbe480000,0xbf0e3ec4,0xbf553f35,0xbf7b3f6d
.long 0x3f353f80,0xbf350000,0xbf35bf80,0x3f350000,0xbf0e0000,0xbf7bbf6d,0xbe48bf35,0x3f553ec4
.long 0xbf6dbf80,0xbec4bf35,0x3ec40000,0x3f6d3f35,0x3e480000,0x3f0e3ec4,0x3f553f35,0x3f7b3f6d
.long 0x0,0x0,0x0,0x0,0x3e480000,0x3f0e3ec4,0x3f553f35,0x3f7b3f6d
.long 0x3ec40000,0x3f6d3f35,0x3f6d3f80,0x3ec43f35,0x3f0e0000,0x3f7b3f6d,0x3e483f35,0xbf55bec4
.long 0x0,0x0,0x0,0x0,0xbe480000,0xbf0e3ec4,0xbf553f35,0xbf7b3f6d
.long 0xbec40000,0xbf6d3f35,0xbf6d3f80,0xbec43f35,0xbf0e0000,0xbf7b3f6d,0xbe483f35,0x3f55bec4
.long 0x3f350000,0x3f353f80,0xbf350000,0xbf35bf80,0x3f550000,0x3e483f6d,0xbf7bbf35,0x3f0ebec4
.long 0x3f6d0000,0xbec43f35,0xbec4bf80,0x3f6d3f35,0x3f7b0000,0xbf553ec4,0x3f0ebf35,0xbe483f6d
.long 0xbf350000,0xbf353f80,0x3f350000,0x3f35bf80,0xbf550000,0xbe483f6d,0x3f7bbf35,0xbf0ebec4
.long 0xbf6d0000,0x3ec43f35,0x3ec4bf80,0xbf6d3f35,0xbf7b0000,0x3f553ec4,0xbf0ebf35,0x3e483f6d
.long 0x3f800000,0xbf800000,0x3f800000,0xbf800000,0x3f7b0000,0xbf55bec4,0x3f0e3f35,0xbe48bf6d
.long 0x3f6d0000,0xbec4bf35,0xbec43f80,0x3f6dbf35,0x3f550000,0x3e48bf6d,0xbf7b3f35,0x3f0e3ec4
.long 0xbf800000,0x3f800000,0xbf800000,0x3f800000,0xbf7b0000,0x3f55bec4,0xbf0e3f35,0x3e48bf6d
.long 0xbf6d0000,0x3ec4bf35,0x3ec43f80,0xbf6dbf35,0xbf550000,0xbe48bf6d,0x3f7b3f35,0xbf0e3ec4
.long 0x3f350000,0x3f35bf80,0xbf350000,0xbf353f80,0x3f0e0000,0x3f7bbf6d,0x3e48bf35,0xbf553ec4
.long 0x3ec40000,0x3f6dbf35,0x3f6dbf80,0x3ec4bf35,0x3e480000,0x3f0ebec4,0x3f55bf35,0x3f7bbf6d
.long 0xbf350000,0xbf35bf80,0x3f350000,0x3f353f80,0xbf0e0000,0xbf7bbf6d,0xbe48bf35,0x3f553ec4
.long 0xbec40000,0xbf6dbf35,0xbf6dbf80,0xbec4bf35,0xbe480000,0xbf0ebec4,0xbf55bf35,0xbf7bbf6d
.long 0x0,0x0,0x0,0x0,0x3f7b3f80,0x3f553f6d,0x3f0e3f35,0x3e483ec4
.long 0xbec40000,0xbf6dbf35,0xbf6dbf80,0xbec4bf35,0xbf55bf80,0x3e48bec4,0x3f7b3f35,0x3f0e3f6d
.long 0x0,0x0,0x0,0x0,0xbf7b3f80,0xbf553f6d,0xbf0e3f35,0xbe483ec4
.long 0x3ec40000,0x3f6dbf35,0x3f6dbf80,0x3ec4bf35,0x3f55bf80,0xbe48bec4,0xbf7b3f35,0xbf0e3f6d
.long 0x3f350000,0x3f353f80,0xbf350000,0xbf35bf80,0x3f0e3f80,0xbf7bbec4,0x3e48bf35,0x3f553f6d
.long 0xbf6d0000,0x3ec4bf35,0x3ec43f80,0xbf6dbf35,0xbe48bf80,0x3f0e3f6d,0xbf55bf35,0x3f7b3ec4
.long 0xbf350000,0xbf353f80,0x3f350000,0x3f35bf80,0xbf0e3f80,0x3f7bbec4,0xbe48bf35,0xbf553f6d
.long 0x3f6d0000,0xbec4bf35,0xbec43f80,0x3f6dbf35,0x3e48bf80,0xbf0e3f6d,0x3f55bf35,0xbf7b3ec4
.long 0x3f800000,0xbf800000,0x3f800000,0xbf800000,0xbe483f80,0x3f0ebf6d,0xbf553f35,0x3f7bbec4
.long 0xbf6d0000,0x3ec43f35,0x3ec4bf80,0xbf6d3f35,0x3f0ebf80,0xbf7b3ec4,0x3e483f35,0x3f55bf6d
.long 0xbf800000,0x3f800000,0xbf800000,0x3f800000,0x3e483f80,0xbf0ebf6d,0x3f553f35,0xbf7bbec4
.long 0x3f6d0000,0xbec43f35,0xbec4bf80,0x3f6d3f35,0xbf0ebf80,0x3f7b3ec4,0xbe483f35,0xbf55bf6d
.long 0x3f350000,0x3f35bf80,0xbf350000,0xbf353f80,0xbf553f80,0x3e483ec4,0x3f7bbf35,0x3f0ebf6d
.long 0xbec40000,0xbf6d3f35,0xbf6d3f80,0xbec43f35,0x3f7bbf80,0x3f55bf6d,0x3f0ebf35,0x3e48bec4
.long 0xbf350000,0xbf35bf80,0x3f350000,0x3f353f80,0x3f553f80,0xbe483ec4,0xbf7bbf35,0xbf0ebf6d
.long 0x3ec40000,0x3f6d3f35,0x3f6d3f80,0x3ec43f35,0xbf7bbf80,0xbf55bf6d,0xbf0ebf35,0xbe48bec4
.long 0x0,0x0,0x0,0x0,0xbe480000,0xbf0ebec4,0xbf55bf35,0xbf7bbf6d
.long 0x3ec40000,0x3f6d3f35,0x3f6d3f80,0x3ec43f35,0xbf0e0000,0xbf7bbf6d,0xbe48bf35,0x3f553ec4
.long 0x0,0x0,0x0,0x0,0x3e480000,0x3f0ebec4,0x3f55bf35,0x3f7bbf6d
.long 0xbec40000,0xbf6d3f35,0xbf6d3f80,0xbec43f35,0x3f0e0000,0x3f7bbf6d,0x3e48bf35,0xbf553ec4
.long 0x3f350000,0x3f353f80,0xbf350000,0xbf35bf80,0xbf550000,0xbe48bf6d,0x3f7b3f35,0xbf0e3ec4
.long 0x3f6d0000,0xbec43f35,0xbec4bf80,0x3f6d3f35,0xbf7b0000,0x3f55bec4,0xbf0e3f35,0x3e48bf6d
.long 0xbf350000,0xbf353f80,0x3f350000,0x3f35bf80,0x3f550000,0x3e48bf6d,0xbf7b3f35,0x3f0e3ec4
.long 0xbf6d0000,0x3ec43f35,0x3ec4bf80,0xbf6d3f35,0x3f7b0000,0xbf55bec4,0x3f0e3f35,0xbe48bf6d
.long 0x3f800000,0xbf800000,0x3f800000,0xbf800000,0xbf7b0000,0x3f553ec4,0xbf0ebf35,0x3e483f6d
.long 0x3f6d0000,0xbec4bf35,0xbec43f80,0x3f6dbf35,0xbf550000,0xbe483f6d,0x3f7bbf35,0xbf0ebec4
.long 0xbf800000,0x3f800000,0xbf800000,0x3f800000,0x3f7b0000,0xbf553ec4,0x3f0ebf35,0xbe483f6d
.long 0xbf6d0000,0x3ec4bf35,0x3ec43f80,0xbf6dbf35,0x3f550000,0x3e483f6d,0xbf7bbf35,0x3f0ebec4
.long 0x3f350000,0x3f35bf80,0xbf350000,0xbf353f80,0xbf0e0000,0xbf7b3f6d,0xbe483f35,0x3f55bec4
.long 0x3ec40000,0x3f6dbf35,0x3f6dbf80,0x3ec4bf35,0xbe480000,0xbf0e3ec4,0xbf553f35,0xbf7b3f6d
.long 0xbf350000,0xbf35bf80,0x3f350000,0x3f353f80,0x3f0e0000,0x3f7b3f6d,0x3e483f35,0xbf55bec4
.long 0xbec40000,0xbf6dbf35,0xbf6dbf80,0xbec4bf35,0x3e480000,0x3f0e3ec4,0x3f553f35,0x3f7b3f6d
.long 0x0,0x0,0x0,0x0,0xbf7bbf80,0xbf55bf6d,0xbf0ebf35,0xbe48bec4
.long 0xbec40000,0xbf6dbf35,0xbf6dbf80,0xbec4bf35,0x3f553f80,0xbe483ec4,0xbf7bbf35,0xbf0ebf6d
.long 0x0,0x0,0x0,0x0,0x3f7bbf80,0x3f55bf6d,0x3f0ebf35,0x3e48bec4
.long 0x3ec40000,0x3f6dbf35,0x3f6dbf80,0x3ec4bf35,0xbf553f80,0x3e483ec4,0x3f7bbf35,0x3f0ebf6d
.long 0x3f350000,0x3f353f80,0xbf350000,0xbf35bf80,0xbf0ebf80,0x3f7b3ec4,0xbe483f35,0xbf55bf6d
.long 0xbf6d0000,0x3ec4bf35,0x3ec43f80,0xbf6dbf35,0x3e483f80,0xbf0ebf6d,0x3f553f35,0xbf7bbec4
.long 0xbf350000,0xbf353f80,0x3f350000,0x3f35bf80,0x3f0ebf80,0xbf7b3ec4,0x3e483f35,0x3f55bf6d
.long 0x3f6d0000,0xbec4bf35,0xbec43f80,0x3f6dbf35,0xbe483f80,0x3f0ebf6d,0xbf553f35,0x3f7bbec4
.long 0x3f800000,0xbf800000,0x3f800000,0xbf800000,0x3e48bf80,0xbf0e3f6d,0x3f55bf35,0xbf7b3ec4
.long 0xbf6d0000,0x3ec43f35,0x3ec4bf80,0xbf6d3f35,0xbf0e3f80,0x3f7bbec4,0xbe48bf35,0xbf553f6d
.long 0xbf800000,0x3f800000,0xbf800000,0x3f800000,0xbe48bf80,0x3f0e3f6d,0xbf55bf35,0x3f7b3ec4
.long 0x3f6d0000,0xbec43f35,0xbec4bf80,0x3f6d3f35,0x3f0e3f80,0xbf7bbec4,0x3e48bf35,0x3f553f6d
.long 0x3f350000,0x3f35bf80,0xbf350000,0xbf353f80,0x3f55bf80,0xbe48bec4,0xbf7b3f35,0xbf0e3f6d
.long 0xbec40000,0xbf6d3f35,0xbf6d3f80,0xbec43f35,0xbf7b3f80,0xbf553f6d,0xbf0e3f35,0xbe483ec4
.long 0xbf350000,0xbf35bf80,0x3f350000,0x3f353f80,0xbf55bf80,0x3e48bec4,0x3f7b3f35,0x3f0e3f6d
.long 0x3ec40000,0x3f6d3f35,0x3f6d3f80,0x3ec43f35,0x3f7b3f80,0x3f553f6d,0x3f0e3f35,0x3e483ec4
.long 0x0,0x0,0x0,0x0,0xbe480000,0xbf0ebec4,0xbf55bf35,0xbf7bbf6d
.long 0xbec40000,0xbf6dbf35,0xbf6dbf80,0xbec4bf35,0xbf0e0000,0xbf7bbf6d,0xbe48bf35,0x3f553ec4
.long 0x0,0x0,0x0,0x0,0x3e480000,0x3f0ebec4,0x3f55bf35,0x3f7bbf6d
.long 0x3ec40000,0x3f6dbf35,0x3f6dbf80,0x3ec4bf35,0x3f0e0000,0x3f7bbf6d,0x3e48bf35,0xbf553ec4
.long 0xbf350000,0xbf35bf80,0x3f350000,0x3f353f80,0xbf550000,0xbe48bf6d,0x3f7b3f35,0xbf0e3ec4
.long 0xbf6d0000,0x3ec4bf35,0x3ec43f80,0xbf6dbf35,0xbf7b0000,0x3f55bec4,0xbf0e3f35,0x3e48bf6d
.long 0x3f350000,0x3f35bf80,0xbf350000,0xbf353f80,0x3f550000,0x3e48bf6d,0xbf7b3f35,0x3f0e3ec4
.long 0x3f6d0000,0xbec4bf35,0xbec43f80,0x3f6dbf35,0x3f7b0000,0xbf55bec4,0x3f0e3f35,0xbe48bf6d
.long 0xbf800000,0x3f800000,0xbf800000,0x3f800000,0xbf7b0000,0x3f553ec4,0xbf0ebf35,0x3e483f6d
.long 0xbf6d0000,0x3ec43f35,0x3ec4bf80,0xbf6d3f35,0xbf550000,0xbe483f6d,0x3f7bbf35,0xbf0ebec4
.long 0x3f800000,0xbf800000,0x3f800000,0xbf800000,0x3f7b0000,0xbf553ec4,0x3f0ebf35,0xbe483f6d
.long 0x3f6d0000,0xbec43f35,0xbec4bf80,0x3f6d3f35,0x3f550000,0x3e483f6d,0xbf7bbf35,0x3f0ebec4
.long 0xbf350000,0xbf353f80,0x3f350000,0x3f35bf80,0xbf0e0000,0xbf7b3f6d,0xbe483f35,0x3f55bec4
.long 0xbec40000,0xbf6d3f35,0xbf6d3f80,0xbec43f35,0xbe480000,0xbf0e3ec4,0xbf553f35,0xbf7b3f6d
.long 0x3f350000,0x3f353f80,0xbf350000,0xbf35bf80,0x3f0e0000,0x3f7b3f6d,0x3e483f35,0xbf55bec4
.long 0x3ec40000,0x3f6d3f35,0x3f6d3f80,0x3ec43f35,0x3e480000,0x3f0e3ec4,0x3f553f35,0x3f7b3f6d
.long 0x0,0x0,0x0,0x0,0xbf7bbf80,0xbf55bf6d,0xbf0ebf35,0xbe48bec4
.long 0x3ec40000,0x3f6d3f35,0x3f6d3f80,0x3ec43f35,0x3f553f80,0xbe483ec4,0xbf7bbf35,0xbf0ebf6d
.long 0x0,0x0,0x0,0x0,0x3f7bbf80,0x3f55bf6d,0x3f0ebf35,0x3e48bec4
.long 0xbec40000,0xbf6d3f35,0xbf6d3f80,0xbec43f35,0xbf553f80,0x3e483ec4,0x3f7bbf35,0x3f0ebf6d
.long 0xbf350000,0xbf35bf80,0x3f350000,0x3f353f80,0xbf0ebf80,0x3f7b3ec4,0xbe483f35,0xbf55bf6d
.long 0x3f6d0000,0xbec43f35,0xbec4bf80,0x3f6d3f35,0x3e483f80,0xbf0ebf6d,0x3f553f35,0xbf7bbec4
.long 0x3f350000,0x3f35bf80,0xbf350000,0xbf353f80,0x3f0ebf80,0xbf7b3ec4,0x3e483f35,0x3f55bf6d
.long 0xbf6d0000,0x3ec43f35,0x3ec4bf80,0xbf6d3f35,0xbe483f80,0x3f0ebf6d,0xbf553f35,0x3f7bbec4
.long 0xbf800000,0x3f800000,0xbf800000,0x3f800000,0x3e48bf80,0xbf0e3f6d,0x3f55bf35,0xbf7b3ec4
.long 0x3f6d0000,0xbec4bf35,0xbec43f80,0x3f6dbf35,0xbf0e3f80,0x3f7bbec4,0xbe48bf35,0xbf553f6d
.long 0x3f800000,0xbf800000,0x3f800000,0xbf800000,0xbe48bf80,0x3f0e3f6d,0xbf55bf35,0x3f7b3ec4
.long 0xbf6d0000,0x3ec4bf35,0x3ec43f80,0xbf6dbf35,0x3f0e3f80,0xbf7bbec4,0x3e48bf35,0x3f553f6d
.long 0xbf350000,0xbf353f80,0x3f350000,0x3f35bf80,0x3f55bf80,0xbe48bec4,0xbf7b3f35,0xbf0e3f6d
.long 0x3ec40000,0x3f6dbf35,0x3f6dbf80,0x3ec4bf35,0xbf7b3f80,0xbf553f6d,0xbf0e3f35,0xbe483ec4
.long 0x3f350000,0x3f353f80,0xbf350000,0xbf35bf80,0xbf55bf80,0x3e48bec4,0x3f7b3f35,0x3f0e3f6d
.long 0xbec40000,0xbf6dbf35,0xbf6dbf80,0xbec4bf35,0x3f7b3f80,0x3f553f6d,0x3f0e3f35,0x3e483ec4
.long 0x0,0x0,0x0,0x0,0x3e480000,0x3f0e3ec4,0x3f553f35,0x3f7b3f6d
.long 0xbec40000,0xbf6dbf35,0xbf6dbf80,0xbec4bf35,0x3f0e0000,0x3f7b3f6d,0x3e483f35,0xbf55bec4
.long 0x0,0x0,0x0,0x0,0xbe480000,0xbf0e3ec4,0xbf553f35,0xbf7b3f6d
.long 0x3ec40000,0x3f6dbf35,0x3f6dbf80,0x3ec4bf35,0xbf0e0000,0xbf7b3f6d,0xbe483f35,0x3f55bec4
.long 0xbf350000,0xbf35bf80,0x3f350000,0x3f353f80,0x3f550000,0x3e483f6d,0xbf7bbf35,0x3f0ebec4
.long 0xbf6d0000,0x3ec4bf35,0x3ec43f80,0xbf6dbf35,0x3f7b0000,0xbf553ec4,0x3f0ebf35,0xbe483f6d
.long 0x3f350000,0x3f35bf80,0xbf350000,0xbf353f80,0xbf550000,0xbe483f6d,0x3f7bbf35,0xbf0ebec4
.long 0x3f6d0000,0xbec4bf35,0xbec43f80,0x3f6dbf35,0xbf7b0000,0x3f553ec4,0xbf0ebf35,0x3e483f6d
.long 0xbf800000,0x3f800000,0xbf800000,0x3f800000,0x3f7b0000,0xbf55bec4,0x3f0e3f35,0xbe48bf6d
.long 0xbf6d0000,0x3ec43f35,0x3ec4bf80,0xbf6d3f35,0x3f550000,0x3e48bf6d,0xbf7b3f35,0x3f0e3ec4
.long 0x3f800000,0xbf800000,0x3f800000,0xbf800000,0xbf7b0000,0x3f55bec4,0xbf0e3f35,0x3e48bf6d
.long 0x3f6d0000,0xbec43f35,0xbec4bf80,0x3f6d3f35,0xbf550000,0xbe48bf6d,0x3f7b3f35,0xbf0e3ec4
.long 0xbf350000,0xbf353f80,0x3f350000,0x3f35bf80,0x3f0e0000,0x3f7bbf6d,0x3e48bf35,0xbf553ec4
.long 0xbec40000,0xbf6d3f35,0xbf6d3f80,0xbec43f35,0x3e480000,0x3f0ebec4,0x3f55bf35,0x3f7bbf6d
.long 0x3f350000,0x3f353f80,0xbf350000,0xbf35bf80,0xbf0e0000,0xbf7bbf6d,0xbe48bf35,0x3f553ec4
.long 0x3ec40000,0x3f6d3f35,0x3f6d3f80,0x3ec43f35,0xbe480000,0xbf0ebec4,0xbf55bf35,0xbf7bbf6d
.long 0x0,0x0,0x0,0x0,0x3f7b3f80,0x3f553f6d,0x3f0e3f35,0x3e483ec4
.long 0x3ec40000,0x3f6d3f35,0x3f6d3f80,0x3ec43f35,0xbf55bf80,0x3e48bec4,0x3f7b3f35,0x3f0e3f6d
.long 0x0,0x0,0x0,0x0,0xbf7b3f80,0xbf553f6d,0xbf0e3f35,0xbe483ec4
.long 0xbec40000,0xbf6d3f35,0xbf6d3f80,0xbec43f35,0x3f55bf80,0xbe48bec4,0xbf7b3f35,0xbf0e3f6d
.long 0xbf350000,0xbf35bf80,0x3f350000,0x3f353f80,0x3f0e3f80,0xbf7bbec4,0x3e48bf35,0x3f553f6d
.long 0x3f6d0000,0xbec43f35,0xbec4bf80,0x3f6d3f35,0xbe48bf80,0x3f0e3f6d,0xbf55bf35,0x3f7b3ec4
.long 0x3f350000,0x3f35bf80,0xbf350000,0xbf353f80,0xbf0e3f80,0x3f7bbec4,0xbe48bf35,0xbf553f6d
.long 0xbf6d0000,0x3ec43f35,0x3ec4bf80,0xbf6d3f35,0x3e48bf80,0xbf0e3f6d,0x3f55bf35,0xbf7b3ec4
.long 0xbf800000,0x3f800000,0xbf800000,0x3f800000,0xbe483f80,0x3f0ebf6d,0xbf553f35,0x3f7bbec4
.long 0x3f6d0000,0xbec4bf35,0xbec43f80,0x3f6dbf35,0x3f0ebf80,0xbf7b3ec4,0x3e483f35,0x3f55bf6d
.long 0x3f800000,0xbf800000,0x3f800000,0xbf800000,0x3e483f80,0xbf0ebf6d,0x3f553f35,0xbf7bbec4
.long 0xbf6d0000,0x3ec4bf35,0x3ec43f80,0xbf6dbf35,0xbf0ebf80,0x3f7b3ec4,0xbe483f35,0xbf55bf6d
.long 0xbf350000,0xbf353f80,0x3f350000,0x3f35bf80,0xbf553f80,0x3e483ec4,0x3f7bbf35,0x3f0ebf6d
.long 0x3ec40000,0x3f6dbf35,0x3f6dbf80,0x3ec4bf35,0x3f7bbf80,0x3f55bf6d,0x3f0ebf35,0x3e48bec4
.long 0x3f350000,0x3f353f80,0xbf350000,0xbf35bf80,0x3f553f80,0xbe483ec4,0xbf7bbf35,0xbf0ebf6d
.long 0xbec40000,0xbf6dbf35,0xbf6dbf80,0xbec4bf35,0xbf7bbf80,0xbf55bf6d,0xbf0ebf35,0xbe48bec4
.long 0x3f800000,0x3f800000,0x3f800000,0x3f800000,0x3f800000,0x3f7ffb11,0x3f7fec43,0x3f7fd397
.long 0x3f800000,0x3f7fec43,0x3f7fb10f,0x3f7f4e6d,0x3f800000,0x3f7fd397,0x3f7f4e6d,0x3f7e70b0
.long 0x3f800000,0x3f7b14be,0x3f6c835e,0x3f54db31,0x3f800000,0x3f7a7302,0x3f6a09a7,0x3f4f7a1f
.long 0x3f800000,0x3f79c79d,0x3f676bd8,0x3f49d112,0x3f800000,0x3f791298,0x3f64aa59,0x3f43e200
.long 0x3f800000,0x3f7fb10f,0x3f7ec46d,0x3f7d3aac,0x3f800000,0x3f7f84ab,0x3f7e1324,0x3f7baccd
.long 0x3f800000,0x3f7f4e6d,0x3f7d3aac,0x3f79c79d,0x3f800000,0x3f7f0e58,0x3f7c3b28,0x3f778bc5
.long 0x3f800000,0x3f7853f8,0x3f61c598,0x3f3daef9,0x3f800000,0x3f778bc5,0x3f5ebe05,0x3f373a23
.long 0x3f800000,0x3f76ba07,0x3f5b941a,0x3f3085bb,0x3f800000,0x3f75dec6,0x3f584853,0x3f299415
.long 0x3f800000,0x3f7ec46d,0x3f7b14be,0x3f74fa0b,0x3f800000,0x3f7e70b0,0x3f79c79d,0x3f721352
.long 0x3f800000,0x3f7e1324,0x3f7853f8,0x3f6ed89e,0x3f800000,0x3f7dabcc,0x3f76ba07,0x3f6b4b0c
.long 0x3f800000,0x3f74fa0b,0x3f54db31,0x3f226799,0x3f800000,0x3f740bdd,0x3f514d3d,0x3f1b02c6
.long 0x3f800000,0x3f731447,0x3f4d9f02,0x3f13682a,0x3f800000,0x3f721352,0x3f49d112,0x3f0b9a6b
.long 0x3f800000,0x3f7d3aac,0x3f74fa0b,0x3f676bd8,0x3f800000,0x3f7cbfc9,0x3f731447,0x3f633c5a
.long 0x3f800000,0x3f7c3b28,0x3f710908,0x3f5ebe05,0x3f800000,0x3f7baccd,0x3f6ed89e,0x3f59f26a
.long 0x3f800000,0x3f710908,0x3f45e403,0x3f039c3d,0x3f800000,0x3f6ff573,0x3f41d870,0x3ef6e0cb
.long 0x3f800000,0x3f6ed89e,0x3f3daef9,0x3ee63375,0x3f800000,0x3f6db293,0x3f396842,0x3ed53641
.long 0x3f800000,0x3f800000,0x3f800000,0x3f800000,0x3f7fb10f,0x3f7f84ab,0x3f7f4e6d,0x3f7f0e58
.long 0x3f7ec46d,0x3f7e1324,0x3f7d3aac,0x3f7c3b28,0x3f7d3aac,0x3f7baccd,0x3f79c79d,0x3f778bc5
.long 0x3f3504f3,0x3f0e39da,0x3ec3ef15,0x3e47c5c2,0x3f2beb4a,0x3f00e7e4,0x3ea09ae5,0x3de1bc2e
.long 0x3f226799,0x3ee63375,0x3e78cfcc,0x3cc90ab0,0x3f187fc0,0x3ec9b953,0x3e2f10a2,0xbd7b2b74
.long 0x3f7b14be,0x3f7853f8,0x3f74fa0b,0x3f710908,0x3f7853f8,0x3f740bdd,0x3f6ed89e,0x3f68bf3c
.long 0x3f74fa0b,0x3f6ed89e,0x3f676bd8,0x3f5ebe05,0x3f710908,0x3f68bf3c,0x3f5ebe05,0x3f531849
.long 0x3f0e39da,0x3eac7cd4,0x3dc8bd36,0xbe164083,0x3f039c3d,0x3e8e9a22,0x3cc90ab0,0xbe6c9a7f
.long 0x3ef15aea,0x3e605c13,0xbd48fb30,0xbea09ae5,0x3edae880,0x3e22abb6,0xbdfab273,0xbec9b953
.long 0x3f6c835e,0x3f61c598,0x3f54db31,0x3f45e403,0x3f676bd8,0x3f59f26a,0x3f49d112,0x3f373a23
.long 0x3f61c598,0x3f514d3d,0x3f3daef9,0x3f273656,0x3f5b941a,0x3f47de65,0x3f3085bb,0x3f15f6d9
.long 0x3ec3ef15,0x3dc8bd36,0xbe47c5c2,0xbef15aea,0x3eac7cd4,0x3d16c32c,0xbe888e93,0xbf0b9a6b
.long 0x3e94a031,0xbcc90ab0,0xbeac7cd4,0xbf1d7fd1,0x3e78cfcc,0xbdafb680,0xbecf7bca,0xbf2e3bde
.long 0x3f54db31,0x3f3daef9,0x3f226799,0x3f039c3d,0x3f4d9f02,0x3f32c8c9,0x3f13682a,0x3ee0924f
.long 0x3f45e403,0x3f273656,0x3f039c3d,0x3eb8442a,0x3f3daef9,0x3f1b02c6,0x3ee63375,0x3e8e9a22
.long 0x3e47c5c2,0xbe164083,0xbef15aea,0xbf3daef9,0x3e164083,0xbe541501,0xbf08f59b,0xbf4bbbf8
.long 0x3dc8bd36,0xbe888e93,0xbf187fc0,0xbf584853,0x3d48fb30,0xbea68f12,0xbf273656,0xbf633c5a
.long 0x3f800000,0x3f800000,0x3f800000,0x3f800000,0x3f7ec46d,0x3f7e70b0,0x3f7e1324,0x3f7dabcc
.long 0x3f7b14be,0x3f79c79d,0x3f7853f8,0x3f76ba07,0x3f74fa0b,0x3f721352,0x3f6ed89e,0x3f6b4b0c
.long 0x248d3132,0xbe47c5c2,0xbec3ef15,0xbf0e39da,0xbdc8bd36,0xbe9aa086,0xbefc5d27,0xbf299415
.long 0xbe47c5c2,0xbecf7bca,0xbf187fc0,0xbf41d870,0xbe94a031,0xbf00e7e4,0xbf3085bb,0xbf5695e5
.long 0x3f6c835e,0x3f676bd8,0x3f61c598,0x3f5b941a,0x3f61c598,0x3f59f26a,0x3f514d3d,0x3f47de65
.long 0x3f54db31,0x3f49d112,0x3f3daef9,0x3f3085bb,0x3f45e403,0x3f373a23,0x3f273656,0x3f15f6d9
.long 0xbec3ef15,0xbf187fc0,0xbf45e403,0xbf676bd8,0xbef15aea,0xbf2e3bde,0xbf584853,0xbf740bdd
.long 0xbf0e39da,0xbf41d870,0xbf676bd8,0xbf7c3b28,0xbf226799,0xbf531849,0xbf731447,0xbf7fd397
.long 0x3f3504f3,0x3f226799,0x3f0e39da,0x3ef15aea,0x3f226799,0x3f0b9a6b,0x3ee63375,0x3eb263ef
.long 0x3f0e39da,0x3ee63375,0x3eac7cd4,0x3e605c13,0x3ef15aea,0x3eb263ef,0x3e605c13,0x3dafb680
.long 0xbf3504f3,0xbf61c598,0xbf7b14be,0xbf7ec46d,0xbf45e403,0xbf6db293,0xbf7f4e6d,0xbf791298
.long 0xbf54db31,0xbf76ba07,0xbf7fb10f,0xbf6ed89e,0xbf61c598,0xbf7cbfc9,0xbf7c3b28,0xbf604621
.long 0x3ec3ef15,0x3e78cfcc,0x3dc8bd36,0xbd48fb30,0x3e94a031,0x3e09cf86,0xbcc90ab0,0xbe3b6ecf
.long 0x3e47c5c2,0x3cc90ab0,0xbe164083,0xbea09ae5,0x3dc8bd36,0xbdafb680,0xbe888e93,0xbee0924f
.long 0xbf6c835e,0xbf7fb10f,0xbf74fa0b,0xbf4d9f02,0xbf74fa0b,0xbf7f84ab,0xbf6a09a7,0xbf373a23
.long 0xbf7b14be,0xbf7c3b28,0xbf5b941a,0xbf1d7fd1,0xbf7ec46d,0xbf75dec6,0xbf49d112,0xbf00e7e4
.long 0x3f800000,0x3f800000,0x3f800000,0x3f800000,0x3f7d3aac,0x3f7cbfc9,0x3f7c3b28,0x3f7baccd
.long 0x3f74fa0b,0x3f731447,0x3f710908,0x3f6ed89e,0x3f676bd8,0x3f633c5a,0x3f5ebe05,0x3f59f26a
.long 0xbf3504f3,0xbf54db31,0xbf6c835e,0xbf7b14be,0xbf4d9f02,0xbf68bf3c,0xbf79c79d,0xbf7ffb11
.long 0xbf61c598,0xbf76ba07,0xbf7fb10f,0xbf7c3b28,0xbf710908,0xbf7e70b0,0xbf7e1324,0xbf6ff573
.long 0x3f54db31,0x3f4d9f02,0x3f45e403,0x3f3daef9,0x3f3daef9,0x3f32c8c9,0x3f273656,0x3f1b02c6
.long 0x3f226799,0x3f13682a,0x3f039c3d,0x3ee63375,0x3f039c3d,0x3ee0924f,0x3eb8442a,0x3e8e9a22
.long 0xbf7b14be,0xbf7fb10f,0xbf74fa0b,0xbf5b941a,0xbf7fb10f,0xbf7a7302,0xbf64aa59,0xbf3fc767
.long 0xbf7ec46d,0xbf6ed89e,0xbf4d9f02,0xbf1d7fd1,0xbf7853f8,0xbf5d2d53,0xbf3085bb,0xbeebcbbb
.long 0x3ec3ef15,0x3e94a031,0x3e47c5c2,0x3dc8bd36,0x3e78cfcc,0x3e09cf86,0x3cc90ab0,0xbdafb680
.long 0x3dc8bd36,0xbcc90ab0,0xbe164083,0xbe888e93,0xbd48fb30,0xbe3b6ecf,0xbea09ae5,0xbee0924f
.long 0xbf6c835e,0xbf45e403,0xbf0e39da,0xbe94a031,0xbf5b941a,0xbf299415,0xbecf7bca,0xbde1bc2e
.long 0xbf45e403,0xbf08f59b,0xbe78cfcc,0x3d96a905,0xbf2beb4a,0xbec9b953,0xbd96a905,0x3e827dc0
.long 0xbe47c5c2,0xbeac7cd4,0xbef15aea,0xbf187fc0,0xbeac7cd4,0xbef6e0cb,0xbf1d7fd1,0xbf3b8f3b
.long 0xbef15aea,0xbf1d7fd1,0xbf3daef9,0xbf584853,0xbf187fc0,0xbf3b8f3b,0xbf584853,0xbf6db293
.long 0xbf0e39da,0xbe78cfcc,0x3dc8bd36,0x3edae880,0xbedae880,0xbdafb680,0x3e888e93,0x3f15f6d9
.long 0xbe94a031,0x3d96a905,0x3edae880,0x3f396842,0xbe164083,0x3e6c9a7f,0x3f13682a,0x3f5695e5
.long 0x0,0x0,0x0,0x0,0x0,0x3c490e90,0x3cc90ab0,0x3d16c32c
.long 0x0,0x3cc90ab0,0x3d48fb30,0x3d96a905,0x0,0x3d16c32c,0x3d96a905,0x3de1bc2e
.long 0x0,0x3e47c5c2,0x3ec3ef15,0x3f0e39da,0x0,0x3e541501,0x3ecf7bca,0x3f15f6d9
.long 0x0,0x3e605c13,0x3edae880,0x3f1d7fd1,0x0,0x3e6c9a7f,0x3ee63375,0x3f24d225
.long 0x0,0x3d48fb30,0x3dc8bd36,0x3e164083,0x0,0x3d7b2b74,0x3dfab273,0x3e3b6ecf
.long 0x0,0x3d96a905,0x3e164083,0x3e605c13,0x0,0x3dafb680,0x3e2f10a2,0x3e827dc0
.long 0x0,0x3e78cfcc,0x3ef15aea,0x3f2beb4a,0x0,0x3e827dc0,0x3efc5d27,0x3f32c8c9
.long 0x0,0x3e888e93,0x3f039c3d,0x3f396842,0x0,0x3e8e9a22,0x3f08f59b,0x3f3fc767
.long 0x0,0x3dc8bd36,0x3e47c5c2,0x3e94a031,0x0,0x3de1bc2e,0x3e605c13,0x3ea68f12
.long 0x0,0x3dfab273,0x3e78cfcc,0x3eb8442a,0x0,0x3e09cf86,0x3e888e93,0x3ec9b953
.long 0x0,0x3e94a031,0x3f0e39da,0x3f45e403,0x0,0x3e9aa086,0x3f13682a,0x3f4bbbf8
.long 0x0,0x3ea09ae5,0x3f187fc0,0x3f514d3d,0x0,0x3ea68f12,0x3f1d7fd1,0x3f5695e5
.long 0x0,0x3e164083,0x3e94a031,0x3edae880,0x0,0x3e22abb6,0x3ea09ae5,0x3eebcbbb
.long 0x0,0x3e2f10a2,0x3eac7cd4,0x3efc5d27,0x0,0x3e3b6ecf,0x3eb8442a,0x3f064b82
.long 0x0,0x3eac7cd4,0x3f226799,0x3f5b941a,0x0,0x3eb263ef,0x3f273656,0x3f604621
.long 0x0,0x3eb8442a,0x3f2beb4a,0x3f64aa59,0x0,0x3ebe1d4a,0x3f3085bb,0x3f68bf3c
.long 0x0,0x0,0x0,0x0,0x3d48fb30,0x3d7b2b74,0x3d96a905,0x3dafb680
.long 0x3dc8bd36,0x3dfab273,0x3e164083,0x3e2f10a2,0x3e164083,0x3e3b6ecf,0x3e605c13,0x3e827dc0
.long 0x3f3504f3,0x3f54db31,0x3f6c835e,0x3f7b14be,0x3f3daef9,0x3f5d2d53,0x3f731447,0x3f7e70b0
.long 0x3f45e403,0x3f64aa59,0x3f7853f8,0x3f7fec43,0x3f4d9f02,0x3f6b4b0c,0x3f7c3b28,0x3f7f84ab
.long 0x3e47c5c2,0x3e78cfcc,0x3e94a031,0x3eac7cd4,0x3e78cfcc,0x3e9aa086,0x3eb8442a,0x3ed53641
.long 0x3e94a031,0x3eb8442a,0x3edae880,0x3efc5d27,0x3eac7cd4,0x3ed53641,0x3efc5d27,0x3f10d3cd
.long 0x3f54db31,0x3f710908,0x3f7ec46d,0x3f7d3aac,0x3f5b941a,0x3f75dec6,0x3f7fec43,0x3f791298
.long 0x3f61c598,0x3f79c79d,0x3f7fb10f,0x3f731447,0x3f676bd8,0x3f7cbfc9,0x3f7e1324,0x3f6b4b0c
.long 0x3ec3ef15,0x3ef15aea,0x3f0e39da,0x3f226799,0x3edae880,0x3f064b82,0x3f1d7fd1,0x3f32c8c9
.long 0x3ef15aea,0x3f13682a,0x3f2beb4a,0x3f41d870,0x3f039c3d,0x3f1ff6cb,0x3f396842,0x3f4f7a1f
.long 0x3f6c835e,0x3f7ec46d,0x3f7b14be,0x3f61c598,0x3f710908,0x3f7fd397,0x3f76ba07,0x3f5695e5
.long 0x3f74fa0b,0x3f7fec43,0x3f710908,0x3f49d112,0x3f7853f8,0x3f7f0e58,0x3f6a09a7,0x3f3b8f3b
.long 0x3f0e39da,0x3f2beb4a,0x3f45e403,0x3f5b941a,0x3f187fc0,0x3f373a23,0x3f514d3d,0x3f660f88
.long 0x3f226799,0x3f41d870,0x3f5b941a,0x3f6ed89e,0x3f2beb4a,0x3f4bbbf8,0x3f64aa59,0x3f75dec6
.long 0x3f7b14be,0x3f7d3aac,0x3f61c598,0x3f2beb4a,0x3f7d3aac,0x3f7a7302,0x3f584853,0x3f1b02c6
.long 0x3f7ec46d,0x3f76ba07,0x3f4d9f02,0x3f08f59b,0x3f7fb10f,0x3f721352,0x3f41d870,0x3eebcbbb
.long 0x0,0x0,0x0,0x0,0x3dc8bd36,0x3de1bc2e,0x3dfab273,0x3e09cf86
.long 0x3e47c5c2,0x3e605c13,0x3e78cfcc,0x3e888e93,0x3e94a031,0x3ea68f12,0x3eb8442a,0x3ec9b953
.long 0x3f800000,0x3f7b14be,0x3f6c835e,0x3f54db31,0x3f7ec46d,0x3f740bdd,0x3f5ebe05,0x3f3fc767
.long 0x3f7b14be,0x3f6a09a7,0x3f4d9f02,0x3f273656,0x3f74fa0b,0x3f5d2d53,0x3f396842,0x3f0b9a6b
.long 0x3ec3ef15,0x3edae880,0x3ef15aea,0x3f039c3d,0x3ef15aea,0x3f064b82,0x3f13682a,0x3f1ff6cb
.long 0x3f0e39da,0x3f1d7fd1,0x3f2beb4a,0x3f396842,0x3f226799,0x3f32c8c9,0x3f41d870,0x3f4f7a1f
.long 0x3f6c835e,0x3f4d9f02,0x3f226799,0x3edae880,0x3f61c598,0x3f3b8f3b,0x3f08f59b,0x3e9aa086
.long 0x3f54db31,0x3f273656,0x3edae880,0x3e2f10a2,0x3f45e403,0x3f10d3cd,0x3ea09ae5,0x3d16c32c
.long 0x3f3504f3,0x3f45e403,0x3f54db31,0x3f61c598,0x3f45e403,0x3f5695e5,0x3f64aa59,0x3f6ff573
.long 0x3f54db31,0x3f64aa59,0x3f710908,0x3f79c79d,0x3f61c598,0x3f6ff573,0x3f79c79d,0x3f7f0e58
.long 0x3f3504f3,0x3ef15aea,0x3e47c5c2,0xbdc8bd36,0x3f226799,0x3ebe1d4a,0x3d96a905,0xbe6c9a7f
.long 0x3f0e39da,0x3e888e93,0xbd48fb30,0xbeb8442a,0x3ef15aea,0x3e22abb6,0xbe2f10a2,0xbef6e0cb
.long 0x3f6c835e,0x3f7853f8,0x3f7ec46d,0x3f7fb10f,0x3f74fa0b,0x3f7dabcc,0x3f7fec43,0x3f7baccd
.long 0x3f7b14be,0x3f7fec43,0x3f7d3aac,0x3f731447,0x3f7ec46d,0x3f7f0e58,0x3f76ba07,0x3f660f88
.long 0x3ec3ef15,0x3d48fb30,0xbe94a031,0xbf187fc0,0x3e94a031,0xbd7b2b74,0xbecf7bca,0xbf32c8c9
.long 0x3e47c5c2,0xbe2f10a2,0xbf039c3d,0xbf49d112,0x3dc8bd36,0xbe8e9a22,0xbf1d7fd1,0xbf5d2d53
.long 0x0,0x0,0x0,0x0,0x3e164083,0x3e22abb6,0x3e2f10a2,0x3e3b6ecf
.long 0x3e94a031,0x3ea09ae5,0x3eac7cd4,0x3eb8442a,0x3edae880,0x3eebcbbb,0x3efc5d27,0x3f064b82
.long 0x3f3504f3,0x3f0e39da,0x3ec3ef15,0x3e47c5c2,0x3f187fc0,0x3ed53641,0x3e605c13,0x3c490e90
.long 0x3ef15aea,0x3e888e93,0x3d48fb30,0xbe2f10a2,0x3eac7cd4,0x3de1bc2e,0xbdfab273,0xbeb263ef
.long 0x3f0e39da,0x3f187fc0,0x3f226799,0x3f2beb4a,0x3f2beb4a,0x3f373a23,0x3f41d870,0x3f4bbbf8
.long 0x3f45e403,0x3f514d3d,0x3f5b941a,0x3f64aa59,0x3f5b941a,0x3f660f88,0x3f6ed89e,0x3f75dec6
.long 0x3e47c5c2,0xbd48fb30,0xbe94a031,0xbf039c3d,0x3d48fb30,0xbe541501,0xbee63375,0xbf299415
.long 0xbdc8bd36,0xbeb8442a,0xbf187fc0,0xbf49d112,0xbe78cfcc,0xbf00e7e4,0xbf396842,0xbf633c5a
.long 0x3f6c835e,0x3f74fa0b,0x3f7b14be,0x3f7ec46d,0x3f7853f8,0x3f7dabcc,0x3f7fec43,0x3f7f0e58
.long 0x3f7ec46d,0x3f7fec43,0x3f7d3aac,0x3f76ba07,0x3f7fb10f,0x3f7baccd,0x3f731447,0x3f660f88
.long 0xbec3ef15,0xbf226799,0xbf54db31,0xbf74fa0b,0xbf039c3d,0xbf3fc767,0xbf6a09a7,0xbf7e70b0
.long 0xbf226799,0xbf584853,0xbf7853f8,0xbf7f4e6d,0xbf3daef9,0xbf6b4b0c,0xbf7f4e6d,0xbf778bc5
.long 0x3f7b14be,0x3f710908,0x3f61c598,0x3f4d9f02,0x3f710908,0x3f604621,0x3f49d112,0x3f2e3bde
.long 0x3f61c598,0x3f49d112,0x3f2beb4a,0x3f08f59b,0x3f4d9f02,0x3f2e3bde,0x3f08f59b,0x3ebe1d4a
.long 0xbf54db31,0xbf7853f8,0xbf7ec46d,0xbf676bd8,0xbf676bd8,0xbf7f0e58,0xbf76ba07,0xbf4f7a1f
.long 0xbf74fa0b,0xbf7f4e6d,0xbf676bd8,0xbf3085bb,0xbf7d3aac,0xbf791298,0xbf514d3d,0xbf0b9a6b
.long 0x3f803f80,0x3f803f80,0x3f803f80,0x3f803f80,0x3f6d3f80,0x3ec43f35,0xbf6dbf80,0xbec4bf35
.long 0x3f353f80,0xbf350000,0x3f353f80,0xbf350000,0x3ec43f80,0xbf6dbf35,0xbec4bf80,0x3f6d3f35
.long 0x3f80,0xbf80,0x3f80,0xbf80,0xbec43f80,0x3f6dbf35,0x3ec4bf80,0xbf6d3f35
.long 0xbf353f80,0x3f350000,0xbf353f80,0x3f350000,0xbf6d3f80,0xbec43f35,0x3f6dbf80,0x3ec4bf35
.long 0xbf803f80,0xbf803f80,0xbf803f80,0xbf803f80,0xbf6d3f80,0xbec43f35,0x3f6dbf80,0x3ec4bf35
.long 0xbf353f80,0x3f350000,0xbf353f80,0x3f350000,0xbec43f80,0x3f6dbf35,0x3ec4bf80,0xbf6d3f35
.long 0x3f80,0xbf80,0x3f80,0xbf80,0x3ec43f80,0xbf6dbf35,0xbec4bf80,0x3f6d3f35
.long 0x3f353f80,0xbf350000,0x3f353f80,0xbf350000,0x3f6d3f80,0x3ec43f35,0xbf6dbf80,0xbec4bf35
.long 0x0,0x0,0x0,0x0,0x0,0x0,0x0,0x0
.long 0x0,0x0,0x0,0x0,0x0,0x0,0x0,0x0
.long 0x0,0x0,0x0,0x0,0x0,0x0,0x0,0x0
.long 0x0,0x0,0x0,0x0,0x0,0x0,0x0,0x0
.long 0x0,0x0,0x0,0x0,0x0,0x0,0x0,0x0
.long 0x0,0x0,0x0,0x0,0x0,0x0,0x0,0x0
.long 0x0,0x0,0x0,0x0,0x0,0x0,0x0,0x0
.long 0x0,0x0,0x0,0x0,0x0,0x0,0x0,0x0
.long 0x3f803f80,0x3f803f80,0x3f803f80,0x3f803f80,0xbec40000,0xbf6dbf35,0x3ec40000,0x3f6d3f35
.long 0xbf35bf80,0x3f350000,0xbf35bf80,0x3f350000,0x3f6d0000,0xbec43f35,0xbf6d0000,0x3ec4bf35
.long 0x3f80,0xbf80,0x3f80,0xbf80,0xbf6d0000,0x3ec43f35,0x3f6d0000,0xbec4bf35
.long 0x3f35bf80,0xbf350000,0x3f35bf80,0xbf350000,0x3ec40000,0x3f6dbf35,0xbec40000,0xbf6d3f35
.long 0xbf803f80,0xbf803f80,0xbf803f80,0xbf803f80,0x3ec40000,0x3f6dbf35,0xbec40000,0xbf6d3f35
.long 0x3f35bf80,0xbf350000,0x3f35bf80,0xbf350000,0xbf6d0000,0x3ec43f35,0x3f6d0000,0xbec4bf35
.long 0x3f80,0xbf80,0x3f80,0xbf80,0x3f6d0000,0xbec43f35,0xbf6d0000,0x3ec4bf35
.long 0xbf35bf80,0x3f350000,0xbf35bf80,0x3f350000,0xbec40000,0xbf6dbf35,0x3ec40000,0x3f6d3f35
.long 0x0,0x0,0x0,0x0,0x0,0x0,0x0,0x0
.long 0x0,0x0,0x0,0x0,0x0,0x0,0x0,0x0
.long 0x0,0x0,0x0,0x0,0x0,0x0,0x0,0x0
.long 0x0,0x0,0x0,0x0,0x0,0x0,0x0,0x0
.long 0x0,0x0,0x0,0x0,0x0,0x0,0x0,0x0
.long 0x0,0x0,0x0,0x0,0x0,0x0,0x0,0x0
.long 0x0,0x0,0x0,0x0,0x0,0x0,0x0,0x0
.long 0x0,0x0,0x0,0x0,0x0,0x0,0x0,0x0
.long 0x0,0x0,0x0,0x0,0x3ec40000,0x3f6d3f35,0xbec40000,0xbf6dbf35
.long 0x3f350000,0x3f353f80,0x3f350000,0x3f353f80,0x3f6d0000,0xbec43f35,0xbf6d0000,0x3ec4bf35
.long 0x3f800000,0xbf800000,0x3f800000,0xbf800000,0x3f6d0000,0xbec4bf35,0xbf6d0000,0x3ec43f35
.long 0x3f350000,0x3f35bf80,0x3f350000,0x3f35bf80,0x3ec40000,0x3f6dbf35,0xbec40000,0xbf6d3f35
.long 0x0,0x0,0x0,0x0,0xbec40000,0xbf6d3f35,0x3ec40000,0x3f6dbf35
.long 0xbf350000,0xbf353f80,0xbf350000,0xbf353f80,0xbf6d0000,0x3ec43f35,0x3f6d0000,0xbec4bf35
.long 0xbf800000,0x3f800000,0xbf800000,0x3f800000,0xbf6d0000,0x3ec4bf35,0x3f6d0000,0xbec43f35
.long 0xbf350000,0xbf35bf80,0xbf350000,0xbf35bf80,0xbec40000,0xbf6dbf35,0x3ec40000,0x3f6d3f35
.long 0x0,0x0,0x0,0x0,0x0,0x0,0x0,0x0
.long 0x0,0x0,0x0,0x0,0x0,0x0,0x0,0x0
.long 0x0,0x0,0x0,0x0,0x0,0x0,0x0,0x0
.long 0x0,0x0,0x0,0x0,0x0,0x0,0x0,0x0
.long 0x0,0x0,0x0,0x0,0x0,0x0,0x0,0x0
.long 0x0,0x0,0x0,0x0,0x0,0x0,0x0,0x0
.long 0x0,0x0,0x0,0x0,0x0,0x0,0x0,0x0
.long 0x0,0x0,0x0,0x0,0x0,0x0,0x0,0x0
.long 0x0,0x0,0x0,0x0,0x3f6d3f80,0x3ec43f35,0xbf6dbf80,0xbec4bf35
.long 0xbf350000,0xbf35bf80,0xbf350000,0xbf35bf80,0xbec4bf80,0x3f6d3f35,0x3ec43f80,0xbf6dbf35
.long 0x3f800000,0xbf800000,0x3f800000,0xbf800000,0xbec43f80,0x3f6dbf35,0x3ec4bf80,0xbf6d3f35
.long 0xbf350000,0xbf353f80,0xbf350000,0xbf353f80,0x3f6dbf80,0x3ec4bf35,0xbf6d3f80,0xbec43f35
.long 0x0,0x0,0x0,0x0,0xbf6d3f80,0xbec43f35,0x3f6dbf80,0x3ec4bf35
.long 0x3f350000,0x3f35bf80,0x3f350000,0x3f35bf80,0x3ec4bf80,0xbf6d3f35,0xbec43f80,0x3f6dbf35
.long 0xbf800000,0x3f800000,0xbf800000,0x3f800000,0x3ec43f80,0xbf6dbf35,0xbec4bf80,0x3f6d3f35
.long 0x3f350000,0x3f353f80,0x3f350000,0x3f353f80,0xbf6dbf80,0xbec4bf35,0x3f6d3f80,0x3ec43f35
.long 0x0,0x0,0x0,0x0,0x0,0x0,0x0,0x0
.long 0x0,0x0,0x0,0x0,0x0,0x0,0x0,0x0
.long 0x0,0x0,0x0,0x0,0x0,0x0,0x0,0x0
.long 0x0,0x0,0x0,0x0,0x0,0x0,0x0,0x0
.long 0x0,0x0,0x0,0x0,0x0,0x0,0x0,0x0
.long 0x0,0x0,0x0,0x0,0x0,0x0,0x0,0x0
.long 0x0,0x0,0x0,0x0,0x0,0x0,0x0,0x0
.long 0x0,0x0,0x0,0x0,0x0,0x0,0x0,0x0
.long 0x0,0x0,0x0,0x0,0x0,0x0,0x0,0x0
.long 0x0,0x0,0x0,0x0,0x0,0x0,0x0,0x0
.long 0x0,0x0,0x0,0x0,0x0,0x0,0x0,0x0
.long 0x0,0x0,0x0,0x0,0x0,0x0,0x0,0x0
.long 0x0,0x0,0x0,0x0,0x0,0x0,0x0,0x0
.long 0x0,0x0,0x0,0x0,0x0,0x0,0x0,0x0
.long 0x0,0x0,0x0,0x0,0x0,0x0,0x0,0x0
.long 0x0,0x0,0x0,0x0,0x0,0x0,0x0,0x0
.long 0x3f803f80,0x3f803f80,0x3f803f80,0x3f803f80,0x3f6d3f80,0x3ec43f35,0xbf6dbf80,0xbec4bf35
.long 0x3f353f80,0xbf350000,0x3f353f80,0xbf350000,0x3ec43f80,0xbf6dbf35,0xbec4bf80,0x3f6d3f35
.long 0x3f80,0xbf80,0x3f80,0xbf80,0xbec43f80,0x3f6dbf35,0x3ec4bf80,0xbf6d3f35
.long 0xbf353f80,0x3f350000,0xbf353f80,0x3f350000,0xbf6d3f80,0xbec43f35,0x3f6dbf80,0x3ec4bf35
.long 0xbf803f80,0xbf803f80,0xbf803f80,0xbf803f80,0xbf6d3f80,0xbec43f35,0x3f6dbf80,0x3ec4bf35
.long 0xbf353f80,0x3f350000,0xbf353f80,0x3f350000,0xbec43f80,0x3f6dbf35,0x3ec4bf80,0xbf6d3f35
.long 0x3f80,0xbf80,0x3f80,0xbf80,0x3ec43f80,0xbf6dbf35,0xbec4bf80,0x3f6d3f35
.long 0x3f353f80,0xbf350000,0x3f353f80,0xbf350000,0x3f6d3f80,0x3ec43f35,0xbf6dbf80,0xbec4bf35
.long 0x0,0x0,0x0,0x0,0x0,0x0,0x0,0x0
.long 0x0,0x0,0x0,0x0,0x0,0x0,0x0,0x0
.long 0x0,0x0,0x0,0x0,0x0,0x0,0x0,0x0
.long 0x0,0x0,0x0,0x0,0x0,0x0,0x0,0x0
.long 0x0,0x0,0x0,0x0,0x0,0x0,0x0,0x0
.long 0x0,0x0,0x0,0x0,0x0,0x0,0x0,0x0
.long 0x0,0x0,0x0,0x0,0x0,0x0,0x0,0x0
.long 0x0,0x0,0x0,0x0,0x0,0x0,0x0,0x0
.long 0x3f803f80,0x3f803f80,0x3f803f80,0x3f803f80,0xbec40000,0xbf6dbf35,0x3ec40000,0x3f6d3f35
.long 0xbf35bf80,0x3f350000,0xbf35bf80,0x3f350000,0x3f6d0000,0xbec43f35,0xbf6d0000,0x3ec4bf35
.long 0x3f80,0xbf80,0x3f80,0xbf80,0xbf6d0000,0x3ec43f35,0x3f6d0000,0xbec4bf35
.long 0x3f35bf80,0xbf350000,0x3f35bf80,0xbf350000,0x3ec40000,0x3f6dbf35,0xbec40000,0xbf6d3f35
.long 0xbf803f80,0xbf803f80,0xbf803f80,0xbf803f80,0x3ec40000,0x3f6dbf35,0xbec40000,0xbf6d3f35
.long 0x3f35bf80,0xbf350000,0x3f35bf80,0xbf350000,0xbf6d0000,0x3ec43f35,0x3f6d0000,0xbec4bf35
.long 0x3f80,0xbf80,0x3f80,0xbf80,0x3f6d0000,0xbec43f35,0xbf6d0000,0x3ec4bf35
.long 0xbf35bf80,0x3f350000,0xbf35bf80,0x3f350000,0xbec40000,0xbf6dbf35,0x3ec40000,0x3f6d3f35
.long 0x0,0x0,0x0,0x0,0x0,0x0,0x0,0x0
.long 0x0,0x0,0x0,0x0,0x0,0x0,0x0,0x0
.long 0x0,0x0,0x0,0x0,0x0,0x0,0x0,0x0
.long 0x0,0x0,0x0,0x0,0x0,0x0,0x0,0x0
.long 0x0,0x0,0x0,0x0,0x0,0x0,0x0,0x0
.long 0x0,0x0,0x0,0x0,0x0,0x0,0x0,0x0
.long 0x0,0x0,0x0,0x0,0x0,0x0,0x0,0x0
.long 0x0,0x0,0x0,0x0,0x0,0x0,0x0,0x0
.long 0x0,0x0,0x0,0x0,0x3ec40000,0x3f6d3f35,0xbec40000,0xbf6dbf35
.long 0x3f350000,0x3f353f80,0x3f350000,0x3f353f80,0x3f6d0000,0xbec43f35,0xbf6d0000,0x3ec4bf35
.long 0x3f800000,0xbf800000,0x3f800000,0xbf800000,0x3f6d0000,0xbec4bf35,0xbf6d0000,0x3ec43f35
.long 0x3f350000,0x3f35bf80,0x3f350000,0x3f35bf80,0x3ec40000,0x3f6dbf35,0xbec40000,0xbf6d3f35
.long 0x0,0x0,0x0,0x0,0xbec40000,0xbf6d3f35,0x3ec40000,0x3f6dbf35
.long 0xbf350000,0xbf353f80,0xbf350000,0xbf353f80,0xbf6d0000,0x3ec43f35,0x3f6d0000,0xbec4bf35
.long 0xbf800000,0x3f800000,0xbf800000,0x3f800000,0xbf6d0000,0x3ec4bf35,0x3f6d0000,0xbec43f35
.long 0xbf350000,0xbf35bf80,0xbf350000,0xbf35bf80,0xbec40000,0xbf6dbf35,0x3ec40000,0x3f6d3f35
.long 0x0,0x0,0x0,0x0,0x0,0x0,0x0,0x0
.long 0x0,0x0,0x0,0x0,0x0,0x0,0x0,0x0
.long 0x0,0x0,0x0,0x0,0x0,0x0,0x0,0x0
.long 0x0,0x0,0x0,0x0,0x0,0x0,0x0,0x0
.long 0x0,0x0,0x0,0x0,0x0,0x0,0x0,0x0
.long 0x0,0x0,0x0,0x0,0x0,0x0,0x0,0x0
.long 0x0,0x0,0x0,0x0,0x0,0x0,0x0,0x0
.long 0x0,0x0,0x0,0x0,0x0,0x0,0x0,0x0
.long 0x0,0x0,0x0,0x0,0x3f6d3f80,0x3ec43f35,0xbf6dbf80,0xbec4bf35
.long 0xbf350000,0xbf35bf80,0xbf350000,0xbf35bf80,0xbec4bf80,0x3f6d3f35,0x3ec43f80,0xbf6dbf35
.long 0x3f800000,0xbf800000,0x3f800000,0xbf800000,0xbec43f80,0x3f6dbf35,0x3ec4bf80,0xbf6d3f35
.long 0xbf350000,0xbf353f80,0xbf350000,0xbf353f80,0x3f6dbf80,0x3ec4bf35,0xbf6d3f80,0xbec43f35
.long 0x0,0x0,0x0,0x0,0xbf6d3f80,0xbec43f35,0x3f6dbf80,0x3ec4bf35
.long 0x3f350000,0x3f35bf80,0x3f350000,0x3f35bf80,0x3ec4bf80,0xbf6d3f35,0xbec43f80,0x3f6dbf35
.long 0xbf800000,0x3f800000,0xbf800000,0x3f800000,0x3ec43f80,0xbf6dbf35,0xbec4bf80,0x3f6d3f35
.long 0x3f350000,0x3f353f80,0x3f350000,0x3f353f80,0xbf6dbf80,0xbec4bf35,0x3f6d3f80,0x3ec43f35
.long 0x3f803f80,0x3f803f80,0x3f803f80,0x3f803f80,0x3f803f80,0x3f803f80,0x3f803f80,0x3f803f80
.long 0x3f7b3f80,0x3f553f6d,0xbe480000,0xbf0ebec4,0xbe480000,0xbf0ebec4,0xbf7bbf80,0xbf55bf6d
.long 0x3f6d3f80,0x3ec43f35,0xbf6dbf80,0xbec4bf35,0xbec40000,0xbf6dbf35,0x3ec40000,0x3f6d3f35
.long 0x3f553f80,0xbe483ec4,0x3f0e0000,0x3f7b3f6d,0xbf0e0000,0xbf7bbf6d,0x3f553f80,0xbe483ec4
.long 0x3f353f80,0xbf350000,0x3f353f80,0xbf350000,0xbf350000,0xbf35bf80,0xbf350000,0xbf35bf80
.long 0x3f0e3f80,0xbf7bbec4,0xbf550000,0xbe48bf6d,0xbf550000,0xbe48bf6d,0xbf0ebf80,0x3f7b3ec4
.long 0x3ec43f80,0xbf6dbf35,0xbec4bf80,0x3f6d3f35,0xbf6d0000,0x3ec4bf35,0x3f6d0000,0xbec43f35
.long 0x3e483f80,0xbf0ebf6d,0x3f7b0000,0xbf553ec4,0xbf7b0000,0x3f55bec4,0x3e483f80,0xbf0ebf6d
.long 0x3f803f80,0x3f803f80,0x3f803f80,0x3f803f80,0x3f803f80,0x3f803f80,0x3f803f80,0x3f803f80
.long 0x3f0e3f35,0x3e483ec4,0xbf55bf35,0xbf7bbf6d,0xbf55bf35,0xbf7bbf6d,0xbf0ebf35,0xbe48bec4
.long 0xbec40000,0xbf6dbf35,0x3ec40000,0x3f6d3f35,0xbf6dbf80,0xbec4bf35,0x3f6d3f80,0x3ec43f35
.long 0xbf7bbf35,0xbf0ebf6d,0x3e483f35,0xbf55bec4,0xbe48bf35,0x3f553ec4,0xbf7bbf35,0xbf0ebf6d
.long 0xbf35bf80,0x3f350000,0xbf35bf80,0x3f350000,0x3f350000,0x3f353f80,0x3f350000,0x3f353f80
.long 0x3e48bf35,0x3f553f6d,0x3f7b3f35,0xbf0e3ec4,0x3f7b3f35,0xbf0e3ec4,0xbe483f35,0xbf55bf6d
.long 0x3f6d0000,0xbec43f35,0xbf6d0000,0x3ec4bf35,0x3ec43f80,0xbf6dbf35,0xbec4bf80,0x3f6d3f35
.long 0x3f553f35,0xbf7bbec4,0x3f0ebf35,0xbe483f6d,0xbf0e3f35,0x3e48bf6d,0x3f553f35,0xbf7bbec4
.long 0x3f803f80,0x3f803f80,0x3f803f80,0x3f803f80,0xbf80bf80,0xbf80bf80,0xbf80bf80,0xbf80bf80
.long 0x3f753f7f,0x3f463f62,0xbe95bdc9,0xbf22bef1,0xbe95bdc9,0xbf22bef1,0xbf75bf7f,0xbf46bf62
.long 0x3f553f7b,0x3e483f0e,0xbf55bf7b,0xbe48bf0e,0xbf0ebe48,0xbf7bbf55,0x3f0e3e48,0x3f7b3f55
.long 0x3f223f75,0xbef13dc9,0x3f463e95,0x3f623f7f,0xbf46be95,0xbf62bf7f,0x3f223f75,0xbef13dc9
.long 0x3ec43f6d,0xbf6dbec4,0x3ec43f6d,0xbf6dbec4,0xbf6dbec4,0xbec4bf6d,0xbf6dbec4,0xbec4bf6d
.long 0x3dc93f62,0xbf75bf46,0xbf7fbef1,0x3e95bf22,0xbf7fbef1,0x3e95bf22,0xbdc9bf62,0x3f753f46
.long 0xbe483f55,0xbf0ebf7b,0x3e48bf55,0x3f0e3f7b,0xbf7bbf0e,0x3f55be48,0x3f7b3f0e,0xbf553e48
.long 0xbef13f46,0x3dc9bf75,0x3f623f22,0xbf7fbe95,0xbf62bf22,0x3f7f3e95,0xbef13f46,0x3dc9bf75
.long 0x3f803f80,0x3f803f80,0x3f803f80,0x3f803f80,0xbf80bf80,0xbf80bf80,0xbf80bf80,0xbf80bf80
.long 0x3ef13f22,0x3dc93e95,0xbf62bf46,0xbf7fbf75,0xbf62bf46,0xbf7fbf75,0xbef1bf22,0xbdc9be95
.long 0xbf0ebe48,0xbf7bbf55,0x3f0e3e48,0x3f7b3f55,0xbf55bf7b,0xbe48bf0e,0x3f553f7b,0x3e483f0e
.long 0xbf7fbf62,0xbe95bf46,0xbdc93ef1,0xbf75bf22,0x3dc9bef1,0x3f753f22,0xbf7fbf62,0xbe95bf46
.long 0xbec4bf6d,0x3f6d3ec4,0xbec4bf6d,0x3f6d3ec4,0x3f6d3ec4,0x3ec43f6d,0x3f6d3ec4,0x3ec43f6d
.long 0x3f22be95,0x3ef13f7f,0x3f463f75,0xbf62bdc9,0x3f463f75,0xbf62bdc9,0xbf223e95,0xbef1bf7f
.long 0x3f7b3f0e,0xbf553e48,0xbf7bbf0e,0x3f55be48,0xbe483f55,0xbf0ebf7b,0x3e48bf55,0x3f0e3f7b
.long 0x3e953f7f,0xbf22bf62,0x3f75bdc9,0xbf463ef1,0xbf753dc9,0x3f46bef1,0x3e953f7f,0xbf22bf62
.long 0x3f803f80,0x3f803f80,0x3f803f80,0x3f803f80,0x3f803f80,0x3f803f80,0x3f803f80,0x3f803f80
.long 0xbf7bbf80,0xbf55bf6d,0x3e480000,0x3f0e3ec4,0x3e480000,0x3f0e3ec4,0x3f7b3f80,0x3f553f6d
.long 0x3f6d3f80,0x3ec43f35,0xbf6dbf80,0xbec4bf35,0xbec40000,0xbf6dbf35,0x3ec40000,0x3f6d3f35
.long 0xbf55bf80,0x3e48bec4,0xbf0e0000,0xbf7bbf6d,0x3f0e0000,0x3f7b3f6d,0xbf55bf80,0x3e48bec4
.long 0x3f353f80,0xbf350000,0x3f353f80,0xbf350000,0xbf350000,0xbf35bf80,0xbf350000,0xbf35bf80
.long 0xbf0ebf80,0x3f7b3ec4,0x3f550000,0x3e483f6d,0x3f550000,0x3e483f6d,0x3f0e3f80,0xbf7bbec4
.long 0x3ec43f80,0xbf6dbf35,0xbec4bf80,0x3f6d3f35,0xbf6d0000,0x3ec4bf35,0x3f6d0000,0xbec43f35
.long 0xbe48bf80,0x3f0e3f6d,0xbf7b0000,0x3f55bec4,0x3f7b0000,0xbf553ec4,0xbe48bf80,0x3f0e3f6d
.long 0x3f803f80,0x3f803f80,0x3f803f80,0x3f803f80,0x3f803f80,0x3f803f80,0x3f803f80,0x3f803f80
.long 0xbf0ebf35,0xbe48bec4,0x3f553f35,0x3f7b3f6d,0x3f553f35,0x3f7b3f6d,0x3f0e3f35,0x3e483ec4
.long 0xbec40000,0xbf6dbf35,0x3ec40000,0x3f6d3f35,0xbf6dbf80,0xbec4bf35,0x3f6d3f80,0x3ec43f35
.long 0x3f7b3f35,0x3f0e3f6d,0xbe48bf35,0x3f553ec4,0x3e483f35,0xbf55bec4,0x3f7b3f35,0x3f0e3f6d
.long 0xbf35bf80,0x3f350000,0xbf35bf80,0x3f350000,0x3f350000,0x3f353f80,0x3f350000,0x3f353f80
.long 0xbe483f35,0xbf55bf6d,0xbf7bbf35,0x3f0ebec4,0xbf7bbf35,0x3f0ebec4,0x3e48bf35,0x3f553f6d
.long 0x3f6d0000,0xbec43f35,0xbf6d0000,0x3ec4bf35,0x3ec43f80,0xbf6dbf35,0xbec4bf80,0x3f6d3f35
.long 0xbf55bf35,0x3f7b3ec4,0xbf0e3f35,0x3e48bf6d,0x3f0ebf35,0xbe483f6d,0xbf55bf35,0x3f7b3ec4
.long 0x3f803f80,0x3f803f80,0x3f803f80,0x3f803f80,0xbf80bf80,0xbf80bf80,0xbf80bf80,0xbf80bf80
.long 0xbf75bf7f,0xbf46bf62,0x3e953dc9,0x3f223ef1,0x3e953dc9,0x3f223ef1,0x3f753f7f,0x3f463f62
.long 0x3f553f7b,0x3e483f0e,0xbf55bf7b,0xbe48bf0e,0xbf0ebe48,0xbf7bbf55,0x3f0e3e48,0x3f7b3f55
.long 0xbf22bf75,0x3ef1bdc9,0xbf46be95,0xbf62bf7f,0x3f463e95,0x3f623f7f,0xbf22bf75,0x3ef1bdc9
.long 0x3ec43f6d,0xbf6dbec4,0x3ec43f6d,0xbf6dbec4,0xbf6dbec4,0xbec4bf6d,0xbf6dbec4,0xbec4bf6d
.long 0xbdc9bf62,0x3f753f46,0x3f7f3ef1,0xbe953f22,0x3f7f3ef1,0xbe953f22,0x3dc93f62,0xbf75bf46
.long 0xbe483f55,0xbf0ebf7b,0x3e48bf55,0x3f0e3f7b,0xbf7bbf0e,0x3f55be48,0x3f7b3f0e,0xbf553e48
.long 0x3ef1bf46,0xbdc93f75,0xbf62bf22,0x3f7f3e95,0x3f623f22,0xbf7fbe95,0x3ef1bf46,0xbdc93f75
.long 0x3f803f80,0x3f803f80,0x3f803f80,0x3f803f80,0xbf80bf80,0xbf80bf80,0xbf80bf80,0xbf80bf80
.long 0xbef1bf22,0xbdc9be95,0x3f623f46,0x3f7f3f75,0x3f623f46,0x3f7f3f75,0x3ef13f22,0x3dc93e95
.long 0xbf0ebe48,0xbf7bbf55,0x3f0e3e48,0x3f7b3f55,0xbf55bf7b,0xbe48bf0e,0x3f553f7b,0x3e483f0e
.long 0x3f7f3f62,0x3e953f46,0x3dc9bef1,0x3f753f22,0xbdc93ef1,0xbf75bf22,0x3f7f3f62,0x3e953f46
.long 0xbec4bf6d,0x3f6d3ec4,0xbec4bf6d,0x3f6d3ec4,0x3f6d3ec4,0x3ec43f6d,0x3f6d3ec4,0x3ec43f6d
.long 0xbf223e95,0xbef1bf7f,0xbf46bf75,0x3f623dc9,0xbf46bf75,0x3f623dc9,0x3f22be95,0x3ef13f7f
.long 0x3f7b3f0e,0xbf553e48,0xbf7bbf0e,0x3f55be48,0xbe483f55,0xbf0ebf7b,0x3e48bf55,0x3f0e3f7b
.long 0xbe95bf7f,0x3f223f62,0xbf753dc9,0x3f46bef1,0x3f75bdc9,0xbf463ef1,0xbe95bf7f,0x3f223f62
.long 0x3f80,0xbf80,0x3f80,0xbf80,0xbf800000,0x3f800000,0xbf800000,0x3f800000
.long 0xbe483f80,0x3f0ebf6d,0xbf7b0000,0x3f553ec4,0xbf7b0000,0x3f553ec4,0x3e48bf80,0xbf0e3f6d
.long 0xbec43f80,0x3f6dbf35,0x3ec4bf80,0xbf6d3f35,0xbf6d0000,0x3ec43f35,0x3f6d0000,0xbec4bf35
.long 0xbf0e3f80,0x3f7bbec4,0x3f550000,0x3e48bf6d,0xbf550000,0xbe483f6d,0xbf0e3f80,0x3f7bbec4
.long 0xbf353f80,0x3f350000,0xbf353f80,0x3f350000,0xbf350000,0xbf353f80,0xbf350000,0xbf353f80
.long 0xbf553f80,0x3e483ec4,0xbf0e0000,0xbf7b3f6d,0xbf0e0000,0xbf7b3f6d,0x3f55bf80,0xbe48bec4
.long 0xbf6d3f80,0xbec43f35,0x3f6dbf80,0x3ec4bf35,0xbec40000,0xbf6d3f35,0x3ec40000,0x3f6dbf35
.long 0xbf7b3f80,0xbf553f6d,0x3e480000,0x3f0ebec4,0xbe480000,0xbf0e3ec4,0xbf7b3f80,0xbf553f6d
.long 0x3f80,0xbf80,0x3f80,0xbf80,0xbf800000,0x3f800000,0xbf800000,0x3f800000
.long 0xbf553f35,0x3f7bbec4,0xbf0ebf35,0x3e483f6d,0xbf0ebf35,0x3e483f6d,0x3f55bf35,0xbf7b3ec4
.long 0xbf6d0000,0x3ec43f35,0x3f6d0000,0xbec4bf35,0x3ec4bf80,0xbf6d3f35,0xbec43f80,0x3f6dbf35
.long 0xbe48bf35,0xbf553f6d,0xbf7b3f35,0x3f0e3ec4,0x3f7bbf35,0xbf0ebec4,0xbe48bf35,0xbf553f6d
.long 0x3f35bf80,0xbf350000,0x3f35bf80,0xbf350000,0x3f350000,0x3f35bf80,0x3f350000,0x3f35bf80
.long 0x3f7bbf35,0x3f0ebf6d,0xbe483f35,0x3f55bec4,0xbe483f35,0x3f55bec4,0xbf7b3f35,0xbf0e3f6d
.long 0x3ec40000,0x3f6dbf35,0xbec40000,0xbf6d3f35,0xbf6d3f80,0xbec43f35,0x3f6dbf80,0x3ec4bf35
.long 0xbf0e3f35,0xbe483ec4,0x3f55bf35,0x3f7bbf6d,0xbf553f35,0xbf7b3f6d,0xbf0e3f35,0xbe483ec4
.long 0xbf353f35,0x3f35bf35,0xbf353f35,0x3f35bf35,0xbf35bf35,0x3f353f35,0xbf35bf35,0x3f353f35
.long 0xbf623f22,0x3f7fbe95,0xbef1bf46,0x3dc93f75,0xbef1bf46,0x3dc93f75,0x3f62bf22,0xbf7f3e95
.long 0xbf7b3f0e,0x3f553e48,0x3f7bbf0e,0xbf55be48,0xbe48bf55,0xbf0e3f7b,0x3e483f55,0x3f0ebf7b
.long 0xbf7f3ef1,0x3e953f22,0xbdc93f62,0x3f75bf46,0x3dc9bf62,0xbf753f46,0xbf7f3ef1,0x3e953f22
.long 0xbf6d3ec4,0xbec43f6d,0xbf6d3ec4,0xbec43f6d,0x3ec4bf6d,0xbf6d3ec4,0x3ec4bf6d,0xbf6d3ec4
.long 0xbf463e95,0xbf623f7f,0x3f22bf75,0xbef1bdc9,0x3f22bf75,0xbef1bdc9,0x3f46be95,0x3f62bf7f
.long 0xbf0e3e48,0xbf7b3f55,0x3f0ebe48,0x3f7bbf55,0x3f55bf7b,0x3e48bf0e,0xbf553f7b,0xbe483f0e
.long 0xbe953dc9,0xbf223ef1,0xbf753f7f,0xbf463f62,0x3f75bf7f,0x3f46bf62,0xbe953dc9,0xbf223ef1
.long 0xbf353f35,0x3f35bf35,0xbf353f35,0x3f35bf35,0xbf35bf35,0x3f353f35,0xbf35bf35,0x3f353f35
.long 0xbf75bdc9,0x3f463ef1,0x3e95bf7f,0xbf223f62,0x3e95bf7f,0xbf223f62,0x3f753dc9,0xbf46bef1
.long 0xbe48bf55,0xbf0e3f7b,0x3e483f55,0x3f0ebf7b,0x3f7bbf0e,0xbf55be48,0xbf7b3f0e,0x3f553e48
.long 0x3f46bf75,0xbf623dc9,0xbf22be95,0xbef13f7f,0x3f223e95,0x3ef1bf7f,0x3f46bf75,0xbf623dc9
.long 0x3f6dbec4,0x3ec4bf6d,0x3f6dbec4,0x3ec4bf6d,0xbec43f6d,0x3f6dbec4,0xbec43f6d,0x3f6dbec4
.long 0x3dc93ef1,0x3f75bf22,0xbf7f3f62,0xbe953f46,0xbf7f3f62,0xbe953f46,0xbdc9bef1,0xbf753f22
.long 0xbf553f7b,0xbe483f0e,0x3f55bf7b,0x3e48bf0e,0xbf0e3e48,0xbf7b3f55,0x3f0ebe48,0x3f7bbf55
.long 0xbf623f46,0xbf7f3f75,0xbef13f22,0xbdc93e95,0x3ef1bf22,0x3dc9be95,0xbf623f46,0xbf7f3f75
.long 0x3f80,0xbf80,0x3f80,0xbf80,0xbf800000,0x3f800000,0xbf800000,0x3f800000
.long 0x3e48bf80,0xbf0e3f6d,0x3f7b0000,0xbf55bec4,0x3f7b0000,0xbf55bec4,0xbe483f80,0x3f0ebf6d
.long 0xbec43f80,0x3f6dbf35,0x3ec4bf80,0xbf6d3f35,0xbf6d0000,0x3ec43f35,0x3f6d0000,0xbec4bf35
.long 0x3f0ebf80,0xbf7b3ec4,0xbf550000,0xbe483f6d,0x3f550000,0x3e48bf6d,0x3f0ebf80,0xbf7b3ec4
.long 0xbf353f80,0x3f350000,0xbf353f80,0x3f350000,0xbf350000,0xbf353f80,0xbf350000,0xbf353f80
.long 0x3f55bf80,0xbe48bec4,0x3f0e0000,0x3f7bbf6d,0x3f0e0000,0x3f7bbf6d,0xbf553f80,0x3e483ec4
.long 0xbf6d3f80,0xbec43f35,0x3f6dbf80,0x3ec4bf35,0xbec40000,0xbf6d3f35,0x3ec40000,0x3f6dbf35
.long 0x3f7bbf80,0x3f55bf6d,0xbe480000,0xbf0e3ec4,0x3e480000,0x3f0ebec4,0x3f7bbf80,0x3f55bf6d
.long 0x3f80,0xbf80,0x3f80,0xbf80,0xbf800000,0x3f800000,0xbf800000,0x3f800000
.long 0x3f55bf35,0xbf7b3ec4,0x3f0e3f35,0xbe48bf6d,0x3f0e3f35,0xbe48bf6d,0xbf553f35,0x3f7bbec4
.long 0xbf6d0000,0x3ec43f35,0x3f6d0000,0xbec4bf35,0x3ec4bf80,0xbf6d3f35,0xbec43f80,0x3f6dbf35
.long 0x3e483f35,0x3f55bf6d,0x3f7bbf35,0xbf0ebec4,0xbf7b3f35,0x3f0e3ec4,0x3e483f35,0x3f55bf6d
.long 0x3f35bf80,0xbf350000,0x3f35bf80,0xbf350000,0x3f350000,0x3f35bf80,0x3f350000,0x3f35bf80
.long 0xbf7b3f35,0xbf0e3f6d,0x3e48bf35,0xbf553ec4,0x3e48bf35,0xbf553ec4,0x3f7bbf35,0x3f0ebf6d
.long 0x3ec40000,0x3f6dbf35,0xbec40000,0xbf6d3f35,0xbf6d3f80,0xbec43f35,0x3f6dbf80,0x3ec4bf35
.long 0x3f0ebf35,0x3e48bec4,0xbf553f35,0xbf7b3f6d,0x3f55bf35,0x3f7bbf6d,0x3f0ebf35,0x3e48bec4
.long 0xbf353f35,0x3f35bf35,0xbf353f35,0x3f35bf35,0xbf35bf35,0x3f353f35,0xbf35bf35,0x3f353f35
.long 0x3f62bf22,0xbf7f3e95,0x3ef13f46,0xbdc9bf75,0x3ef13f46,0xbdc9bf75,0xbf623f22,0x3f7fbe95
.long 0xbf7b3f0e,0x3f553e48,0x3f7bbf0e,0xbf55be48,0xbe48bf55,0xbf0e3f7b,0x3e483f55,0x3f0ebf7b
.long 0x3f7fbef1,0xbe95bf22,0x3dc9bf62,0xbf753f46,0xbdc93f62,0x3f75bf46,0x3f7fbef1,0xbe95bf22
.long 0xbf6d3ec4,0xbec43f6d,0xbf6d3ec4,0xbec43f6d,0x3ec4bf6d,0xbf6d3ec4,0x3ec4bf6d,0xbf6d3ec4
.long 0x3f46be95,0x3f62bf7f,0xbf223f75,0x3ef13dc9,0xbf223f75,0x3ef13dc9,0xbf463e95,0xbf623f7f
.long 0xbf0e3e48,0xbf7b3f55,0x3f0ebe48,0x3f7bbf55,0x3f55bf7b,0x3e48bf0e,0xbf553f7b,0xbe483f0e
.long 0x3e95bdc9,0x3f22bef1,0x3f75bf7f,0x3f46bf62,0xbf753f7f,0xbf463f62,0x3e95bdc9,0x3f22bef1
.long 0xbf353f35,0x3f35bf35,0xbf353f35,0x3f35bf35,0xbf35bf35,0x3f353f35,0xbf35bf35,0x3f353f35
.long 0x3f753dc9,0xbf46bef1,0xbe953f7f,0x3f22bf62,0xbe953f7f,0x3f22bf62,0xbf75bdc9,0x3f463ef1
.long 0xbe48bf55,0xbf0e3f7b,0x3e483f55,0x3f0ebf7b,0x3f7bbf0e,0xbf55be48,0xbf7b3f0e,0x3f553e48
.long 0xbf463f75,0x3f62bdc9,0x3f223e95,0x3ef1bf7f,0xbf22be95,0xbef13f7f,0xbf463f75,0x3f62bdc9
.long 0x3f6dbec4,0x3ec4bf6d,0x3f6dbec4,0x3ec4bf6d,0xbec43f6d,0x3f6dbec4,0xbec43f6d,0x3f6dbec4
.long 0xbdc9bef1,0xbf753f22,0x3f7fbf62,0x3e95bf46,0x3f7fbf62,0x3e95bf46,0x3dc93ef1,0x3f75bf22
.long 0xbf553f7b,0xbe483f0e,0x3f55bf7b,0x3e48bf0e,0xbf0e3e48,0xbf7b3f55,0x3f0ebe48,0x3f7bbf55
.long 0x3f62bf46,0x3f7fbf75,0x3ef1bf22,0x3dc9be95,0xbef13f22,0xbdc93e95,0x3f62bf46,0x3f7fbf75
.long 0xbf803f80,0xbf803f80,0xbf803f80,0xbf803f80,0x0,0x0,0x0,0x0
.long 0xbf7b3f80,0xbf553f6d,0x3e480000,0x3f0ebec4,0x3e480000,0x3f0ebec4,0x3f7bbf80,0x3f55bf6d
.long 0xbf6d3f80,0xbec43f35,0x3f6dbf80,0x3ec4bf35,0x3ec40000,0x3f6dbf35,0xbec40000,0xbf6d3f35
.long 0xbf553f80,0x3e483ec4,0xbf0e0000,0xbf7b3f6d,0x3f0e0000,0x3f7bbf6d,0xbf553f80,0x3e483ec4
.long 0xbf353f80,0x3f350000,0xbf353f80,0x3f350000,0x3f350000,0x3f35bf80,0x3f350000,0x3f35bf80
.long 0xbf0e3f80,0x3f7bbec4,0x3f550000,0x3e48bf6d,0x3f550000,0x3e48bf6d,0x3f0ebf80,0xbf7b3ec4
.long 0xbec43f80,0x3f6dbf35,0x3ec4bf80,0xbf6d3f35,0x3f6d0000,0xbec4bf35,0xbf6d0000,0x3ec43f35
.long 0xbe483f80,0x3f0ebf6d,0xbf7b0000,0x3f553ec4,0x3f7b0000,0xbf55bec4,0xbe483f80,0x3f0ebf6d
.long 0xbf803f80,0xbf803f80,0xbf803f80,0xbf803f80,0x0,0x0,0x0,0x0
.long 0xbf0e3f35,0xbe483ec4,0x3f55bf35,0x3f7bbf6d,0x3f55bf35,0x3f7bbf6d,0x3f0ebf35,0x3e48bec4
.long 0x3ec40000,0x3f6dbf35,0xbec40000,0xbf6d3f35,0x3f6dbf80,0x3ec4bf35,0xbf6d3f80,0xbec43f35
.long 0x3f7bbf35,0x3f0ebf6d,0xbe483f35,0x3f55bec4,0x3e48bf35,0xbf553ec4,0x3f7bbf35,0x3f0ebf6d
.long 0x3f35bf80,0xbf350000,0x3f35bf80,0xbf350000,0xbf350000,0xbf353f80,0xbf350000,0xbf353f80
.long 0xbe48bf35,0xbf553f6d,0xbf7b3f35,0x3f0e3ec4,0xbf7b3f35,0x3f0e3ec4,0x3e483f35,0x3f55bf6d
.long 0xbf6d0000,0x3ec43f35,0x3f6d0000,0xbec4bf35,0xbec43f80,0x3f6dbf35,0x3ec4bf80,0xbf6d3f35
.long 0xbf553f35,0x3f7bbec4,0xbf0ebf35,0x3e483f6d,0x3f0e3f35,0xbe48bf6d,0xbf553f35,0x3f7bbec4
.long 0x0,0x0,0x0,0x0,0x3f80bf80,0x3f80bf80,0x3f80bf80,0x3f80bf80
.long 0x3e95bdc9,0x3f22bef1,0x3f75bf7f,0x3f46bf62,0x3f75bf7f,0x3f46bf62,0xbe953dc9,0xbf223ef1
.long 0x3f0ebe48,0x3f7bbf55,0xbf0e3e48,0xbf7b3f55,0x3f55bf7b,0x3e48bf0e,0xbf553f7b,0xbe483f0e
.long 0x3f46be95,0x3f62bf7f,0xbf223f75,0x3ef13dc9,0x3f22bf75,0xbef1bdc9,0x3f46be95,0x3f62bf7f
.long 0x3f6dbec4,0x3ec4bf6d,0x3f6dbec4,0x3ec4bf6d,0x3ec4bf6d,0xbf6d3ec4,0x3ec4bf6d,0xbf6d3ec4
.long 0x3f7fbef1,0xbe95bf22,0x3dc9bf62,0xbf753f46,0x3dc9bf62,0xbf753f46,0xbf7f3ef1,0x3e953f22
.long 0x3f7bbf0e,0xbf55be48,0xbf7b3f0e,0x3f553e48,0xbe48bf55,0xbf0e3f7b,0x3e483f55,0x3f0ebf7b
.long 0x3f62bf22,0xbf7f3e95,0x3ef13f46,0xbdc9bf75,0xbef1bf46,0x3dc93f75,0x3f62bf22,0xbf7f3e95
.long 0x0,0x0,0x0,0x0,0x3f80bf80,0x3f80bf80,0x3f80bf80,0x3f80bf80
.long 0x3f62bf46,0x3f7fbf75,0x3ef1bf22,0x3dc9be95,0x3ef1bf22,0x3dc9be95,0xbf623f46,0xbf7f3f75
.long 0x3f55bf7b,0x3e48bf0e,0xbf553f7b,0xbe483f0e,0xbf0e3e48,0xbf7b3f55,0x3f0ebe48,0x3f7bbf55
.long 0xbdc9bef1,0xbf753f22,0x3f7fbf62,0x3e95bf46,0xbf7f3f62,0xbe953f46,0xbdc9bef1,0xbf753f22
.long 0xbf6d3ec4,0xbec43f6d,0xbf6d3ec4,0xbec43f6d,0xbec43f6d,0x3f6dbec4,0xbec43f6d,0x3f6dbec4
.long 0xbf463f75,0x3f62bdc9,0x3f223e95,0x3ef1bf7f,0x3f223e95,0x3ef1bf7f,0x3f46bf75,0xbf623dc9
.long 0x3e483f55,0x3f0ebf7b,0xbe48bf55,0xbf0e3f7b,0x3f7bbf0e,0xbf55be48,0xbf7b3f0e,0x3f553e48
.long 0x3f753dc9,0xbf46bef1,0xbe953f7f,0x3f22bf62,0x3e95bf7f,0xbf223f62,0x3f753dc9,0xbf46bef1
.long 0xbf803f80,0xbf803f80,0xbf803f80,0xbf803f80,0x0,0x0,0x0,0x0
.long 0x3f7bbf80,0x3f55bf6d,0xbe480000,0xbf0e3ec4,0xbe480000,0xbf0e3ec4,0xbf7b3f80,0xbf553f6d
.long 0xbf6d3f80,0xbec43f35,0x3f6dbf80,0x3ec4bf35,0x3ec40000,0x3f6dbf35,0xbec40000,0xbf6d3f35
.long 0x3f55bf80,0xbe48bec4,0x3f0e0000,0x3f7bbf6d,0xbf0e0000,0xbf7b3f6d,0x3f55bf80,0xbe48bec4
.long 0xbf353f80,0x3f350000,0xbf353f80,0x3f350000,0x3f350000,0x3f35bf80,0x3f350000,0x3f35bf80
.long 0x3f0ebf80,0xbf7b3ec4,0xbf550000,0xbe483f6d,0xbf550000,0xbe483f6d,0xbf0e3f80,0x3f7bbec4
.long 0xbec43f80,0x3f6dbf35,0x3ec4bf80,0xbf6d3f35,0x3f6d0000,0xbec4bf35,0xbf6d0000,0x3ec43f35
.long 0x3e48bf80,0xbf0e3f6d,0x3f7b0000,0xbf55bec4,0xbf7b0000,0x3f553ec4,0x3e48bf80,0xbf0e3f6d
.long 0xbf803f80,0xbf803f80,0xbf803f80,0xbf803f80,0x0,0x0,0x0,0x0
.long 0x3f0ebf35,0x3e48bec4,0xbf553f35,0xbf7b3f6d,0xbf553f35,0xbf7b3f6d,0xbf0e3f35,0xbe483ec4
.long 0x3ec40000,0x3f6dbf35,0xbec40000,0xbf6d3f35,0x3f6dbf80,0x3ec4bf35,0xbf6d3f80,0xbec43f35
.long 0xbf7b3f35,0xbf0e3f6d,0x3e48bf35,0xbf553ec4,0xbe483f35,0x3f55bec4,0xbf7b3f35,0xbf0e3f6d
.long 0x3f35bf80,0xbf350000,0x3f35bf80,0xbf350000,0xbf350000,0xbf353f80,0xbf350000,0xbf353f80
.long 0x3e483f35,0x3f55bf6d,0x3f7bbf35,0xbf0ebec4,0x3f7bbf35,0xbf0ebec4,0xbe48bf35,0xbf553f6d
.long 0xbf6d0000,0x3ec43f35,0x3f6d0000,0xbec4bf35,0xbec43f80,0x3f6dbf35,0x3ec4bf80,0xbf6d3f35
.long 0x3f55bf35,0xbf7b3ec4,0x3f0e3f35,0xbe48bf6d,0xbf0ebf35,0x3e483f6d,0x3f55bf35,0xbf7b3ec4
.long 0x0,0x0,0x0,0x0,0x3f80bf80,0x3f80bf80,0x3f80bf80,0x3f80bf80
.long 0xbe953dc9,0xbf223ef1,0xbf753f7f,0xbf463f62,0xbf753f7f,0xbf463f62,0x3e95bdc9,0x3f22bef1
.long 0x3f0ebe48,0x3f7bbf55,0xbf0e3e48,0xbf7b3f55,0x3f55bf7b,0x3e48bf0e,0xbf553f7b,0xbe483f0e
.long 0xbf463e95,0xbf623f7f,0x3f22bf75,0xbef1bdc9,0xbf223f75,0x3ef13dc9,0xbf463e95,0xbf623f7f
.long 0x3f6dbec4,0x3ec4bf6d,0x3f6dbec4,0x3ec4bf6d,0x3ec4bf6d,0xbf6d3ec4,0x3ec4bf6d,0xbf6d3ec4
.long 0xbf7f3ef1,0x3e953f22,0xbdc93f62,0x3f75bf46,0xbdc93f62,0x3f75bf46,0x3f7fbef1,0xbe95bf22
.long 0x3f7bbf0e,0xbf55be48,0xbf7b3f0e,0x3f553e48,0xbe48bf55,0xbf0e3f7b,0x3e483f55,0x3f0ebf7b
.long 0xbf623f22,0x3f7fbe95,0xbef1bf46,0x3dc93f75,0x3ef13f46,0xbdc9bf75,0xbf623f22,0x3f7fbe95
.long 0x0,0x0,0x0,0x0,0x3f80bf80,0x3f80bf80,0x3f80bf80,0x3f80bf80
.long 0xbf623f46,0xbf7f3f75,0xbef13f22,0xbdc93e95,0xbef13f22,0xbdc93e95,0x3f62bf46,0x3f7fbf75
.long 0x3f55bf7b,0x3e48bf0e,0xbf553f7b,0xbe483f0e,0xbf0e3e48,0xbf7b3f55,0x3f0ebe48,0x3f7bbf55
.long 0x3dc93ef1,0x3f75bf22,0xbf7f3f62,0xbe953f46,0x3f7fbf62,0x3e95bf46,0x3dc93ef1,0x3f75bf22
.long 0xbf6d3ec4,0xbec43f6d,0xbf6d3ec4,0xbec43f6d,0xbec43f6d,0x3f6dbec4,0xbec43f6d,0x3f6dbec4
.long 0x3f46bf75,0xbf623dc9,0xbf22be95,0xbef13f7f,0xbf22be95,0xbef13f7f,0xbf463f75,0x3f62bdc9
.long 0x3e483f55,0x3f0ebf7b,0xbe48bf55,0xbf0e3f7b,0x3f7bbf0e,0xbf55be48,0xbf7b3f0e,0x3f553e48
.long 0xbf75bdc9,0x3f463ef1,0x3e95bf7f,0xbf223f62,0xbe953f7f,0x3f22bf62,0xbf75bdc9,0x3f463ef1
.long 0x3f80,0xbf80,0x3f80,0xbf80,0x3f800000,0xbf800000,0x3f800000,0xbf800000
.long 0x3e483f80,0xbf0ebf6d,0x3f7b0000,0xbf553ec4,0x3f7b0000,0xbf553ec4,0xbe48bf80,0x3f0e3f6d
.long 0x3ec43f80,0xbf6dbf35,0xbec4bf80,0x3f6d3f35,0x3f6d0000,0xbec43f35,0xbf6d0000,0x3ec4bf35
.long 0x3f0e3f80,0xbf7bbec4,0xbf550000,0xbe48bf6d,0x3f550000,0x3e483f6d,0x3f0e3f80,0xbf7bbec4
.long 0x3f353f80,0xbf350000,0x3f353f80,0xbf350000,0x3f350000,0x3f353f80,0x3f350000,0x3f353f80
.long 0x3f553f80,0xbe483ec4,0x3f0e0000,0x3f7b3f6d,0x3f0e0000,0x3f7b3f6d,0xbf55bf80,0x3e48bec4
.long 0x3f6d3f80,0x3ec43f35,0xbf6dbf80,0xbec4bf35,0x3ec40000,0x3f6d3f35,0xbec40000,0xbf6dbf35
.long 0x3f7b3f80,0x3f553f6d,0xbe480000,0xbf0ebec4,0x3e480000,0x3f0e3ec4,0x3f7b3f80,0x3f553f6d
.long 0x3f80,0xbf80,0x3f80,0xbf80,0x3f800000,0xbf800000,0x3f800000,0xbf800000
.long 0x3f553f35,0xbf7bbec4,0x3f0ebf35,0xbe483f6d,0x3f0ebf35,0xbe483f6d,0xbf55bf35,0x3f7b3ec4
.long 0x3f6d0000,0xbec43f35,0xbf6d0000,0x3ec4bf35,0xbec4bf80,0x3f6d3f35,0x3ec43f80,0xbf6dbf35
.long 0x3e48bf35,0x3f553f6d,0x3f7b3f35,0xbf0e3ec4,0xbf7bbf35,0x3f0ebec4,0x3e48bf35,0x3f553f6d
.long 0xbf35bf80,0x3f350000,0xbf35bf80,0x3f350000,0xbf350000,0xbf35bf80,0xbf350000,0xbf35bf80
.long 0xbf7bbf35,0xbf0ebf6d,0x3e483f35,0xbf55bec4,0x3e483f35,0xbf55bec4,0x3f7b3f35,0x3f0e3f6d
.long 0xbec40000,0xbf6dbf35,0x3ec40000,0x3f6d3f35,0x3f6d3f80,0x3ec43f35,0xbf6dbf80,0xbec4bf35
.long 0x3f0e3f35,0x3e483ec4,0xbf55bf35,0xbf7bbf6d,0x3f553f35,0x3f7b3f6d,0x3f0e3f35,0x3e483ec4
.long 0x3f35bf35,0xbf353f35,0x3f35bf35,0xbf353f35,0xbf35bf35,0x3f353f35,0xbf35bf35,0x3f353f35
.long 0x3ef1bf46,0xbdc93f75,0xbf62bf22,0x3f7f3e95,0xbf62bf22,0x3f7f3e95,0xbef13f46,0x3dc9bf75
.long 0x3e48bf55,0x3f0e3f7b,0xbe483f55,0xbf0ebf7b,0xbf7bbf0e,0x3f55be48,0x3f7b3f0e,0xbf553e48
.long 0xbdc9bf62,0x3f753f46,0x3f7f3ef1,0xbe953f22,0xbf7fbef1,0x3e95bf22,0xbdc9bf62,0x3f753f46
.long 0xbec4bf6d,0x3f6d3ec4,0xbec4bf6d,0x3f6d3ec4,0xbf6dbec4,0xbec4bf6d,0xbf6dbec4,0xbec4bf6d
.long 0xbf22bf75,0x3ef1bdc9,0xbf46be95,0xbf62bf7f,0xbf46be95,0xbf62bf7f,0x3f223f75,0xbef13dc9
.long 0xbf55bf7b,0xbe48bf0e,0x3f553f7b,0x3e483f0e,0xbf0ebe48,0xbf7bbf55,0x3f0e3e48,0x3f7b3f55
.long 0xbf75bf7f,0xbf46bf62,0x3e953dc9,0x3f223ef1,0xbe95bdc9,0xbf22bef1,0xbf75bf7f,0xbf46bf62
.long 0x3f35bf35,0xbf353f35,0x3f35bf35,0xbf353f35,0xbf35bf35,0x3f353f35,0xbf35bf35,0x3f353f35
.long 0xbe95bf7f,0x3f223f62,0xbf753dc9,0x3f46bef1,0xbf753dc9,0x3f46bef1,0x3e953f7f,0xbf22bf62
.long 0xbf7bbf0e,0x3f55be48,0x3f7b3f0e,0xbf553e48,0xbe483f55,0xbf0ebf7b,0x3e48bf55,0x3f0e3f7b
.long 0xbf223e95,0xbef1bf7f,0xbf46bf75,0x3f623dc9,0x3f463f75,0xbf62bdc9,0xbf223e95,0xbef1bf7f
.long 0x3ec43f6d,0xbf6dbec4,0x3ec43f6d,0xbf6dbec4,0x3f6d3ec4,0x3ec43f6d,0x3f6d3ec4,0x3ec43f6d
.long 0x3f7f3f62,0x3e953f46,0x3dc9bef1,0x3f753f22,0x3dc9bef1,0x3f753f22,0xbf7fbf62,0xbe95bf46
.long 0x3f0e3e48,0x3f7b3f55,0xbf0ebe48,0xbf7bbf55,0xbf55bf7b,0xbe48bf0e,0x3f553f7b,0x3e483f0e
.long 0xbef1bf22,0xbdc9be95,0x3f623f46,0x3f7f3f75,0xbf62bf46,0xbf7fbf75,0xbef1bf22,0xbdc9be95
.long 0x3f80,0xbf80,0x3f80,0xbf80,0x3f800000,0xbf800000,0x3f800000,0xbf800000
.long 0xbe48bf80,0x3f0e3f6d,0xbf7b0000,0x3f55bec4,0xbf7b0000,0x3f55bec4,0x3e483f80,0xbf0ebf6d
.long 0x3ec43f80,0xbf6dbf35,0xbec4bf80,0x3f6d3f35,0x3f6d0000,0xbec43f35,0xbf6d0000,0x3ec4bf35
.long 0xbf0ebf80,0x3f7b3ec4,0x3f550000,0x3e483f6d,0xbf550000,0xbe48bf6d,0xbf0ebf80,0x3f7b3ec4
.long 0x3f353f80,0xbf350000,0x3f353f80,0xbf350000,0x3f350000,0x3f353f80,0x3f350000,0x3f353f80
.long 0xbf55bf80,0x3e48bec4,0xbf0e0000,0xbf7bbf6d,0xbf0e0000,0xbf7bbf6d,0x3f553f80,0xbe483ec4
.long 0x3f6d3f80,0x3ec43f35,0xbf6dbf80,0xbec4bf35,0x3ec40000,0x3f6d3f35,0xbec40000,0xbf6dbf35
.long 0xbf7bbf80,0xbf55bf6d,0x3e480000,0x3f0e3ec4,0xbe480000,0xbf0ebec4,0xbf7bbf80,0xbf55bf6d
.long 0x3f80,0xbf80,0x3f80,0xbf80,0x3f800000,0xbf800000,0x3f800000,0xbf800000
.long 0xbf55bf35,0x3f7b3ec4,0xbf0e3f35,0x3e48bf6d,0xbf0e3f35,0x3e48bf6d,0x3f553f35,0xbf7bbec4
.long 0x3f6d0000,0xbec43f35,0xbf6d0000,0x3ec4bf35,0xbec4bf80,0x3f6d3f35,0x3ec43f80,0xbf6dbf35
.long 0xbe483f35,0xbf55bf6d,0xbf7bbf35,0x3f0ebec4,0x3f7b3f35,0xbf0e3ec4,0xbe483f35,0xbf55bf6d
.long 0xbf35bf80,0x3f350000,0xbf35bf80,0x3f350000,0xbf350000,0xbf35bf80,0xbf350000,0xbf35bf80
.long 0x3f7b3f35,0x3f0e3f6d,0xbe48bf35,0x3f553ec4,0xbe48bf35,0x3f553ec4,0xbf7bbf35,0xbf0ebf6d
.long 0xbec40000,0xbf6dbf35,0x3ec40000,0x3f6d3f35,0x3f6d3f80,0x3ec43f35,0xbf6dbf80,0xbec4bf35
.long 0xbf0ebf35,0xbe48bec4,0x3f553f35,0x3f7b3f6d,0xbf55bf35,0xbf7bbf6d,0xbf0ebf35,0xbe48bec4
.long 0x3f35bf35,0xbf353f35,0x3f35bf35,0xbf353f35,0xbf35bf35,0x3f353f35,0xbf35bf35,0x3f353f35
.long 0xbef13f46,0x3dc9bf75,0x3f623f22,0xbf7fbe95,0x3f623f22,0xbf7fbe95,0x3ef1bf46,0xbdc93f75
.long 0x3e48bf55,0x3f0e3f7b,0xbe483f55,0xbf0ebf7b,0xbf7bbf0e,0x3f55be48,0x3f7b3f0e,0xbf553e48
.long 0x3dc93f62,0xbf75bf46,0xbf7fbef1,0x3e95bf22,0x3f7f3ef1,0xbe953f22,0x3dc93f62,0xbf75bf46
.long 0xbec4bf6d,0x3f6d3ec4,0xbec4bf6d,0x3f6d3ec4,0xbf6dbec4,0xbec4bf6d,0xbf6dbec4,0xbec4bf6d
.long 0x3f223f75,0xbef13dc9,0x3f463e95,0x3f623f7f,0x3f463e95,0x3f623f7f,0xbf22bf75,0x3ef1bdc9
.long 0xbf55bf7b,0xbe48bf0e,0x3f553f7b,0x3e483f0e,0xbf0ebe48,0xbf7bbf55,0x3f0e3e48,0x3f7b3f55
.long 0x3f753f7f,0x3f463f62,0xbe95bdc9,0xbf22bef1,0x3e953dc9,0x3f223ef1,0x3f753f7f,0x3f463f62
.long 0x3f35bf35,0xbf353f35,0x3f35bf35,0xbf353f35,0xbf35bf35,0x3f353f35,0xbf35bf35,0x3f353f35
.long 0x3e953f7f,0xbf22bf62,0x3f75bdc9,0xbf463ef1,0x3f75bdc9,0xbf463ef1,0xbe95bf7f,0x3f223f62
.long 0xbf7bbf0e,0x3f55be48,0x3f7b3f0e,0xbf553e48,0xbe483f55,0xbf0ebf7b,0x3e48bf55,0x3f0e3f7b
.long 0x3f22be95,0x3ef13f7f,0x3f463f75,0xbf62bdc9,0xbf46bf75,0x3f623dc9,0x3f22be95,0x3ef13f7f
.long 0x3ec43f6d,0xbf6dbec4,0x3ec43f6d,0xbf6dbec4,0x3f6d3ec4,0x3ec43f6d,0x3f6d3ec4,0x3ec43f6d
.long 0xbf7fbf62,0xbe95bf46,0xbdc93ef1,0xbf75bf22,0xbdc93ef1,0xbf75bf22,0x3f7f3f62,0x3e953f46
.long 0x3f0e3e48,0x3f7b3f55,0xbf0ebe48,0xbf7bbf55,0xbf55bf7b,0xbe48bf0e,0x3f553f7b,0x3e483f0e
.long 0x3ef13f22,0x3dc93e95,0xbf62bf46,0xbf7fbf75,0x3f623f46,0x3f7f3f75,0x3ef13f22,0x3dc93e95
.size L_table, 22528
L_end:
.section .rodata,"a"
.p2align 6
.amdhsa_kernel interleave_layers__spectral_fnet__mixer_gmlp__prompt_kernel
  .amdhsa_next_free_vgpr 512
  .amdhsa_next_free_sgpr 102
  .amdhsa_accum_offset 256
  .amdhsa_group_segment_fixed_size 0
  .amdhsa_kernarg_size 104
  .amdhsa_user_sgpr_count 2
  .amdhsa_user_sgpr_kernarg_segment_ptr 1
  .amdhsa_system_sgpr_workgroup_id_x 1
  .amdhsa_float_denorm_mode_32 3
.end_amdhsa_kernel
```
